```python
import torch

def _softmax(x, axis=-1):
    return torch.softmax(x, dim=axis)

def _gelu(x):
    return torch.nn.functional.gelu(x, approximate='tanh')

def _silu(x):
    return torch.nn.functional.silu(x)

def _sigmoid(x):
    return torch.sigmoid(x)

def _layernorm(x, axis=-1, eps=1e-05):
    m = x.mean(dim=axis, keepdim=True)
    v = x.var(dim=axis, keepdim=True, unbiased=False)
    return (x - m) / torch.sqrt(v + eps)

def _scatter_add(tgt, idx, src, axis=0):
    return tgt.clone().index_add_(axis, idx, src)

def _segment_sum(src, seg, n):
    out = torch.zeros((n,) + src.shape[1:], dtype=src.dtype)
    return out.index_add_(0, seg, src)

def _pad(x, pw):
    flat = tuple((v for pair in reversed(pw) for v in pair))
    return torch.nn.functional.pad(x, flat)
kernel_name = 'adaLN_cond__sliding_block_cached__dense_activation_squared_relu__prompt'

def setup_inputs():

    _w = lambda a: (lambda t: t.to(torch.bfloat16) if t.is_floating_point() else t)(torch.as_tensor(a))

    def _A_setup():
        B, Sq, D = (1, 2048, 640)
        Hq, Hkv, Sk, Dh = (32, 32, 2048, 128)
        assert Hq % Hkv == 0, (Hq, Hkv)
        return {'x': _w((lambda *s: torch.randn(*s, dtype=torch.bfloat16) * 0.05)(B, Sq, D)), 'k_cache': _w((lambda *s: torch.randn(*s, dtype=torch.bfloat16) * 3.2)(B, Hkv, Sk, Dh)), 'v_cache': _w((lambda *s: torch.randn(*s, dtype=torch.bfloat16) * 0.4)(B, Hkv, Sk, Dh)), 'wq': _w((lambda *s: torch.randn(*s, dtype=torch.bfloat16) * 3.2)(D, Hq * Dh) * D ** (-0.5)), 'wo': _w((lambda *s: torch.randn(*s, dtype=torch.bfloat16) * 0.4)(Hq * Dh, D) * (Hq * Dh) ** (-0.5))}
    _A_in = _A_setup()

    def _B_setup():
        B, S, D, F = (1, 2048, 640, 1728)
        return {'x': _w((lambda *s: torch.randn(*s, dtype=torch.bfloat16) * 0.05)(B, S, D)), 'w1': _w((lambda *s: torch.randn(*s, dtype=torch.bfloat16) * 0.05)(D, F)), 'b1': _w((lambda *s: torch.randn(*s, dtype=torch.bfloat16) * 0.8)(F)), 'w2': _w((lambda *s: torch.randn(*s, dtype=torch.bfloat16) * 0.05)(F, D)), 'b2': _w((lambda *s: torch.randn(*s, dtype=torch.bfloat16) * 6.4)(D))}
    _B_in = _B_setup()
    return {'A_x': _A_in['x'], 'A_k_cache': _A_in['k_cache'], 'A_v_cache': _A_in['v_cache'], 'A_wq': _A_in['wq'], 'A_wo': _A_in['wo'], 'B_x': _B_in['x'], 'B_w1': _B_in['w1'], 'B_b1': _B_in['b1'], 'B_w2': _B_in['w2'], 'B_b2': _B_in['b2'], 'c': _w((lambda *s: torch.randn(*s, dtype=torch.bfloat16) * 0.1)(1, 640) * 8.0), 'w_mod': _w((lambda *s: torch.randn(*s, dtype=torch.bfloat16) * 0.1)(640, 6 * 640) * 640 ** (-0.5) * 8.0)}

def reference(A_x, A_k_cache, A_v_cache, A_wq, A_wo, B_x, B_w1, B_b1, B_w2, B_b2, c, w_mod):

    def _A_ref(x, k_cache, v_cache, wq, wo):
        B, Sq, D = x.shape
        Hq, Dh = (32, 128)
        Hkv, Sk = (k_cache.shape[1], k_cache.shape[2])
        W = min(4096, max(256, Sk // 4))
        rep = Hq // Hkv
        q = (lambda x, *d: x.permute(*d))((x @ wq).reshape(B, Sq, Hq, Dh), 0, 2, 1, 3)
        k = (lambda x, n, axis: torch.repeat_interleave(x, n, dim=axis))(k_cache[:, :, Sk - W:, :], rep, axis=1)
        v = (lambda x, n, axis: torch.repeat_interleave(x, n, dim=axis))(v_cache[:, :, Sk - W:, :], rep, axis=1)
        scores = torch.einsum('bhqd,bhkd->bhqk', q, k) * Dh ** (-0.5)
        p = _softmax(scores, axis=-1)
        o = torch.einsum('bhqk,bhkd->bhqd', p, v)
        return (lambda x, *d: x.permute(*d))(o, 0, 2, 1, 3).reshape(B, Sq, Hq * Dh) @ wo

    def _B_ref(x, w1, b1, w2, b2):
        h = torch.einsum('bsd,df->bsf', x, w1) + b1
        zero = torch.zeros_like(h)
        r = torch.where(h > zero, h, zero)
        h = r * r
        out = torch.einsum('bsf,fd->bsd', h, w2) + b2
        return out
    x = A_x
    mod = (_silu(c) @ w_mod).reshape(c.shape[0], 6, 1, -1)
    sa, ca, ga, sb, cb, gb = (mod[:, 0].clone(), mod[:, 1].clone(), mod[:, 2].clone(), mod[:, 3].clone(), mod[:, 4].clone(), mod[:, 5].clone())
    h = _layernorm(x, axis=-1) * (1 + ca) + sa
    x = x + ga * _A_ref(h, A_k_cache, A_v_cache, A_wq, A_wo)
    h = _layernorm(x, axis=-1) * (1 + cb) + sb
    x = x + gb * _B_ref(h, B_w1, B_b1, B_w2, B_b2)
    return x
```

```asm
; @launch kernel=k1_kernel grid=(256,1,1) block=(512,1,1) lds=161024
; @launch kernel=kf_kernel grid=(256,1,1) block=(256,1,1) lds=163840
.amdgcn_target "amdgcn-amd-amdhsa--gfx950"
.text
.globl k1_kernel
.p2align 8
.type k1_kernel,@function
k1_kernel:
  s_cmp_ge_u32 s2, 256
  s_cbranch_scc1 K2_END
  s_load_dwordx2 s[40:41], s[0:1], 80
  s_load_dwordx2 s[44:45], s[0:1], 88
  s_load_dwordx2 s[48:49], s[0:1], 0
  s_load_dwordx2 s[16:17], s[0:1], 112
  s_load_dwordx2 s[4:5], s[0:1], 24
  s_load_dwordx2 s[52:53], s[0:1], 104
  s_load_dwordx2 s[8:9], s[0:1], 8
  s_load_dwordx2 s[12:13], s[0:1], 16
  s_mov_b32 s42, 1280
  s_mov_b32 s43, 0x00020000
  s_mov_b32 s46, 4915200
  s_mov_b32 s47, 0x00020000
  s_mov_b32 s50, 2621440
  s_mov_b32 s51, 0x00020000
  s_mov_b32 s18, 268435456
  s_mov_b32 s19, 0x00020000
  s_mov_b32 s6, 5242880
  s_mov_b32 s7, 0x00020000
  s_mov_b32 s54, 256
  s_mov_b32 s55, 0x00020000
  s_mov_b32 s10, 16777216
  s_mov_b32 s11, 0x00020000
  s_mov_b32 s14, 16777216
  s_mov_b32 s15, 0x00020000
  v_readfirstlane_b32 s20, v0
  s_nop 0
  s_lshr_b32 s20, s20, 6
  s_and_b32 s21, s2, 7
  s_lshl_b32 s21, s21, 2
  s_bfe_u32 s32, s2, 0x20003
  s_add_u32 s21, s21, s32
  s_lshr_b32 s22, s2, 5
  s_lshl_b32 s23, s20, 11
  s_mov_b32 s30, 0xffff0000
  s_cmp_ge_u32 s2, 184
  s_cbranch_scc1 K1_NONE
  s_sub_u32 s24, s2, 40
  s_cmp_lt_u32 s24, 64
  s_cbranch_scc1 K1_LN
  s_cmp_lt_u32 s2, 40
  s_cselect_b32 s24, 0, 64
  s_sub_u32 s24, s2, s24
  s_and_b32 s25, s24, 7
  s_lshl_b32 s25, s25, 1
  s_bfe_u32 s26, s24, 0x10003
  s_or_b32 s25, s25, s26
  s_andn2_b32 s26, s24, 15
  s_or_b32 s25, s25, s26
  s_sub_u32 s26, s24, 32
  s_cmp_lt_u32 s26, 16
  s_cselect_b32 s25, s24, s25
  s_cmp_ge_u32 s24, 112
  s_cselect_b32 s24, s24, s25
  v_bfe_u32 v60, v0, 4, 2
  v_and_b32 v61, 15, v0
  v_lshlrev_b32 v61, 4, v61
  v_lshl_add_u32 v250, v60, 13, v61
  s_lshl_b32 s32, s20, 16
  s_lshl_b32 s33, s21, 8
  s_add_u32 s32, s32, s33
  v_add_u32 v250, s32, v250
  v_add_u32 v251, 32768, v250
  s_cmp_lt_u32 s2, 40
  s_cbranch_scc1 K1_MGO
  s_sleep 30
K1_MGO:
  v_lshrrev_b32 v1, 2, v0
  v_and_b32 v2, 3, v0
  v_mul_u32_u24 v3, 10, v1
  v_mul_u32_u24 v4, 38400, v1
  v_lshl_add_u32 v4, v2, 4, v4
  s_lshl_b32 s25, s24, 6
  s_add_u32 s26, s25, 7680
  s_add_u32 s27, s25, 15360
  s_add_u32 s28, s25, 23040
  s_add_u32 s29, s25, 30720
  s_waitcnt lgkmcnt(0)
  buffer_load_dwordx4 v[16:19], v4, s[44:47], s25 offen
  buffer_load_dwordx4 v[20:23], v4, s[44:47], s26 offen
  buffer_load_dwordx4 v[24:27], v4, s[44:47], s27 offen
  buffer_load_dwordx4 v[28:31], v4, s[44:47], s28 offen
  buffer_load_dwordx4 v[32:35], v4, s[44:47], s29 offen
  buffer_load_ushort v10, v3, s[40:43], 0 offen offset:0
  buffer_load_ushort v11, v3, s[40:43], 0 offen offset:2
  buffer_load_ushort v12, v3, s[40:43], 0 offen offset:4
  buffer_load_ushort v13, v3, s[40:43], 0 offen offset:6
  buffer_load_ushort v14, v3, s[40:43], 0 offen offset:8
  s_memrealtime s[98:99]
  s_cmp_eq_u32 s20, 0
  s_cselect_b32 s96, 0, 0x1000
  v_mov_b32 v249, s96
  v_mov_b32 v254, 0
  v_mov_b32 v255, 0
  s_waitcnt lgkmcnt(0)
  v_mov_b32 v252, s98
  v_mov_b32 v253, s99
  s_mov_b64 exec, 1
  buffer_atomic_cmpswap_x2 v[252:255], v249, s[52:55], 0 offen sc0 sc1
  s_mov_b64 exec, -1
  s_waitcnt vmcnt(5)
  v_lshlrev_b32 v10, 16, v10
  v_mul_f32 v40, 0xbfb8aa3b, v10
  v_exp_f32 v40, v40
  s_nop 0
  v_add_f32 v40, 1.0, v40
  v_rcp_f32 v40, v40
  s_nop 0
  v_mul_f32 v10, v10, v40
  v_cvt_pk_bf16_f32 v10, v10, v10
  v_lshlrev_b32 v10, 16, v10
  s_waitcnt vmcnt(4)
  v_lshlrev_b32 v11, 16, v11
  v_mul_f32 v41, 0xbfb8aa3b, v11
  v_exp_f32 v41, v41
  s_nop 0
  v_add_f32 v41, 1.0, v41
  v_rcp_f32 v41, v41
  s_nop 0
  v_mul_f32 v11, v11, v41
  v_cvt_pk_bf16_f32 v11, v11, v11
  v_lshlrev_b32 v11, 16, v11
  s_waitcnt vmcnt(3)
  v_lshlrev_b32 v12, 16, v12
  v_mul_f32 v42, 0xbfb8aa3b, v12
  v_exp_f32 v42, v42
  s_nop 0
  v_add_f32 v42, 1.0, v42
  v_rcp_f32 v42, v42
  s_nop 0
  v_mul_f32 v12, v12, v42
  v_cvt_pk_bf16_f32 v12, v12, v12
  v_lshlrev_b32 v12, 16, v12
  s_waitcnt vmcnt(2)
  v_lshlrev_b32 v13, 16, v13
  v_mul_f32 v43, 0xbfb8aa3b, v13
  v_exp_f32 v43, v43
  s_nop 0
  v_add_f32 v43, 1.0, v43
  v_rcp_f32 v43, v43
  s_nop 0
  v_mul_f32 v13, v13, v43
  v_cvt_pk_bf16_f32 v13, v13, v13
  v_lshlrev_b32 v13, 16, v13
  s_waitcnt vmcnt(1)
  v_lshlrev_b32 v14, 16, v14
  v_mul_f32 v44, 0xbfb8aa3b, v14
  v_exp_f32 v44, v44
  s_nop 0
  v_add_f32 v44, 1.0, v44
  v_rcp_f32 v44, v44
  s_nop 0
  v_mul_f32 v14, v14, v44
  v_cvt_pk_bf16_f32 v14, v14, v14
  v_lshlrev_b32 v14, 16, v14
  v_lshlrev_b32 v56, 16, v16
  v_and_b32 v57, s30, v16
  v_mul_f32 v48, v56, v10
  v_mul_f32 v49, v57, v10
  v_lshlrev_b32 v56, 16, v17
  v_and_b32 v57, s30, v17
  v_mul_f32 v50, v56, v10
  v_mul_f32 v51, v57, v10
  v_lshlrev_b32 v56, 16, v18
  v_and_b32 v57, s30, v18
  v_mul_f32 v52, v56, v10
  v_mul_f32 v53, v57, v10
  v_lshlrev_b32 v56, 16, v19
  v_and_b32 v57, s30, v19
  v_mul_f32 v54, v56, v10
  v_mul_f32 v55, v57, v10
  v_lshlrev_b32 v56, 16, v20
  v_and_b32 v57, s30, v20
  v_fmac_f32 v48, v56, v11
  v_fmac_f32 v49, v57, v11
  v_lshlrev_b32 v56, 16, v21
  v_and_b32 v57, s30, v21
  v_fmac_f32 v50, v56, v11
  v_fmac_f32 v51, v57, v11
  v_lshlrev_b32 v56, 16, v22
  v_and_b32 v57, s30, v22
  v_fmac_f32 v52, v56, v11
  v_fmac_f32 v53, v57, v11
  v_lshlrev_b32 v56, 16, v23
  v_and_b32 v57, s30, v23
  v_fmac_f32 v54, v56, v11
  v_fmac_f32 v55, v57, v11
  v_lshlrev_b32 v56, 16, v24
  v_and_b32 v57, s30, v24
  v_fmac_f32 v48, v56, v12
  v_fmac_f32 v49, v57, v12
  v_lshlrev_b32 v56, 16, v25
  v_and_b32 v57, s30, v25
  v_fmac_f32 v50, v56, v12
  v_fmac_f32 v51, v57, v12
  v_lshlrev_b32 v56, 16, v26
  v_and_b32 v57, s30, v26
  v_fmac_f32 v52, v56, v12
  v_fmac_f32 v53, v57, v12
  v_lshlrev_b32 v56, 16, v27
  v_and_b32 v57, s30, v27
  v_fmac_f32 v54, v56, v12
  v_fmac_f32 v55, v57, v12
  v_lshlrev_b32 v56, 16, v28
  v_and_b32 v57, s30, v28
  v_fmac_f32 v48, v56, v13
  v_fmac_f32 v49, v57, v13
  v_lshlrev_b32 v56, 16, v29
  v_and_b32 v57, s30, v29
  v_fmac_f32 v50, v56, v13
  v_fmac_f32 v51, v57, v13
  v_lshlrev_b32 v56, 16, v30
  v_and_b32 v57, s30, v30
  v_fmac_f32 v52, v56, v13
  v_fmac_f32 v53, v57, v13
  v_lshlrev_b32 v56, 16, v31
  v_and_b32 v57, s30, v31
  v_fmac_f32 v54, v56, v13
  v_fmac_f32 v55, v57, v13
  v_lshlrev_b32 v56, 16, v32
  v_and_b32 v57, s30, v32
  v_fmac_f32 v48, v56, v14
  v_fmac_f32 v49, v57, v14
  v_lshlrev_b32 v56, 16, v33
  v_and_b32 v57, s30, v33
  v_fmac_f32 v50, v56, v14
  v_fmac_f32 v51, v57, v14
  v_lshlrev_b32 v56, 16, v34
  v_and_b32 v57, s30, v34
  v_fmac_f32 v52, v56, v14
  v_fmac_f32 v53, v57, v14
  v_lshlrev_b32 v56, 16, v35
  v_and_b32 v57, s30, v35
  v_fmac_f32 v54, v56, v14
  v_fmac_f32 v55, v57, v14
  v_add_f32_dpp v48, v48, v48 row_ror:8 row_mask:0xf bank_mask:0xf
  v_add_f32_dpp v49, v49, v49 row_ror:8 row_mask:0xf bank_mask:0xf
  v_add_f32_dpp v50, v50, v50 row_ror:8 row_mask:0xf bank_mask:0xf
  v_add_f32_dpp v51, v51, v51 row_ror:8 row_mask:0xf bank_mask:0xf
  v_add_f32_dpp v52, v52, v52 row_ror:8 row_mask:0xf bank_mask:0xf
  v_add_f32_dpp v53, v53, v53 row_ror:8 row_mask:0xf bank_mask:0xf
  v_add_f32_dpp v54, v54, v54 row_ror:8 row_mask:0xf bank_mask:0xf
  v_add_f32_dpp v55, v55, v55 row_ror:8 row_mask:0xf bank_mask:0xf
  v_add_f32_dpp v48, v48, v48 row_ror:4 row_mask:0xf bank_mask:0xf
  v_add_f32_dpp v49, v49, v49 row_ror:4 row_mask:0xf bank_mask:0xf
  v_add_f32_dpp v50, v50, v50 row_ror:4 row_mask:0xf bank_mask:0xf
  v_add_f32_dpp v51, v51, v51 row_ror:4 row_mask:0xf bank_mask:0xf
  v_add_f32_dpp v52, v52, v52 row_ror:4 row_mask:0xf bank_mask:0xf
  v_add_f32_dpp v53, v53, v53 row_ror:4 row_mask:0xf bank_mask:0xf
  v_add_f32_dpp v54, v54, v54 row_ror:4 row_mask:0xf bank_mask:0xf
  v_add_f32_dpp v55, v55, v55 row_ror:4 row_mask:0xf bank_mask:0xf
  v_lshrrev_b32 v5, 4, v0
  v_lshlrev_b32 v5, 7, v5
  v_lshl_add_u32 v5, v2, 5, v5
  v_add_u32 v5, 147712, v5
  ds_write_b128 v5, v[48:51]
  ds_write_b128 v5, v[52:55] offset:16
  s_waitcnt lgkmcnt(0)
  s_barrier
  s_cmp_lg_u32 s20, 0
  s_cbranch_scc1 K1_MEND
  v_and_b32 v6, 31, v0
  v_lshrrev_b32 v7, 5, v0
  v_lshlrev_b32 v7, 11, v7
  v_lshl_add_u32 v7, v6, 2, v7
  v_add_u32 v7, 147712, v7
  ds_read_b32 v16, v7 offset:0
  ds_read_b32 v17, v7 offset:128
  ds_read_b32 v18, v7 offset:256
  ds_read_b32 v19, v7 offset:384
  ds_read_b32 v20, v7 offset:512
  ds_read_b32 v21, v7 offset:640
  ds_read_b32 v22, v7 offset:768
  ds_read_b32 v23, v7 offset:896
  ds_read_b32 v24, v7 offset:1024
  ds_read_b32 v25, v7 offset:1152
  ds_read_b32 v26, v7 offset:1280
  ds_read_b32 v27, v7 offset:1408
  ds_read_b32 v28, v7 offset:1536
  ds_read_b32 v29, v7 offset:1664
  ds_read_b32 v30, v7 offset:1792
  ds_read_b32 v31, v7 offset:1920
  s_waitcnt lgkmcnt(7)
  v_add_f32 v16, v16, v24
  s_waitcnt lgkmcnt(6)
  v_add_f32 v17, v17, v25
  s_waitcnt lgkmcnt(5)
  v_add_f32 v18, v18, v26
  s_waitcnt lgkmcnt(4)
  v_add_f32 v19, v19, v27
  s_waitcnt lgkmcnt(3)
  v_add_f32 v20, v20, v28
  s_waitcnt lgkmcnt(2)
  v_add_f32 v21, v21, v29
  s_waitcnt lgkmcnt(1)
  v_add_f32 v22, v22, v30
  s_waitcnt lgkmcnt(0)
  v_add_f32 v23, v23, v31
  v_add_f32 v16, v16, v20
  v_add_f32 v17, v17, v21
  v_add_f32 v18, v18, v22
  v_add_f32 v19, v19, v23
  v_add_f32 v16, v16, v18
  v_add_f32 v17, v17, v19
  v_add_f32 v16, v16, v17
  v_mov_b32 v17, v16
  s_nop 1
  v_permlane32_swap_b32 v16, v17
  v_add_f32 v16, v16, v17
  v_cvt_pk_bf16_f32 v16, v16, v16
  v_lshlrev_b32 v16, 16, v16
  s_mov_b32 s31, 0
  s_sub_u32 s26, s24, 20
  s_cmp_lt_u32 s26, 20
  s_cselect_b32 s31, 1.0, s31
  s_sub_u32 s26, s24, 80
  s_cmp_lt_u32 s26, 20
  s_cselect_b32 s31, 1.0, s31
  v_add_f32 v16, s31, v16
  v_cvt_pk_bf16_f32 v17, v16, v16
  v_lshlrev_b32 v16, 16, v17
  v_lshlrev_b32 v8, 2, v6
  v_lshlrev_b32 v9, 1, v6
  s_lshl_b32 s26, s24, 7
  s_add_u32 s27, s25, 16384
  s_waitcnt vmcnt(0)
  v_readfirstlane_b32 s96, v252
  v_readfirstlane_b32 s97, v253
  s_nop 0
  s_cmp_eq_u64 s[96:97], 0
  s_cselect_b64 s[96:97], s[98:99], s[96:97]
  s_cmp_ge_u32 s24, 40
  s_cbranch_scc1 K1_MODB
  v_add_u32 v20, 151808, v9
  ds_write_b16 v20, v17
  v_and_b32 v21, 7, v0
  v_lshlrev_b32 v22, 3, v21
  v_add_u32 v22, 151808, v22
  ds_read_b64 v[24:25], v22
  v_lshrrev_b32 v23, 3, v0
  v_lshlrev_b32 v23, 13, v23
  v_lshl_add_u32 v23, v21, 4, v23
  v_mov_b32 v26, s96
  v_mov_b32 v27, s97
  s_add_u32 s28, s26, 54525952
  s_waitcnt lgkmcnt(0)
  buffer_store_dwordx4 v[24:27], v23, s[16:19], s28 offen sc1
  s_nop 0
  s_add_u32 s28, s28, 65536
  buffer_store_dwordx4 v[24:27], v23, s[16:19], s28 offen sc1
  s_nop 0
  s_add_u32 s28, s28, 65536
  buffer_store_dwordx4 v[24:27], v23, s[16:19], s28 offen sc1
  s_nop 0
  s_add_u32 s28, s28, 65536
  buffer_store_dwordx4 v[24:27], v23, s[16:19], s28 offen sc1
K1_MODB:
  buffer_store_dword v16, v8, s[16:19], s26 offen
  buffer_store_short v17, v9, s[16:19], s27 offen
K1_MEND:
  s_cmp_lt_u32 s2, 40
  s_cbranch_scc1 K1_BULK
  s_branch K1_BULK
K1_LN:
  v_and_b32 v1, 3, v0
  v_lshrrev_b32 v2, 6, v0
  v_lshl_add_u32 v1, v2, 2, v1
  v_bfe_u32 v2, v0, 2, 4
  v_mul_u32_u24 v3, 1280, v1
  v_lshl_add_u32 v3, v2, 4, v3
  s_mul_i32 s26, s24, 40960
  s_waitcnt lgkmcnt(0)
  buffer_load_dwordx4 v[8:11], v3, s[48:51], s26 offen offset:0
  buffer_load_dwordx4 v[12:15], v3, s[48:51], s26 offen offset:256
  buffer_load_dwordx4 v[16:19], v3, s[48:51], s26 offen offset:512
  buffer_load_dwordx4 v[20:23], v3, s[48:51], s26 offen offset:768
  buffer_load_dwordx4 v[24:27], v3, s[48:51], s26 offen offset:1024
  s_memrealtime s[98:99]
  s_cmp_eq_u32 s20, 0
  s_cselect_b32 s96, 0, 0x1000
  v_mov_b32 v249, s96
  v_mov_b32 v254, 0
  v_mov_b32 v255, 0
  s_waitcnt lgkmcnt(0)
  v_mov_b32 v252, s98
  v_mov_b32 v253, s99
  s_mov_b64 exec, 1
  buffer_atomic_cmpswap_x2 v[252:255], v249, s[52:55], 0 offen sc0 sc1
  s_mov_b64 exec, -1
  v_bfe_u32 v60, v0, 4, 2
  v_and_b32 v61, 15, v0
  v_lshlrev_b32 v61, 4, v61
  v_lshl_add_u32 v250, v60, 13, v61
  s_lshl_b32 s32, s20, 16
  s_lshl_b32 s33, s21, 8
  s_add_u32 s32, s32, s33
  v_add_u32 v250, s32, v250
  v_add_u32 v251, 32768, v250
  v_lshlrev_b32 v4, 9, v2
  v_lshl_add_u32 v4, v1, 4, v4
  s_add_u32 s34, s26, 4194304
  s_add_u32 s35, s34, 8192
  s_add_u32 s36, s34, 16384
  s_add_u32 s37, s34, 24576
  s_add_u32 s38, s34, 32768
  s_lshr_b32 s39, s24, 3
  s_lshl_b32 s39, s39, 13
  s_and_b32 s29, s24, 7
  s_lshl_b32 s29, s29, 3
  s_add_u32 s39, s39, s29
  s_add_u32 s39, s39, 55574528
  s_waitcnt vmcnt(5)
  v_lshlrev_b32 v32, 16, v8
  v_and_b32 v33, s30, v8
  v_lshlrev_b32 v34, 16, v9
  v_and_b32 v35, s30, v9
  v_lshlrev_b32 v36, 16, v10
  v_and_b32 v37, s30, v10
  v_lshlrev_b32 v38, 16, v11
  v_and_b32 v39, s30, v11
  s_waitcnt vmcnt(4)
  v_lshlrev_b32 v40, 16, v12
  v_and_b32 v41, s30, v12
  v_lshlrev_b32 v42, 16, v13
  v_and_b32 v43, s30, v13
  v_lshlrev_b32 v44, 16, v14
  v_and_b32 v45, s30, v14
  v_lshlrev_b32 v46, 16, v15
  v_and_b32 v47, s30, v15
  s_waitcnt vmcnt(3)
  v_lshlrev_b32 v48, 16, v16
  v_and_b32 v49, s30, v16
  v_lshlrev_b32 v50, 16, v17
  v_and_b32 v51, s30, v17
  v_lshlrev_b32 v52, 16, v18
  v_and_b32 v53, s30, v18
  v_lshlrev_b32 v54, 16, v19
  v_and_b32 v55, s30, v19
  s_waitcnt vmcnt(2)
  v_lshlrev_b32 v56, 16, v20
  v_and_b32 v57, s30, v20
  v_lshlrev_b32 v58, 16, v21
  v_and_b32 v59, s30, v21
  v_lshlrev_b32 v60, 16, v22
  v_and_b32 v61, s30, v22
  v_lshlrev_b32 v62, 16, v23
  v_and_b32 v63, s30, v23
  s_waitcnt vmcnt(1)
  v_lshlrev_b32 v64, 16, v24
  v_and_b32 v65, s30, v24
  v_lshlrev_b32 v66, 16, v25
  v_and_b32 v67, s30, v25
  v_lshlrev_b32 v68, 16, v26
  v_and_b32 v69, s30, v26
  v_lshlrev_b32 v70, 16, v27
  v_and_b32 v71, s30, v27
  v_add_f32 v5, v32, v33
  v_add_f32 v6, v34, v35
  v_add_f32 v5, v5, v36
  v_add_f32 v6, v6, v37
  v_add_f32 v5, v5, v38
  v_add_f32 v6, v6, v39
  v_add_f32 v5, v5, v40
  v_add_f32 v6, v6, v41
  v_add_f32 v5, v5, v42
  v_add_f32 v6, v6, v43
  v_add_f32 v5, v5, v44
  v_add_f32 v6, v6, v45
  v_add_f32 v5, v5, v46
  v_add_f32 v6, v6, v47
  v_add_f32 v5, v5, v48
  v_add_f32 v6, v6, v49
  v_add_f32 v5, v5, v50
  v_add_f32 v6, v6, v51
  v_add_f32 v5, v5, v52
  v_add_f32 v6, v6, v53
  v_add_f32 v5, v5, v54
  v_add_f32 v6, v6, v55
  v_add_f32 v5, v5, v56
  v_add_f32 v6, v6, v57
  v_add_f32 v5, v5, v58
  v_add_f32 v6, v6, v59
  v_add_f32 v5, v5, v60
  v_add_f32 v6, v6, v61
  v_add_f32 v5, v5, v62
  v_add_f32 v6, v6, v63
  v_add_f32 v5, v5, v64
  v_add_f32 v6, v6, v65
  v_add_f32 v5, v5, v66
  v_add_f32 v6, v6, v67
  v_add_f32 v5, v5, v68
  v_add_f32 v6, v6, v69
  v_add_f32 v5, v5, v70
  v_add_f32 v6, v6, v71
  v_add_f32 v5, v5, v6
  s_nop 1
  v_add_f32_dpp v5, v5, v5 row_ror:8 row_mask:0xf bank_mask:0xf
  s_nop 1
  v_add_f32_dpp v5, v5, v5 row_ror:4 row_mask:0xf bank_mask:0xf
  v_mov_b32 v7, v5
  s_nop 1
  v_permlane16_swap_b32 v5, v7
  v_add_f32 v5, v5, v7
  v_mov_b32 v7, v5
  s_nop 1
  v_permlane32_swap_b32 v5, v7
  v_add_f32 v5, v5, v7
  v_mul_f32 v5, 0x3acccccd, v5
  v_mov_b32 v6, 0
  v_mov_b32 v30, 0
  v_sub_f32 v28, v32, v5
  v_sub_f32 v29, v33, v5
  v_fmac_f32 v6, v28, v28
  v_fmac_f32 v30, v29, v29
  v_sub_f32 v28, v34, v5
  v_sub_f32 v29, v35, v5
  v_fmac_f32 v6, v28, v28
  v_fmac_f32 v30, v29, v29
  v_sub_f32 v28, v36, v5
  v_sub_f32 v29, v37, v5
  v_fmac_f32 v6, v28, v28
  v_fmac_f32 v30, v29, v29
  v_sub_f32 v28, v38, v5
  v_sub_f32 v29, v39, v5
  v_fmac_f32 v6, v28, v28
  v_fmac_f32 v30, v29, v29
  v_sub_f32 v28, v40, v5
  v_sub_f32 v29, v41, v5
  v_fmac_f32 v6, v28, v28
  v_fmac_f32 v30, v29, v29
  v_sub_f32 v28, v42, v5
  v_sub_f32 v29, v43, v5
  v_fmac_f32 v6, v28, v28
  v_fmac_f32 v30, v29, v29
  v_sub_f32 v28, v44, v5
  v_sub_f32 v29, v45, v5
  v_fmac_f32 v6, v28, v28
  v_fmac_f32 v30, v29, v29
  v_sub_f32 v28, v46, v5
  v_sub_f32 v29, v47, v5
  v_fmac_f32 v6, v28, v28
  v_fmac_f32 v30, v29, v29
  v_sub_f32 v28, v48, v5
  v_sub_f32 v29, v49, v5
  v_fmac_f32 v6, v28, v28
  v_fmac_f32 v30, v29, v29
  v_sub_f32 v28, v50, v5
  v_sub_f32 v29, v51, v5
  v_fmac_f32 v6, v28, v28
  v_fmac_f32 v30, v29, v29
  v_sub_f32 v28, v52, v5
  v_sub_f32 v29, v53, v5
  v_fmac_f32 v6, v28, v28
  v_fmac_f32 v30, v29, v29
  v_sub_f32 v28, v54, v5
  v_sub_f32 v29, v55, v5
  v_fmac_f32 v6, v28, v28
  v_fmac_f32 v30, v29, v29
  v_sub_f32 v28, v56, v5
  v_sub_f32 v29, v57, v5
  v_fmac_f32 v6, v28, v28
  v_fmac_f32 v30, v29, v29
  v_sub_f32 v28, v58, v5
  v_sub_f32 v29, v59, v5
  v_fmac_f32 v6, v28, v28
  v_fmac_f32 v30, v29, v29
  v_sub_f32 v28, v60, v5
  v_sub_f32 v29, v61, v5
  v_fmac_f32 v6, v28, v28
  v_fmac_f32 v30, v29, v29
  v_sub_f32 v28, v62, v5
  v_sub_f32 v29, v63, v5
  v_fmac_f32 v6, v28, v28
  v_fmac_f32 v30, v29, v29
  v_sub_f32 v28, v64, v5
  v_sub_f32 v29, v65, v5
  v_fmac_f32 v6, v28, v28
  v_fmac_f32 v30, v29, v29
  v_sub_f32 v28, v66, v5
  v_sub_f32 v29, v67, v5
  v_fmac_f32 v6, v28, v28
  v_fmac_f32 v30, v29, v29
  v_sub_f32 v28, v68, v5
  v_sub_f32 v29, v69, v5
  v_fmac_f32 v6, v28, v28
  v_fmac_f32 v30, v29, v29
  v_sub_f32 v28, v70, v5
  v_sub_f32 v29, v71, v5
  v_fmac_f32 v6, v28, v28
  v_fmac_f32 v30, v29, v29
  v_add_f32 v6, v6, v30
  s_nop 1
  v_add_f32_dpp v6, v6, v6 row_ror:8 row_mask:0xf bank_mask:0xf
  s_nop 1
  v_add_f32_dpp v6, v6, v6 row_ror:4 row_mask:0xf bank_mask:0xf
  v_mov_b32 v7, v6
  s_nop 1
  v_permlane16_swap_b32 v6, v7
  v_add_f32 v6, v6, v7
  v_mov_b32 v7, v6
  s_nop 1
  v_permlane32_swap_b32 v6, v7
  v_add_f32 v6, v6, v7
  v_mul_f32 v6, 0x3acccccd, v6
  v_cvt_pk_bf16_f32 v7, v5, v6
  v_lshlrev_b32 v5, 16, v7
  v_and_b32 v6, s30, v7
  v_add_f32 v6, 0x3727c5ac, v6
  v_cvt_pk_bf16_f32 v6, v6, v6
  v_lshlrev_b32 v6, 16, v6
  v_sqrt_f32 v6, v6
  s_nop 0
  v_cvt_pk_bf16_f32 v6, v6, v6
  v_lshlrev_b32 v6, 16, v6
  v_rcp_f32 v6, v6
  v_sub_f32 v32, v32, v5
  v_sub_f32 v33, v33, v5
  v_cvt_pk_bf16_f32 v28, v32, v33
  v_lshlrev_b32 v32, 16, v28
  v_and_b32 v33, s30, v28
  v_mul_f32 v32, v32, v6
  v_mul_f32 v33, v33, v6
  v_cvt_pk_bf16_f32 v8, v32, v33
  v_sub_f32 v34, v34, v5
  v_sub_f32 v35, v35, v5
  v_cvt_pk_bf16_f32 v28, v34, v35
  v_lshlrev_b32 v34, 16, v28
  v_and_b32 v35, s30, v28
  v_mul_f32 v34, v34, v6
  v_mul_f32 v35, v35, v6
  v_cvt_pk_bf16_f32 v9, v34, v35
  v_sub_f32 v36, v36, v5
  v_sub_f32 v37, v37, v5
  v_cvt_pk_bf16_f32 v28, v36, v37
  v_lshlrev_b32 v36, 16, v28
  v_and_b32 v37, s30, v28
  v_mul_f32 v36, v36, v6
  v_mul_f32 v37, v37, v6
  v_cvt_pk_bf16_f32 v10, v36, v37
  v_sub_f32 v38, v38, v5
  v_sub_f32 v39, v39, v5
  v_cvt_pk_bf16_f32 v28, v38, v39
  v_lshlrev_b32 v38, 16, v28
  v_and_b32 v39, s30, v28
  v_mul_f32 v38, v38, v6
  v_mul_f32 v39, v39, v6
  v_cvt_pk_bf16_f32 v11, v38, v39
  buffer_store_dwordx4 v[8:11], v4, s[16:19], s34 offen sc1
  v_sub_f32 v40, v40, v5
  v_sub_f32 v41, v41, v5
  v_cvt_pk_bf16_f32 v28, v40, v41
  v_lshlrev_b32 v40, 16, v28
  v_and_b32 v41, s30, v28
  v_mul_f32 v40, v40, v6
  v_mul_f32 v41, v41, v6
  v_cvt_pk_bf16_f32 v12, v40, v41
  v_sub_f32 v42, v42, v5
  v_sub_f32 v43, v43, v5
  v_cvt_pk_bf16_f32 v28, v42, v43
  v_lshlrev_b32 v42, 16, v28
  v_and_b32 v43, s30, v28
  v_mul_f32 v42, v42, v6
  v_mul_f32 v43, v43, v6
  v_cvt_pk_bf16_f32 v13, v42, v43
  v_sub_f32 v44, v44, v5
  v_sub_f32 v45, v45, v5
  v_cvt_pk_bf16_f32 v28, v44, v45
  v_lshlrev_b32 v44, 16, v28
  v_and_b32 v45, s30, v28
  v_mul_f32 v44, v44, v6
  v_mul_f32 v45, v45, v6
  v_cvt_pk_bf16_f32 v14, v44, v45
  v_sub_f32 v46, v46, v5
  v_sub_f32 v47, v47, v5
  v_cvt_pk_bf16_f32 v28, v46, v47
  v_lshlrev_b32 v46, 16, v28
  v_and_b32 v47, s30, v28
  v_mul_f32 v46, v46, v6
  v_mul_f32 v47, v47, v6
  v_cvt_pk_bf16_f32 v15, v46, v47
  buffer_store_dwordx4 v[12:15], v4, s[16:19], s35 offen sc1
  v_sub_f32 v48, v48, v5
  v_sub_f32 v49, v49, v5
  v_cvt_pk_bf16_f32 v28, v48, v49
  v_lshlrev_b32 v48, 16, v28
  v_and_b32 v49, s30, v28
  v_mul_f32 v48, v48, v6
  v_mul_f32 v49, v49, v6
  v_cvt_pk_bf16_f32 v16, v48, v49
  v_sub_f32 v50, v50, v5
  v_sub_f32 v51, v51, v5
  v_cvt_pk_bf16_f32 v28, v50, v51
  v_lshlrev_b32 v50, 16, v28
  v_and_b32 v51, s30, v28
  v_mul_f32 v50, v50, v6
  v_mul_f32 v51, v51, v6
  v_cvt_pk_bf16_f32 v17, v50, v51
  v_sub_f32 v52, v52, v5
  v_sub_f32 v53, v53, v5
  v_cvt_pk_bf16_f32 v28, v52, v53
  v_lshlrev_b32 v52, 16, v28
  v_and_b32 v53, s30, v28
  v_mul_f32 v52, v52, v6
  v_mul_f32 v53, v53, v6
  v_cvt_pk_bf16_f32 v18, v52, v53
  v_sub_f32 v54, v54, v5
  v_sub_f32 v55, v55, v5
  v_cvt_pk_bf16_f32 v28, v54, v55
  v_lshlrev_b32 v54, 16, v28
  v_and_b32 v55, s30, v28
  v_mul_f32 v54, v54, v6
  v_mul_f32 v55, v55, v6
  v_cvt_pk_bf16_f32 v19, v54, v55
  buffer_store_dwordx4 v[16:19], v4, s[16:19], s36 offen sc1
  v_sub_f32 v56, v56, v5
  v_sub_f32 v57, v57, v5
  v_cvt_pk_bf16_f32 v28, v56, v57
  v_lshlrev_b32 v56, 16, v28
  v_and_b32 v57, s30, v28
  v_mul_f32 v56, v56, v6
  v_mul_f32 v57, v57, v6
  v_cvt_pk_bf16_f32 v20, v56, v57
  v_sub_f32 v58, v58, v5
  v_sub_f32 v59, v59, v5
  v_cvt_pk_bf16_f32 v28, v58, v59
  v_lshlrev_b32 v58, 16, v28
  v_and_b32 v59, s30, v28
  v_mul_f32 v58, v58, v6
  v_mul_f32 v59, v59, v6
  v_cvt_pk_bf16_f32 v21, v58, v59
  v_sub_f32 v60, v60, v5
  v_sub_f32 v61, v61, v5
  v_cvt_pk_bf16_f32 v28, v60, v61
  v_lshlrev_b32 v60, 16, v28
  v_and_b32 v61, s30, v28
  v_mul_f32 v60, v60, v6
  v_mul_f32 v61, v61, v6
  v_cvt_pk_bf16_f32 v22, v60, v61
  v_sub_f32 v62, v62, v5
  v_sub_f32 v63, v63, v5
  v_cvt_pk_bf16_f32 v28, v62, v63
  v_lshlrev_b32 v62, 16, v28
  v_and_b32 v63, s30, v28
  v_mul_f32 v62, v62, v6
  v_mul_f32 v63, v63, v6
  v_cvt_pk_bf16_f32 v23, v62, v63
  buffer_store_dwordx4 v[20:23], v4, s[16:19], s37 offen sc1
  v_sub_f32 v64, v64, v5
  v_sub_f32 v65, v65, v5
  v_cvt_pk_bf16_f32 v28, v64, v65
  v_lshlrev_b32 v64, 16, v28
  v_and_b32 v65, s30, v28
  v_mul_f32 v64, v64, v6
  v_mul_f32 v65, v65, v6
  v_cvt_pk_bf16_f32 v24, v64, v65
  v_sub_f32 v66, v66, v5
  v_sub_f32 v67, v67, v5
  v_cvt_pk_bf16_f32 v28, v66, v67
  v_lshlrev_b32 v66, 16, v28
  v_and_b32 v67, s30, v28
  v_mul_f32 v66, v66, v6
  v_mul_f32 v67, v67, v6
  v_cvt_pk_bf16_f32 v25, v66, v67
  v_sub_f32 v68, v68, v5
  v_sub_f32 v69, v69, v5
  v_cvt_pk_bf16_f32 v28, v68, v69
  v_lshlrev_b32 v68, 16, v28
  v_and_b32 v69, s30, v28
  v_mul_f32 v68, v68, v6
  v_mul_f32 v69, v69, v6
  v_cvt_pk_bf16_f32 v26, v68, v69
  v_sub_f32 v70, v70, v5
  v_sub_f32 v71, v71, v5
  v_cvt_pk_bf16_f32 v28, v70, v71
  v_lshlrev_b32 v70, 16, v28
  v_and_b32 v71, s30, v28
  v_mul_f32 v70, v70, v6
  v_mul_f32 v71, v71, v6
  v_cvt_pk_bf16_f32 v27, v70, v71
  buffer_store_dwordx4 v[24:27], v4, s[16:19], s38 offen sc1
  s_waitcnt vmcnt(0)
  s_barrier
  s_cmp_lg_u32 s20, 0
  s_cbranch_scc1 K1_BULK
  v_readfirstlane_b32 s96, v252
  v_readfirstlane_b32 s97, v253
  s_nop 0
  s_cmp_eq_u64 s[96:97], 0
  s_cselect_b64 s[96:97], s[98:99], s[96:97]
  v_lshlrev_b32 v1, 8, v0
  v_mov_b32 v2, s96
  v_mov_b32 v3, s97
  s_mov_b64 exec, 0xffffffff
  buffer_store_dwordx2 v[2:3], v1, s[16:19], s39 offen sc1
  s_mov_b64 exec, -1
  s_branch K1_BULK
K1_NONE:
  s_memrealtime s[98:99]
  s_cmp_eq_u32 s20, 0
  s_cselect_b32 s96, 0, 0x1000
  v_mov_b32 v249, s96
  v_mov_b32 v254, 0
  v_mov_b32 v255, 0
  s_waitcnt lgkmcnt(0)
  v_mov_b32 v252, s98
  v_mov_b32 v253, s99
  s_mov_b64 exec, 1
  buffer_atomic_cmpswap_x2 v[252:255], v249, s[52:55], 0 offen sc0 sc1
  s_mov_b64 exec, -1
  v_bfe_u32 v60, v0, 4, 2
  v_and_b32 v61, 15, v0
  v_lshlrev_b32 v61, 4, v61
  v_lshl_add_u32 v250, v60, 13, v61
  s_lshl_b32 s32, s20, 16
  s_lshl_b32 s33, s21, 8
  s_add_u32 s32, s32, s33
  v_add_u32 v250, s32, v250
  v_add_u32 v251, 32768, v250
  s_sleep 64
  s_mov_b32 s28, 0
  buffer_load_dwordx4 v[192:195], v250, s[4:7], s28 offen
  buffer_load_dwordx4 v[196:199], v251, s[4:7], s28 offen
  s_mov_b32 s28, 524288
  buffer_load_dwordx4 v[200:203], v250, s[4:7], s28 offen
  buffer_load_dwordx4 v[204:207], v251, s[4:7], s28 offen
  s_mov_b32 s28, 1048576
  buffer_load_dwordx4 v[208:211], v250, s[4:7], s28 offen
  buffer_load_dwordx4 v[212:215], v251, s[4:7], s28 offen
  s_mov_b32 s28, 1572864
  buffer_load_dwordx4 v[216:219], v250, s[4:7], s28 offen
  buffer_load_dwordx4 v[220:223], v251, s[4:7], s28 offen
  s_waitcnt vmcnt(8)
  v_readfirstlane_b32 s96, v252
  v_readfirstlane_b32 s97, v253
  s_nop 0
  s_cmp_eq_u64 s[96:97], 0
  s_cselect_b64 s[96:97], s[98:99], s[96:97]
  s_branch K1_BULK2
K1_BULK:
  s_mov_b32 s28, 0
  buffer_load_dwordx4 v[192:195], v250, s[4:7], s28 offen
  buffer_load_dwordx4 v[196:199], v251, s[4:7], s28 offen
  s_mov_b32 s28, 524288
  buffer_load_dwordx4 v[200:203], v250, s[4:7], s28 offen
  buffer_load_dwordx4 v[204:207], v251, s[4:7], s28 offen
  s_mov_b32 s28, 1048576
  buffer_load_dwordx4 v[208:211], v250, s[4:7], s28 offen
  buffer_load_dwordx4 v[212:215], v251, s[4:7], s28 offen
  s_mov_b32 s28, 1572864
  buffer_load_dwordx4 v[216:219], v250, s[4:7], s28 offen
  buffer_load_dwordx4 v[220:223], v251, s[4:7], s28 offen
K1_BULK2:
  s_cmp_ge_u32 s2, 182
  s_cbranch_scc1 K1_W1
  s_cmp_ge_u32 s2, 128
  s_cbranch_scc1 K1_W2
  s_load_dwordx2 s[56:57], s[0:1], 32
  s_mov_b32 s58, 5242880
  s_mov_b32 s59, 0x00020000
  s_mul_i32 s40, s2, 40960
  s_mul_i32 s42, s2, 5120
  s_mul_i32 s46, s20, 655360
  s_add_u32 s42, s42, 41943040
  s_branch K1_P5
K1_W2:
  s_waitcnt lgkmcnt(0)
  s_load_dwordx2 s[56:57], s[0:1], 64
  s_mov_b32 s58, 2211840
  s_mov_b32 s59, 0x00020000
  s_sub_u32 s47, s2, 128
  s_mul_i32 s40, s47, 40960
  s_mul_i32 s42, s47, 5120
  s_mul_i32 s46, s20, 276480
  s_add_u32 s42, s42, 48234496
K1_P5:
  s_add_u32 s42, s42, s46
  s_mov_b32 s41, -64
  s_mul_i32 s43, s20, 160
  s_mov_b32 s44, 0
  s_mov_b32 s45, 8
  s_branch K1_DMA
K1_W1:
  s_waitcnt lgkmcnt(0)
  s_load_dwordx2 s[56:57], s[0:1], 48
  s_mov_b32 s58, 2211840
  s_mov_b32 s59, 0x00020000
  s_sub_u32 s47, s2, 182
  s_mov_b32 s24, 0
  s_mov_b32 s45, 6
  s_cmp_ge_u32 s47, 20
  s_cselect_b32 s24, 6, s24
  s_cselect_b32 s45, 5, s45
  s_cselect_b32 s25, 20, 0
  s_cmp_ge_u32 s47, 40
  s_cselect_b32 s24, 11, s24
  s_cselect_b32 s25, 40, s25
  s_sub_u32 s47, s47, s25
  s_mul_i32 s40, s47, 110592
  s_mul_i32 s25, s24, 224
  s_add_u32 s40, s40, s25
  s_add_u32 s24, s24, s20
  s_mul_i32 s42, s24, 20
  s_add_u32 s42, s42, s47
  s_mul_i32 s42, s42, 7168
  s_add_u32 s42, s42, 51380224
  s_mov_b32 s41, 2112
  s_mul_i32 s43, s20, 224
  s_mov_b32 s44, 1
K1_DMA:
  s_add_u32 s47, s42, 4096
  s_add_u32 s43, s43, 98304
  s_lshl_b32 s46, s20, 10
  s_add_u32 s46, s46, 98304
  s_lshl_b32 s32, s22, 3
  s_add_u32 s32, s32, s20
  s_mul_i32 s24, s32, 40960
  s_add_u32 s24, s24, 4194304
  s_lshl_b32 s25, s21, 19
  s_add_u32 s25, s25, 393216
  s_lshl_b32 s26, s32, 18
  s_lshl_b32 s33, s21, 13
  s_add_u32 s26, s26, s33
  s_add_u32 s26, s26, 16777216
  s_add_u32 s31, s26, 4096
  s_mov_b32 s27, 0
  s_mov_b32 s30, 0x3e0293ee
  s_mov_b64 s[34:35], 0
  s_nop 1
  v_mov_b32 v17, v250
  v_mov_b32 v18, v251
  v_and_b32 v224, 63, v0
  v_lshrrev_b32 v225, 4, v224
  v_bfe_u32 v226, v0, 2, 2
  v_and_b32 v227, 3, v0
  v_lshlrev_b32 v22, 4, v224
  v_xor_b32 v228, v226, v225
  v_lshlrev_b32 v228, 6, v228
  v_lshl_add_u32 v228, v227, 4, v228
  v_lshl_add_u32 v19, v225, 8, v228
  v_add_u32 v19, s23, v19
  s_and_b32 s32, s20, 1
  s_lshl_b32 s32, s32, 3
  v_add_u32 v228, s32, v225
  v_and_b32 v229, 15, v0
  v_xor_b32 v228, v228, v229
  v_lshlrev_b32 v20, 8, v225
  v_add_u32 v20, s23, v20
  v_xor_b32 v229, 4, v228
  v_lshl_add_u32 v21, v229, 4, v20
  v_lshl_add_u32 v20, v228, 4, v20
  v_lshrrev_b32 v228, 1, v225
  v_lshl_add_u32 v228, v228, 3, v226
  v_lshlrev_b32 v228, 8, v228
  v_and_b32 v229, 1, v225
  v_lshl_add_u32 v228, v229, 5, v228
  v_and_b32 v229, 1, v227
  v_lshl_add_u32 v228, v229, 4, v228
  v_lshrrev_b32 v229, 1, v227
  v_lshl_add_u32 v228, v229, 3, v228
  v_xor_b32 v229, 0, v226
  v_lshl_add_u32 v1, v229, 6, v228
  v_add_u32 v5, 0x10000, v1
  v_xor_b32 v229, 1, v226
  v_lshl_add_u32 v2, v229, 6, v228
  v_add_u32 v6, 0x10000, v2
  v_xor_b32 v229, 2, v226
  v_lshl_add_u32 v3, v229, 6, v228
  v_add_u32 v7, 0x10000, v3
  v_xor_b32 v229, 3, v226
  v_lshl_add_u32 v4, v229, 6, v228
  v_add_u32 v8, 0x10000, v4
  v_and_b32 v228, 19, v0
  v_bfe_u32 v229, v0, 2, 1
  v_lshl_add_u32 v228, v229, 3, v228
  v_bfe_u32 v229, v0, 3, 1
  v_lshl_add_u32 v228, v229, 2, v228
  v_and_b32 v229, 15, v228
  v_lshrrev_b32 v225, 5, v224
  v_xor_b32 v229, v229, v225
  v_lshlrev_b32 v229, 4, v229
  v_lshl_add_u32 v228, v228, 8, v229
  v_add_u32 v228, 0x10000, v228
  v_xor_b32 v9, 0, v228
  v_xor_b32 v10, 32, v228
  v_xor_b32 v11, 64, v228
  v_xor_b32 v12, 96, v228
  v_xor_b32 v13, 128, v228
  v_xor_b32 v14, 160, v228
  v_xor_b32 v15, 192, v228
  v_xor_b32 v16, 224, v228
  v_bfe_u32 v225, v0, 4, 2
  s_lshl_b32 s32, s20, 5
  s_add_u32 s32, s32, 147712
  v_lshl_add_u32 v126, v225, 2, s32
  v_min_u32 v96, 11, v224
  s_mul_i32 s32, s20, 12
  v_add_u32 v96, s32, v96
  v_lshrrev_b32 v97, 1, v96
  v_and_b32 v96, 1, v96
  v_lshlrev_b32 v97, 13, v97
  v_lshl_add_u32 v96, v96, 7, v97
  s_mul_i32 s32, s22, 393216
  s_lshl_b32 s33, s21, 8
  s_add_u32 s32, s32, s33
  s_add_u32 s32, s32, 2097152
  buffer_load_dword v30, v96, s[4:7], s32 offen
  v_mov_b32 v228, 147520
  v_mov_b32 v230, s96
  v_mov_b32 v231, s97
  s_cmp_lg_u32 s20, 0
  s_cbranch_scc1 K1_T1
  ds_write_b64 v228, v[230:231]
K1_T1:
  s_waitcnt lgkmcnt(0)
  s_barrier
  ds_read_b64 v[230:231], v228
  s_lshl_b32 s32, s2, 8
  s_lshl_b32 s33, s20, 3
  s_add_u32 s32, s32, s33
  s_add_u32 s32, s32, 55574528
  v_mov_b32 v229, 0
  v_min_u32 v96, 39, v224
  v_lshlrev_b32 v96, 4, v96
  s_mul_i32 s33, s20, 640
  v_add_u32 v96, s33, v96
  v_add_u32 v97, 147712, v96
  s_and_b32 s33, s2, 31
  s_lshl_b32 s33, s33, 13
  s_add_u32 s33, s33, 54525952
  s_mov_b32 s37, 0xffff0000
  s_waitcnt lgkmcnt(0)
  v_readfirstlane_b32 s96, v230
  v_readfirstlane_b32 s97, v231
  s_nop 4
  s_mov_b32 s60, 200000
  s_nop 0
K1_PH_L:
  buffer_load_dwordx2 v[230:231], v229, s[16:19], s32 offen sc1
  s_waitcnt vmcnt(0)
  v_cmp_ne_u64 vcc, s[96:97], v[230:231]
  s_nop 0
  s_cmp_eq_u64 vcc, 0
  s_cbranch_scc1 K1_PH_A
  s_sub_u32 s60, s60, 1
  s_cbranch_scc1 K1_PH_A
  s_sleep 2
  s_branch K1_PH_L
K1_PH_A:
  s_add_u32 s29, s24, 0
  buffer_load_dwordx4 v[32:35], v22, s[16:19], s29 offen offset:0
  buffer_load_dwordx4 v[36:39], v22, s[16:19], s29 offen offset:1024
  buffer_load_dwordx4 v[40:43], v22, s[16:19], s29 offen offset:2048
  buffer_load_dwordx4 v[44:47], v22, s[16:19], s29 offen offset:3072
  s_mov_b32 s60, 200000
  s_nop 0
K1_PM_L:
  buffer_load_dwordx4 v[160:163], v96, s[16:19], s33 offen sc1
  s_waitcnt vmcnt(0)
  v_cmp_ne_u64 vcc, s[96:97], v[162:163]
  s_nop 0
  s_cmp_eq_u64 vcc, 0
  s_cbranch_scc1 K1_PM_A
  s_sub_u32 s60, s60, 1
  s_cbranch_scc1 K1_PM_A
  s_sleep 2
  s_branch K1_PM_L
K1_PM_A:
  s_add_u32 s29, s24, 4096
  buffer_load_dwordx4 v[48:51], v22, s[16:19], s29 offen offset:0
  buffer_load_dwordx4 v[52:55], v22, s[16:19], s29 offen offset:1024
  buffer_load_dwordx4 v[56:59], v22, s[16:19], s29 offen offset:2048
  buffer_load_dwordx4 v[60:63], v22, s[16:19], s29 offen offset:3072
  s_add_u32 s29, s24, 8192
  buffer_load_dwordx4 v[64:67], v22, s[16:19], s29 offen offset:0
  buffer_load_dwordx4 v[68:71], v22, s[16:19], s29 offen offset:1024
  buffer_load_dwordx4 v[72:75], v22, s[16:19], s29 offen offset:2048
  buffer_load_dwordx4 v[76:79], v22, s[16:19], s29 offen offset:3072
  s_add_u32 s29, s24, 12288
  buffer_load_dwordx4 v[80:83], v22, s[16:19], s29 offen offset:0
  buffer_load_dwordx4 v[84:87], v22, s[16:19], s29 offen offset:1024
  buffer_load_dwordx4 v[88:91], v22, s[16:19], s29 offen offset:2048
  buffer_load_dwordx4 v[92:95], v22, s[16:19], s29 offen offset:3072
  v_lshlrev_b32 v164, 16, v160
  v_and_b32 v165, s37, v160
  v_lshlrev_b32 v166, 16, v161
  v_and_b32 v167, s37, v161
  ds_write_b128 v97, v[164:167]
  s_waitcnt lgkmcnt(0)
  s_barrier
  s_branch K2_START2
K2_START:
  v_bfe_u32 v225, v0, 4, 2
  s_lshl_b32 s32, s20, 5
  s_add_u32 s32, s32, 147712
  v_lshl_add_u32 v126, v225, 2, s32
  s_mov_b32 s45, 0
  s_mov_b32 s28, 0
  buffer_load_dwordx4 v[192:195], v17, s[4:7], s28 offen
  buffer_load_dwordx4 v[196:199], v18, s[4:7], s28 offen
  s_mov_b32 s28, 524288
  buffer_load_dwordx4 v[200:203], v17, s[4:7], s28 offen
  buffer_load_dwordx4 v[204:207], v18, s[4:7], s28 offen
  s_mov_b32 s28, 1048576
  buffer_load_dwordx4 v[208:211], v17, s[4:7], s28 offen
  buffer_load_dwordx4 v[212:215], v18, s[4:7], s28 offen
  s_mov_b32 s28, 1572864
  buffer_load_dwordx4 v[216:219], v17, s[4:7], s28 offen
  buffer_load_dwordx4 v[220:223], v18, s[4:7], s28 offen
  s_barrier
  s_add_u32 s29, s24, 0
  buffer_load_dwordx4 v[32:35], v22, s[16:19], s29 offen offset:0
  buffer_load_dwordx4 v[36:39], v22, s[16:19], s29 offen offset:1024
  buffer_load_dwordx4 v[40:43], v22, s[16:19], s29 offen offset:2048
  buffer_load_dwordx4 v[44:47], v22, s[16:19], s29 offen offset:3072
  s_add_u32 s29, s24, 4096
  buffer_load_dwordx4 v[48:51], v22, s[16:19], s29 offen offset:0
  buffer_load_dwordx4 v[52:55], v22, s[16:19], s29 offen offset:1024
  buffer_load_dwordx4 v[56:59], v22, s[16:19], s29 offen offset:2048
  buffer_load_dwordx4 v[60:63], v22, s[16:19], s29 offen offset:3072
  s_add_u32 s29, s24, 8192
  buffer_load_dwordx4 v[64:67], v22, s[16:19], s29 offen offset:0
  buffer_load_dwordx4 v[68:71], v22, s[16:19], s29 offen offset:1024
  buffer_load_dwordx4 v[72:75], v22, s[16:19], s29 offen offset:2048
  buffer_load_dwordx4 v[76:79], v22, s[16:19], s29 offen offset:3072
  s_add_u32 s29, s24, 12288
  buffer_load_dwordx4 v[80:83], v22, s[16:19], s29 offen offset:0
  buffer_load_dwordx4 v[84:87], v22, s[16:19], s29 offen offset:1024
  buffer_load_dwordx4 v[88:91], v22, s[16:19], s29 offen offset:2048
  buffer_load_dwordx4 v[92:95], v22, s[16:19], s29 offen offset:3072
K2_START2:
  s_mov_b32 s37, 0xffff0000
  v_mov_b32 v23, 0
  v_mov_b32 v24, 0
  s_cmp_lg_u32 s27, 0
  s_cbranch_scc1 K2_NOINIT
  v_mov_b32 v25, 0xff800000
K2_NOINIT:
  v_mov_b32 v26, 0xff800000
  s_mov_b32 s36, 0x71800000
  ds_read_b32 v120, v126 offset:2560
  ds_read_b32 v121, v126 offset:2576
  ds_read_b32 v122, v126 offset:0
  ds_read_b32 v123, v126 offset:16
  s_waitcnt vmcnt(23)
  v_lshlrev_b32 v104, 16, v192
  v_and_b32 v105, s37, v192
  s_waitcnt lgkmcnt(0)
  v_pk_mul_f32 v[112:113], v[104:105], v[122:123] op_sel:[0,0] op_sel_hi:[1,0]
  v_pk_mul_f32 v[104:105], v[104:105], v[120:121] op_sel:[0,0] op_sel_hi:[1,0]
  v_cvt_pk_bf16_f32 v96, v104, v105
  v_lshlrev_b32 v106, 16, v193
  v_and_b32 v107, s37, v193
  v_pk_mul_f32 v[114:115], v[106:107], v[122:123] op_sel:[0,0] op_sel_hi:[1,0]
  v_pk_mul_f32 v[106:107], v[106:107], v[120:121] op_sel:[0,0] op_sel_hi:[1,0]
  v_cvt_pk_bf16_f32 v97, v106, v107
  v_lshlrev_b32 v108, 16, v194
  v_and_b32 v109, s37, v194
  v_pk_mul_f32 v[116:117], v[108:109], v[122:123] op_sel:[0,0] op_sel_hi:[1,0]
  v_pk_mul_f32 v[108:109], v[108:109], v[120:121] op_sel:[0,0] op_sel_hi:[1,0]
  v_cvt_pk_bf16_f32 v98, v108, v109
  v_lshlrev_b32 v110, 16, v195
  v_and_b32 v111, s37, v195
  v_pk_mul_f32 v[118:119], v[110:111], v[122:123] op_sel:[0,0] op_sel_hi:[1,0]
  v_pk_mul_f32 v[110:111], v[110:111], v[120:121] op_sel:[0,0] op_sel_hi:[1,0]
  v_cvt_pk_bf16_f32 v99, v110, v111
  ds_write_b128 v19, v[96:99] offset:16384
  s_mov_b32 s28, 2097152
  buffer_load_dwordx4 v[192:195], v17, s[4:7], s28 offen
  s_waitcnt vmcnt(23)
  v_lshlrev_b32 v104, 16, v196
  v_and_b32 v105, s37, v196
  v_pk_fma_f32 v[112:113], v[104:105], v[122:123], v[112:113] op_sel:[0,1,0] op_sel_hi:[1,1,1]
  v_pk_mul_f32 v[104:105], v[104:105], v[120:121] op_sel:[0,1] op_sel_hi:[1,1]
  v_cvt_pk_bf16_f32 v100, v104, v105
  v_lshlrev_b32 v106, 16, v197
  v_and_b32 v107, s37, v197
  v_pk_fma_f32 v[114:115], v[106:107], v[122:123], v[114:115] op_sel:[0,1,0] op_sel_hi:[1,1,1]
  v_pk_mul_f32 v[106:107], v[106:107], v[120:121] op_sel:[0,1] op_sel_hi:[1,1]
  v_cvt_pk_bf16_f32 v101, v106, v107
  v_lshlrev_b32 v108, 16, v198
  v_and_b32 v109, s37, v198
  v_pk_fma_f32 v[116:117], v[108:109], v[122:123], v[116:117] op_sel:[0,1,0] op_sel_hi:[1,1,1]
  v_pk_mul_f32 v[108:109], v[108:109], v[120:121] op_sel:[0,1] op_sel_hi:[1,1]
  v_cvt_pk_bf16_f32 v102, v108, v109
  v_lshlrev_b32 v110, 16, v199
  v_and_b32 v111, s37, v199
  v_pk_fma_f32 v[118:119], v[110:111], v[122:123], v[118:119] op_sel:[0,1,0] op_sel_hi:[1,1,1]
  v_pk_mul_f32 v[110:111], v[110:111], v[120:121] op_sel:[0,1] op_sel_hi:[1,1]
  v_cvt_pk_bf16_f32 v103, v110, v111
  ds_write_b128 v19, v[100:103] offset:17408
  s_mov_b32 s28, 2097152
  buffer_load_dwordx4 v[196:199], v18, s[4:7], s28 offen
  s_waitcnt lgkmcnt(0)
  s_barrier
  ds_read_b64_tr_b16 v[224:225], v1 offset:16384
  ds_read_b64_tr_b16 v[226:227], v1 offset:17408
  ds_read_b64_tr_b16 v[228:229], v2 offset:16384
  ds_read_b64_tr_b16 v[230:231], v2 offset:17408
  ds_read_b64_tr_b16 v[232:233], v3 offset:16384
  ds_read_b64_tr_b16 v[234:235], v3 offset:17408
  ds_read_b64_tr_b16 v[236:237], v4 offset:16384
  ds_read_b64_tr_b16 v[238:239], v4 offset:17408
  ds_read_b64_tr_b16 v[240:241], v1 offset:20480
  ds_read_b64_tr_b16 v[242:243], v1 offset:21504
  ds_read_b64_tr_b16 v[244:245], v2 offset:20480
  ds_read_b64_tr_b16 v[246:247], v2 offset:21504
  s_waitcnt vmcnt(17) lgkmcnt(10)
  v_mfma_f32_32x32x16_bf16 v[128:143], v[224:227], v[32:35], 0
  ds_read_b64_tr_b16 v[248:249], v3 offset:20480
  ds_read_b64_tr_b16 v[250:251], v3 offset:21504
  ds_read_b32 v120, v126 offset:2816
  ds_read_b32 v121, v126 offset:2832
  ds_read_b32 v122, v126 offset:256
  ds_read_b32 v123, v126 offset:272
  s_waitcnt lgkmcnt(14)
  v_mfma_f32_32x32x16_bf16 v[144:159], v[228:231], v[32:35], 0
  ds_read_b64_tr_b16 v[252:253], v4 offset:20480
  ds_read_b64_tr_b16 v[254:255], v4 offset:21504
  s_waitcnt lgkmcnt(14)
  v_mfma_f32_32x32x16_bf16 v[160:175], v[232:235], v[32:35], 0
  ds_read_b64_tr_b16 v[224:225], v1 offset:24576
  ds_read_b64_tr_b16 v[226:227], v1 offset:25600
  v_lshlrev_b32 v104, 16, v200
  v_and_b32 v105, s37, v200
  s_waitcnt lgkmcnt(4)
  v_pk_fma_f32 v[112:113], v[104:105], v[122:123], v[112:113] op_sel:[0,0,0] op_sel_hi:[1,0,1]
  v_pk_mul_f32 v[104:105], v[104:105], v[120:121] op_sel:[0,0] op_sel_hi:[1,0]
  v_cvt_pk_bf16_f32 v96, v104, v105
  v_mfma_f32_32x32x16_bf16 v[176:191], v[236:239], v[32:35], 0
  ds_read_b64_tr_b16 v[228:229], v2 offset:24576
  ds_read_b64_tr_b16 v[230:231], v2 offset:25600
  s_add_u32 s29, s24, 16384
  buffer_load_dwordx4 v[32:35], v22, s[16:19], s29 offen offset:0
  v_lshlrev_b32 v106, 16, v201
  v_and_b32 v107, s37, v201
  v_pk_fma_f32 v[114:115], v[106:107], v[122:123], v[114:115] op_sel:[0,0,0] op_sel_hi:[1,0,1]
  v_pk_mul_f32 v[106:107], v[106:107], v[120:121] op_sel:[0,0] op_sel_hi:[1,0]
  s_waitcnt vmcnt(17)
  v_mfma_f32_32x32x16_bf16 v[128:143], v[240:243], v[36:39], v[128:143]
  ds_read_b64_tr_b16 v[232:233], v3 offset:24576
  ds_read_b64_tr_b16 v[234:235], v3 offset:25600
  v_cvt_pk_bf16_f32 v97, v106, v107
  v_lshlrev_b32 v108, 16, v202
  v_and_b32 v109, s37, v202
  v_pk_fma_f32 v[116:117], v[108:109], v[122:123], v[116:117] op_sel:[0,0,0] op_sel_hi:[1,0,1]
  v_pk_mul_f32 v[108:109], v[108:109], v[120:121] op_sel:[0,0] op_sel_hi:[1,0]
  v_mfma_f32_32x32x16_bf16 v[144:159], v[244:247], v[36:39], v[144:159]
  ds_read_b64_tr_b16 v[236:237], v4 offset:24576
  ds_read_b64_tr_b16 v[238:239], v4 offset:25600
  v_cvt_pk_bf16_f32 v98, v108, v109
  v_lshlrev_b32 v110, 16, v203
  v_and_b32 v111, s37, v203
  v_pk_fma_f32 v[118:119], v[110:111], v[122:123], v[118:119] op_sel:[0,0,0] op_sel_hi:[1,0,1]
  v_pk_mul_f32 v[110:111], v[110:111], v[120:121] op_sel:[0,0] op_sel_hi:[1,0]
  v_mfma_f32_32x32x16_bf16 v[160:175], v[248:251], v[36:39], v[160:175]
  ds_read_b64_tr_b16 v[240:241], v1 offset:28672
  ds_read_b64_tr_b16 v[242:243], v1 offset:29696
  v_cvt_pk_bf16_f32 v99, v110, v111
  ds_write_b128 v19, v[96:99] offset:32768
  s_mov_b32 s28, 2621440
  buffer_load_dwordx4 v[200:203], v17, s[4:7], s28 offen
  v_lshlrev_b32 v104, 16, v204
  v_and_b32 v105, s37, v204
  s_waitcnt lgkmcnt(11)
  v_mfma_f32_32x32x16_bf16 v[176:191], v[252:255], v[36:39], v[176:191]
  ds_read_b64_tr_b16 v[244:245], v2 offset:28672
  ds_read_b64_tr_b16 v[246:247], v2 offset:29696
  buffer_load_dwordx4 v[36:39], v22, s[16:19], s29 offen offset:1024
  v_pk_fma_f32 v[112:113], v[104:105], v[122:123], v[112:113] op_sel:[0,1,0] op_sel_hi:[1,1,1]
  v_pk_mul_f32 v[104:105], v[104:105], v[120:121] op_sel:[0,1] op_sel_hi:[1,1]
  v_cvt_pk_bf16_f32 v100, v104, v105
  v_lshlrev_b32 v106, 16, v205
  s_waitcnt vmcnt(18) lgkmcnt(11)
  v_mfma_f32_32x32x16_bf16 v[128:143], v[224:227], v[40:43], v[128:143]
  ds_read_b64_tr_b16 v[248:249], v3 offset:28672
  ds_read_b64_tr_b16 v[250:251], v3 offset:29696
  v_and_b32 v107, s37, v205
  v_pk_fma_f32 v[114:115], v[106:107], v[122:123], v[114:115] op_sel:[0,1,0] op_sel_hi:[1,1,1]
  v_pk_mul_f32 v[106:107], v[106:107], v[120:121] op_sel:[0,1] op_sel_hi:[1,1]
  v_cvt_pk_bf16_f32 v101, v106, v107
  v_lshlrev_b32 v108, 16, v206
  s_waitcnt lgkmcnt(11)
  v_mfma_f32_32x32x16_bf16 v[144:159], v[228:231], v[40:43], v[144:159]
  ds_read_b64_tr_b16 v[252:253], v4 offset:28672
  ds_read_b64_tr_b16 v[254:255], v4 offset:29696
  v_and_b32 v109, s37, v206
  v_pk_fma_f32 v[116:117], v[108:109], v[122:123], v[116:117] op_sel:[0,1,0] op_sel_hi:[1,1,1]
  v_pk_mul_f32 v[108:109], v[108:109], v[120:121] op_sel:[0,1] op_sel_hi:[1,1]
  v_cvt_pk_bf16_f32 v102, v108, v109
  v_lshlrev_b32 v110, 16, v207
  v_and_b32 v111, s37, v207
  v_pk_fma_f32 v[118:119], v[110:111], v[122:123], v[118:119] op_sel:[0,1,0] op_sel_hi:[1,1,1]
  v_pk_mul_f32 v[110:111], v[110:111], v[120:121] op_sel:[0,1] op_sel_hi:[1,1]
  v_cvt_pk_bf16_f32 v103, v110, v111
  ds_write_b128 v19, v[100:103] offset:33792
  s_mov_b32 s28, 2621440
  buffer_load_dwordx4 v[204:207], v18, s[4:7], s28 offen
  s_waitcnt lgkmcnt(12)
  v_mfma_f32_32x32x16_bf16 v[160:175], v[232:235], v[40:43], v[160:175]
  s_waitcnt lgkmcnt(0)
  s_barrier
  ds_read_b64_tr_b16 v[224:225], v1 offset:32768
  ds_read_b64_tr_b16 v[226:227], v1 offset:33792
  v_mfma_f32_32x32x16_bf16 v[176:191], v[236:239], v[40:43], v[176:191]
  ds_read_b64_tr_b16 v[228:229], v2 offset:32768
  ds_read_b64_tr_b16 v[230:231], v2 offset:33792
  v_add_u32 v29, 0, v0
  v_min_u32 v29, 2687, v29
  v_mul_u32_u24 v31, 3121, v29
  v_lshrrev_b32 v31, 18, v31
  v_lshlrev_b32 v29, 4, v29
  v_mad_i32_i24 v30, v31, s41, v29
  v_add_u32 v30, s40, v30
  buffer_load_dwordx4 v[40:43], v22, s[16:19], s29 offen offset:2048
  s_waitcnt vmcnt(19)
  v_mfma_f32_32x32x16_bf16 v[128:143], v[240:243], v[44:47], v[128:143]
  ds_read_b64_tr_b16 v[232:233], v3 offset:32768
  ds_read_b64_tr_b16 v[234:235], v3 offset:33792
  ds_read_b32 v120, v126 offset:3072
  ds_read_b32 v121, v126 offset:3088
  ds_read_b32 v122, v126 offset:512
  ds_read_b32 v123, v126 offset:528
  v_mfma_f32_32x32x16_bf16 v[144:159], v[244:247], v[44:47], v[144:159]
  ds_read_b64_tr_b16 v[236:237], v4 offset:32768
  ds_read_b64_tr_b16 v[238:239], v4 offset:33792
  s_add_u32 m0, s46, 0
  s_nop 0
  buffer_load_dwordx4 v30, s[56:59], 0 offen lds
  v_lshlrev_b32 v104, 16, v208
  v_and_b32 v105, s37, v208
  s_waitcnt lgkmcnt(2)
  v_pk_fma_f32 v[112:113], v[104:105], v[122:123], v[112:113] op_sel:[0,0,0] op_sel_hi:[1,0,1]
  v_mfma_f32_32x32x16_bf16 v[160:175], v[248:251], v[44:47], v[160:175]
  ds_read_b64_tr_b16 v[240:241], v1 offset:36864
  ds_read_b64_tr_b16 v[242:243], v1 offset:37888
  v_pk_mul_f32 v[104:105], v[104:105], v[120:121] op_sel:[0,0] op_sel_hi:[1,0]
  v_cvt_pk_bf16_f32 v96, v104, v105
  v_lshlrev_b32 v106, 16, v209
  v_and_b32 v107, s37, v209
  v_pk_fma_f32 v[114:115], v[106:107], v[122:123], v[114:115] op_sel:[0,0,0] op_sel_hi:[1,0,1]
  v_mfma_f32_32x32x16_bf16 v[176:191], v[252:255], v[44:47], v[176:191]
  ds_read_b64_tr_b16 v[244:245], v2 offset:36864
  ds_read_b64_tr_b16 v[246:247], v2 offset:37888
  v_add_u32 v29, 512, v0
  v_min_u32 v29, 2687, v29
  v_mul_u32_u24 v31, 3121, v29
  v_lshrrev_b32 v31, 18, v31
  v_lshlrev_b32 v29, 4, v29
  v_mad_i32_i24 v30, v31, s41, v29
  v_add_u32 v30, s40, v30
  buffer_load_dwordx4 v[44:47], v22, s[16:19], s29 offen offset:3072
  s_waitcnt vmcnt(20)
  v_mfma_f32_32x32x16_bf16 v[128:143], v[224:227], v[48:51], v[128:143]
  ds_read_b64_tr_b16 v[248:249], v3 offset:36864
  ds_read_b64_tr_b16 v[250:251], v3 offset:37888
  v_pk_mul_f32 v[106:107], v[106:107], v[120:121] op_sel:[0,0] op_sel_hi:[1,0]
  v_cvt_pk_bf16_f32 v97, v106, v107
  v_lshlrev_b32 v108, 16, v210
  v_and_b32 v109, s37, v210
  v_pk_fma_f32 v[116:117], v[108:109], v[122:123], v[116:117] op_sel:[0,0,0] op_sel_hi:[1,0,1]
  v_mfma_f32_32x32x16_bf16 v[144:159], v[228:231], v[48:51], v[144:159]
  ds_read_b64_tr_b16 v[252:253], v4 offset:36864
  ds_read_b64_tr_b16 v[254:255], v4 offset:37888
  s_add_u32 m0, s46, 8192
  s_nop 0
  buffer_load_dwordx4 v30, s[56:59], 0 offen lds
  v_pk_mul_f32 v[108:109], v[108:109], v[120:121] op_sel:[0,0] op_sel_hi:[1,0]
  v_cvt_pk_bf16_f32 v98, v108, v109
  v_lshlrev_b32 v110, 16, v211
  v_mfma_f32_32x32x16_bf16 v[160:175], v[232:235], v[48:51], v[160:175]
  ds_read_b64_tr_b16 v[224:225], v1 offset:40960
  ds_read_b64_tr_b16 v[226:227], v1 offset:41984
  v_and_b32 v111, s37, v211
  v_pk_fma_f32 v[118:119], v[110:111], v[122:123], v[118:119] op_sel:[0,0,0] op_sel_hi:[1,0,1]
  v_pk_mul_f32 v[110:111], v[110:111], v[120:121] op_sel:[0,0] op_sel_hi:[1,0]
  v_cvt_pk_bf16_f32 v99, v110, v111
  ds_write_b128 v19, v[96:99] offset:49152
  s_waitcnt lgkmcnt(11)
  v_mfma_f32_32x32x16_bf16 v[176:191], v[236:239], v[48:51], v[176:191]
  ds_read_b64_tr_b16 v[228:229], v2 offset:40960
  ds_read_b64_tr_b16 v[230:231], v2 offset:41984
  s_add_u32 s29, s24, 20480
  buffer_load_dwordx4 v[48:51], v22, s[16:19], s29 offen offset:0
  s_mov_b32 s28, 3145728
  buffer_load_dwordx4 v[208:211], v17, s[4:7], s28 offen
  v_lshlrev_b32 v104, 16, v212
  v_and_b32 v105, s37, v212
  v_pk_fma_f32 v[112:113], v[104:105], v[122:123], v[112:113] op_sel:[0,1,0] op_sel_hi:[1,1,1]
  s_waitcnt vmcnt(22) lgkmcnt(11)
  v_mfma_f32_32x32x16_bf16 v[128:143], v[240:243], v[52:55], v[128:143]
  ds_read_b64_tr_b16 v[232:233], v3 offset:40960
  ds_read_b64_tr_b16 v[234:235], v3 offset:41984
  v_pk_mul_f32 v[104:105], v[104:105], v[120:121] op_sel:[0,1] op_sel_hi:[1,1]
  v_cvt_pk_bf16_f32 v100, v104, v105
  v_lshlrev_b32 v106, 16, v213
  v_and_b32 v107, s37, v213
  v_pk_fma_f32 v[114:115], v[106:107], v[122:123], v[114:115] op_sel:[0,1,0] op_sel_hi:[1,1,1]
  s_waitcnt lgkmcnt(11)
  v_mfma_f32_32x32x16_bf16 v[144:159], v[244:247], v[52:55], v[144:159]
  ds_read_b64_tr_b16 v[236:237], v4 offset:40960
  ds_read_b64_tr_b16 v[238:239], v4 offset:41984
  v_pk_mul_f32 v[106:107], v[106:107], v[120:121] op_sel:[0,1] op_sel_hi:[1,1]
  v_cvt_pk_bf16_f32 v101, v106, v107
  v_lshlrev_b32 v108, 16, v214
  v_and_b32 v109, s37, v214
  v_pk_fma_f32 v[116:117], v[108:109], v[122:123], v[116:117] op_sel:[0,1,0] op_sel_hi:[1,1,1]
  s_waitcnt lgkmcnt(11)
  v_mfma_f32_32x32x16_bf16 v[160:175], v[248:251], v[52:55], v[160:175]
  ds_read_b64_tr_b16 v[240:241], v1 offset:45056
  ds_read_b64_tr_b16 v[242:243], v1 offset:46080
  v_pk_mul_f32 v[108:109], v[108:109], v[120:121] op_sel:[0,1] op_sel_hi:[1,1]
  v_cvt_pk_bf16_f32 v102, v108, v109
  v_lshlrev_b32 v110, 16, v215
  v_and_b32 v111, s37, v215
  v_pk_fma_f32 v[118:119], v[110:111], v[122:123], v[118:119] op_sel:[0,1,0] op_sel_hi:[1,1,1]
  s_waitcnt lgkmcnt(11)
  v_mfma_f32_32x32x16_bf16 v[176:191], v[252:255], v[52:55], v[176:191]
  ds_read_b64_tr_b16 v[244:245], v2 offset:45056
  ds_read_b64_tr_b16 v[246:247], v2 offset:46080
  buffer_load_dwordx4 v[52:55], v22, s[16:19], s29 offen offset:1024
  v_pk_mul_f32 v[110:111], v[110:111], v[120:121] op_sel:[0,1] op_sel_hi:[1,1]
  v_cvt_pk_bf16_f32 v103, v110, v111
  ds_write_b128 v19, v[100:103] offset:50176
  s_mov_b32 s28, 3145728
  buffer_load_dwordx4 v[212:215], v18, s[4:7], s28 offen
  s_waitcnt vmcnt(23) lgkmcnt(12)
  v_mfma_f32_32x32x16_bf16 v[128:143], v[224:227], v[56:59], v[128:143]
  ds_read_b64_tr_b16 v[248:249], v3 offset:45056
  ds_read_b64_tr_b16 v[250:251], v3 offset:46080
  s_waitcnt lgkmcnt(11)
  v_mfma_f32_32x32x16_bf16 v[144:159], v[228:231], v[56:59], v[144:159]
  ds_read_b64_tr_b16 v[252:253], v4 offset:45056
  ds_read_b64_tr_b16 v[254:255], v4 offset:46080
  s_waitcnt lgkmcnt(11)
  v_mfma_f32_32x32x16_bf16 v[160:175], v[232:235], v[56:59], v[160:175]
  s_waitcnt lgkmcnt(2)
  s_barrier
  ds_read_b64_tr_b16 v[224:225], v1 offset:49152
  ds_read_b64_tr_b16 v[226:227], v1 offset:50176
  v_mfma_f32_32x32x16_bf16 v[176:191], v[236:239], v[56:59], v[176:191]
  ds_read_b64_tr_b16 v[228:229], v2 offset:49152
  ds_read_b64_tr_b16 v[230:231], v2 offset:50176
  v_add_u32 v29, 1024, v0
  v_min_u32 v29, 2687, v29
  v_mul_u32_u24 v31, 3121, v29
  v_lshrrev_b32 v31, 18, v31
  v_lshlrev_b32 v29, 4, v29
  v_mad_i32_i24 v30, v31, s41, v29
  v_add_u32 v30, s40, v30
  buffer_load_dwordx4 v[56:59], v22, s[16:19], s29 offen offset:2048
  s_waitcnt vmcnt(23)
  v_mfma_f32_32x32x16_bf16 v[128:143], v[240:243], v[60:63], v[128:143]
  ds_read_b64_tr_b16 v[232:233], v3 offset:49152
  ds_read_b64_tr_b16 v[234:235], v3 offset:50176
  ds_read_b32 v120, v126 offset:3328
  ds_read_b32 v121, v126 offset:3344
  ds_read_b32 v122, v126 offset:768
  ds_read_b32 v123, v126 offset:784
  v_mfma_f32_32x32x16_bf16 v[144:159], v[244:247], v[60:63], v[144:159]
  ds_read_b64_tr_b16 v[236:237], v4 offset:49152
  ds_read_b64_tr_b16 v[238:239], v4 offset:50176
  s_add_u32 m0, s46, 16384
  s_nop 0
  buffer_load_dwordx4 v30, s[56:59], 0 offen lds
  v_lshlrev_b32 v104, 16, v216
  v_and_b32 v105, s37, v216
  s_waitcnt lgkmcnt(2)
  v_pk_fma_f32 v[112:113], v[104:105], v[122:123], v[112:113] op_sel:[0,0,0] op_sel_hi:[1,0,1]
  v_mfma_f32_32x32x16_bf16 v[160:175], v[248:251], v[60:63], v[160:175]
  ds_read_b64_tr_b16 v[240:241], v1 offset:53248
  ds_read_b64_tr_b16 v[242:243], v1 offset:54272
  v_pk_mul_f32 v[104:105], v[104:105], v[120:121] op_sel:[0,0] op_sel_hi:[1,0]
  v_cvt_pk_bf16_f32 v96, v104, v105
  v_lshlrev_b32 v106, 16, v217
  v_and_b32 v107, s37, v217
  v_pk_fma_f32 v[114:115], v[106:107], v[122:123], v[114:115] op_sel:[0,0,0] op_sel_hi:[1,0,1]
  v_mfma_f32_32x32x16_bf16 v[176:191], v[252:255], v[60:63], v[176:191]
  ds_read_b64_tr_b16 v[244:245], v2 offset:53248
  ds_read_b64_tr_b16 v[246:247], v2 offset:54272
  v_add_u32 v29, 1536, v0
  v_min_u32 v29, 2687, v29
  v_mul_u32_u24 v31, 3121, v29
  v_lshrrev_b32 v31, 18, v31
  v_lshlrev_b32 v29, 4, v29
  v_mad_i32_i24 v30, v31, s41, v29
  v_add_u32 v30, s40, v30
  buffer_load_dwordx4 v[60:63], v22, s[16:19], s29 offen offset:3072
  s_waitcnt vmcnt(24)
  v_mfma_f32_32x32x16_bf16 v[128:143], v[224:227], v[64:67], v[128:143]
  ds_read_b64_tr_b16 v[248:249], v3 offset:53248
  ds_read_b64_tr_b16 v[250:251], v3 offset:54272
  v_pk_mul_f32 v[106:107], v[106:107], v[120:121] op_sel:[0,0] op_sel_hi:[1,0]
  v_cvt_pk_bf16_f32 v97, v106, v107
  v_lshlrev_b32 v108, 16, v218
  v_and_b32 v109, s37, v218
  v_pk_fma_f32 v[116:117], v[108:109], v[122:123], v[116:117] op_sel:[0,0,0] op_sel_hi:[1,0,1]
  v_mfma_f32_32x32x16_bf16 v[144:159], v[228:231], v[64:67], v[144:159]
  ds_read_b64_tr_b16 v[252:253], v4 offset:53248
  ds_read_b64_tr_b16 v[254:255], v4 offset:54272
  s_add_u32 m0, s46, 24576
  s_nop 0
  buffer_load_dwordx4 v30, s[56:59], 0 offen lds
  v_pk_mul_f32 v[108:109], v[108:109], v[120:121] op_sel:[0,0] op_sel_hi:[1,0]
  v_cvt_pk_bf16_f32 v98, v108, v109
  v_lshlrev_b32 v110, 16, v219
  v_mfma_f32_32x32x16_bf16 v[160:175], v[232:235], v[64:67], v[160:175]
  ds_read_b64_tr_b16 v[224:225], v1 offset:57344
  ds_read_b64_tr_b16 v[226:227], v1 offset:58368
  v_and_b32 v111, s37, v219
  v_pk_fma_f32 v[118:119], v[110:111], v[122:123], v[118:119] op_sel:[0,0,0] op_sel_hi:[1,0,1]
  v_pk_mul_f32 v[110:111], v[110:111], v[120:121] op_sel:[0,0] op_sel_hi:[1,0]
  v_cvt_pk_bf16_f32 v99, v110, v111
  ds_write_b128 v19, v[96:99] offset:16384
  s_waitcnt lgkmcnt(11)
  v_mfma_f32_32x32x16_bf16 v[176:191], v[236:239], v[64:67], v[176:191]
  ds_read_b64_tr_b16 v[228:229], v2 offset:57344
  ds_read_b64_tr_b16 v[230:231], v2 offset:58368
  s_add_u32 s29, s24, 24576
  buffer_load_dwordx4 v[64:67], v22, s[16:19], s29 offen offset:0
  s_mov_b32 s28, 3670016
  buffer_load_dwordx4 v[216:219], v17, s[4:7], s28 offen
  v_lshlrev_b32 v104, 16, v220
  v_and_b32 v105, s37, v220
  v_pk_fma_f32 v[112:113], v[104:105], v[122:123], v[112:113] op_sel:[0,1,0] op_sel_hi:[1,1,1]
  s_waitcnt vmcnt(26) lgkmcnt(11)
  v_mfma_f32_32x32x16_bf16 v[128:143], v[240:243], v[68:71], v[128:143]
  ds_read_b64_tr_b16 v[232:233], v3 offset:57344
  ds_read_b64_tr_b16 v[234:235], v3 offset:58368
  v_pk_mul_f32 v[104:105], v[104:105], v[120:121] op_sel:[0,1] op_sel_hi:[1,1]
  v_cvt_pk_bf16_f32 v100, v104, v105
  v_lshlrev_b32 v106, 16, v221
  v_and_b32 v107, s37, v221
  v_pk_fma_f32 v[114:115], v[106:107], v[122:123], v[114:115] op_sel:[0,1,0] op_sel_hi:[1,1,1]
  s_waitcnt lgkmcnt(11)
  v_mfma_f32_32x32x16_bf16 v[144:159], v[244:247], v[68:71], v[144:159]
  ds_read_b64_tr_b16 v[236:237], v4 offset:57344
  ds_read_b64_tr_b16 v[238:239], v4 offset:58368
  v_pk_mul_f32 v[106:107], v[106:107], v[120:121] op_sel:[0,1] op_sel_hi:[1,1]
  v_cvt_pk_bf16_f32 v101, v106, v107
  v_lshlrev_b32 v108, 16, v222
  v_and_b32 v109, s37, v222
  v_pk_fma_f32 v[116:117], v[108:109], v[122:123], v[116:117] op_sel:[0,1,0] op_sel_hi:[1,1,1]
  s_waitcnt lgkmcnt(11)
  v_mfma_f32_32x32x16_bf16 v[160:175], v[248:251], v[68:71], v[160:175]
  ds_read_b64_tr_b16 v[240:241], v1 offset:61440
  ds_read_b64_tr_b16 v[242:243], v1 offset:62464
  v_pk_mul_f32 v[108:109], v[108:109], v[120:121] op_sel:[0,1] op_sel_hi:[1,1]
  v_cvt_pk_bf16_f32 v102, v108, v109
  v_lshlrev_b32 v110, 16, v223
  v_and_b32 v111, s37, v223
  v_pk_fma_f32 v[118:119], v[110:111], v[122:123], v[118:119] op_sel:[0,1,0] op_sel_hi:[1,1,1]
  s_waitcnt lgkmcnt(11)
  v_mfma_f32_32x32x16_bf16 v[176:191], v[252:255], v[68:71], v[176:191]
  ds_read_b64_tr_b16 v[244:245], v2 offset:61440
  ds_read_b64_tr_b16 v[246:247], v2 offset:62464
  buffer_load_dwordx4 v[68:71], v22, s[16:19], s29 offen offset:1024
  v_pk_mul_f32 v[110:111], v[110:111], v[120:121] op_sel:[0,1] op_sel_hi:[1,1]
  v_cvt_pk_bf16_f32 v103, v110, v111
  ds_write_b128 v19, v[100:103] offset:17408
  s_mov_b32 s28, 3670016
  buffer_load_dwordx4 v[220:223], v18, s[4:7], s28 offen
  s_waitcnt vmcnt(27) lgkmcnt(12)
  v_mfma_f32_32x32x16_bf16 v[128:143], v[224:227], v[72:75], v[128:143]
  ds_read_b64_tr_b16 v[248:249], v3 offset:61440
  ds_read_b64_tr_b16 v[250:251], v3 offset:62464
  s_waitcnt lgkmcnt(11)
  v_mfma_f32_32x32x16_bf16 v[144:159], v[228:231], v[72:75], v[144:159]
  ds_read_b64_tr_b16 v[252:253], v4 offset:61440
  ds_read_b64_tr_b16 v[254:255], v4 offset:62464
  s_waitcnt lgkmcnt(11)
  v_mfma_f32_32x32x16_bf16 v[160:175], v[232:235], v[72:75], v[160:175]
  s_waitcnt lgkmcnt(2)
  s_barrier
  ds_read_b64_tr_b16 v[224:225], v1 offset:16384
  ds_read_b64_tr_b16 v[226:227], v1 offset:17408
  v_mfma_f32_32x32x16_bf16 v[176:191], v[236:239], v[72:75], v[176:191]
  ds_read_b64_tr_b16 v[228:229], v2 offset:16384
  ds_read_b64_tr_b16 v[230:231], v2 offset:17408
  v_add_u32 v29, 2048, v0
  v_min_u32 v29, 2687, v29
  v_mul_u32_u24 v31, 3121, v29
  v_lshrrev_b32 v31, 18, v31
  v_lshlrev_b32 v29, 4, v29
  v_mad_i32_i24 v30, v31, s41, v29
  v_add_u32 v30, s40, v30
  buffer_load_dwordx4 v[72:75], v22, s[16:19], s29 offen offset:2048
  s_waitcnt vmcnt(27)
  v_mfma_f32_32x32x16_bf16 v[128:143], v[240:243], v[76:79], v[128:143]
  ds_read_b64_tr_b16 v[232:233], v3 offset:16384
  ds_read_b64_tr_b16 v[234:235], v3 offset:17408
  ds_read_b32 v120, v126 offset:3584
  ds_read_b32 v121, v126 offset:3600
  ds_read_b32 v122, v126 offset:1024
  ds_read_b32 v123, v126 offset:1040
  v_mfma_f32_32x32x16_bf16 v[144:159], v[244:247], v[76:79], v[144:159]
  ds_read_b64_tr_b16 v[236:237], v4 offset:16384
  ds_read_b64_tr_b16 v[238:239], v4 offset:17408
  s_add_u32 m0, s46, 32768
  s_nop 0
  buffer_load_dwordx4 v30, s[56:59], 0 offen lds
  s_waitcnt vmcnt(23)
  v_lshlrev_b32 v104, 16, v192
  v_and_b32 v105, s37, v192
  s_waitcnt lgkmcnt(2)
  v_pk_fma_f32 v[112:113], v[104:105], v[122:123], v[112:113] op_sel:[0,0,0] op_sel_hi:[1,0,1]
  v_mfma_f32_32x32x16_bf16 v[160:175], v[248:251], v[76:79], v[160:175]
  ds_read_b64_tr_b16 v[240:241], v1 offset:20480
  ds_read_b64_tr_b16 v[242:243], v1 offset:21504
  v_pk_mul_f32 v[104:105], v[104:105], v[120:121] op_sel:[0,0] op_sel_hi:[1,0]
  v_cvt_pk_bf16_f32 v96, v104, v105
  v_lshlrev_b32 v106, 16, v193
  v_and_b32 v107, s37, v193
  v_pk_fma_f32 v[114:115], v[106:107], v[122:123], v[114:115] op_sel:[0,0,0] op_sel_hi:[1,0,1]
  v_mfma_f32_32x32x16_bf16 v[176:191], v[252:255], v[76:79], v[176:191]
  ds_read_b64_tr_b16 v[244:245], v2 offset:20480
  ds_read_b64_tr_b16 v[246:247], v2 offset:21504
  v_add_u32 v29, 2560, v0
  v_min_u32 v29, 2687, v29
  v_mul_u32_u24 v31, 3121, v29
  v_lshrrev_b32 v31, 18, v31
  v_lshlrev_b32 v29, 4, v29
  v_mad_i32_i24 v30, v31, s41, v29
  v_add_u32 v30, s40, v30
  buffer_load_dwordx4 v[76:79], v22, s[16:19], s29 offen offset:3072
  v_mfma_f32_32x32x16_bf16 v[128:143], v[224:227], v[80:83], v[128:143]
  ds_read_b64_tr_b16 v[248:249], v3 offset:20480
  ds_read_b64_tr_b16 v[250:251], v3 offset:21504
  v_pk_mul_f32 v[106:107], v[106:107], v[120:121] op_sel:[0,0] op_sel_hi:[1,0]
  v_cvt_pk_bf16_f32 v97, v106, v107
  v_lshlrev_b32 v108, 16, v194
  v_and_b32 v109, s37, v194
  v_pk_fma_f32 v[116:117], v[108:109], v[122:123], v[116:117] op_sel:[0,0,0] op_sel_hi:[1,0,1]
  v_mfma_f32_32x32x16_bf16 v[144:159], v[228:231], v[80:83], v[144:159]
  ds_read_b64_tr_b16 v[252:253], v4 offset:20480
  ds_read_b64_tr_b16 v[254:255], v4 offset:21504
  s_add_u32 m0, s46, 40960
  s_nop 0
  buffer_load_dwordx4 v30, s[56:59], 0 offen lds
  v_pk_mul_f32 v[108:109], v[108:109], v[120:121] op_sel:[0,0] op_sel_hi:[1,0]
  v_cvt_pk_bf16_f32 v98, v108, v109
  v_lshlrev_b32 v110, 16, v195
  v_mfma_f32_32x32x16_bf16 v[160:175], v[232:235], v[80:83], v[160:175]
  ds_read_b64_tr_b16 v[224:225], v1 offset:24576
  ds_read_b64_tr_b16 v[226:227], v1 offset:25600
  v_and_b32 v111, s37, v195
  v_pk_fma_f32 v[118:119], v[110:111], v[122:123], v[118:119] op_sel:[0,0,0] op_sel_hi:[1,0,1]
  v_pk_mul_f32 v[110:111], v[110:111], v[120:121] op_sel:[0,0] op_sel_hi:[1,0]
  v_cvt_pk_bf16_f32 v99, v110, v111
  ds_write_b128 v19, v[96:99] offset:32768
  s_waitcnt lgkmcnt(11)
  v_mfma_f32_32x32x16_bf16 v[176:191], v[236:239], v[80:83], v[176:191]
  ds_read_b64_tr_b16 v[228:229], v2 offset:24576
  ds_read_b64_tr_b16 v[230:231], v2 offset:25600
  s_add_u32 s29, s24, 28672
  buffer_load_dwordx4 v[80:83], v22, s[16:19], s29 offen offset:0
  s_mov_b32 s28, 4194304
  buffer_load_dwordx4 v[192:195], v17, s[4:7], s28 offen
  s_waitcnt vmcnt(26)
  v_lshlrev_b32 v104, 16, v196
  v_and_b32 v105, s37, v196
  v_pk_fma_f32 v[112:113], v[104:105], v[122:123], v[112:113] op_sel:[0,1,0] op_sel_hi:[1,1,1]
  s_waitcnt lgkmcnt(11)
  v_mfma_f32_32x32x16_bf16 v[128:143], v[240:243], v[84:87], v[128:143]
  ds_read_b64_tr_b16 v[232:233], v3 offset:24576
  ds_read_b64_tr_b16 v[234:235], v3 offset:25600
  v_pk_mul_f32 v[104:105], v[104:105], v[120:121] op_sel:[0,1] op_sel_hi:[1,1]
  v_cvt_pk_bf16_f32 v100, v104, v105
  v_lshlrev_b32 v106, 16, v197
  v_and_b32 v107, s37, v197
  v_pk_fma_f32 v[114:115], v[106:107], v[122:123], v[114:115] op_sel:[0,1,0] op_sel_hi:[1,1,1]
  s_waitcnt lgkmcnt(11)
  v_mfma_f32_32x32x16_bf16 v[144:159], v[244:247], v[84:87], v[144:159]
  ds_read_b64_tr_b16 v[236:237], v4 offset:24576
  ds_read_b64_tr_b16 v[238:239], v4 offset:25600
  v_pk_mul_f32 v[106:107], v[106:107], v[120:121] op_sel:[0,1] op_sel_hi:[1,1]
  v_cvt_pk_bf16_f32 v101, v106, v107
  v_lshlrev_b32 v108, 16, v198
  v_and_b32 v109, s37, v198
  v_pk_fma_f32 v[116:117], v[108:109], v[122:123], v[116:117] op_sel:[0,1,0] op_sel_hi:[1,1,1]
  s_waitcnt lgkmcnt(11)
  v_mfma_f32_32x32x16_bf16 v[160:175], v[248:251], v[84:87], v[160:175]
  ds_read_b64_tr_b16 v[240:241], v1 offset:28672
  ds_read_b64_tr_b16 v[242:243], v1 offset:29696
  v_pk_mul_f32 v[108:109], v[108:109], v[120:121] op_sel:[0,1] op_sel_hi:[1,1]
  v_cvt_pk_bf16_f32 v102, v108, v109
  v_lshlrev_b32 v110, 16, v199
  v_and_b32 v111, s37, v199
  v_pk_fma_f32 v[118:119], v[110:111], v[122:123], v[118:119] op_sel:[0,1,0] op_sel_hi:[1,1,1]
  s_waitcnt lgkmcnt(11)
  v_mfma_f32_32x32x16_bf16 v[176:191], v[252:255], v[84:87], v[176:191]
  ds_read_b64_tr_b16 v[244:245], v2 offset:28672
  ds_read_b64_tr_b16 v[246:247], v2 offset:29696
  buffer_load_dwordx4 v[84:87], v22, s[16:19], s29 offen offset:1024
  v_pk_mul_f32 v[110:111], v[110:111], v[120:121] op_sel:[0,1] op_sel_hi:[1,1]
  v_cvt_pk_bf16_f32 v103, v110, v111
  ds_write_b128 v19, v[100:103] offset:33792
  s_mov_b32 s28, 4194304
  buffer_load_dwordx4 v[196:199], v18, s[4:7], s28 offen
  s_waitcnt lgkmcnt(12)
  v_mfma_f32_32x32x16_bf16 v[128:143], v[224:227], v[88:91], v[128:143]
  ds_read_b64_tr_b16 v[248:249], v3 offset:28672
  ds_read_b64_tr_b16 v[250:251], v3 offset:29696
  s_waitcnt lgkmcnt(11)
  v_mfma_f32_32x32x16_bf16 v[144:159], v[228:231], v[88:91], v[144:159]
  ds_read_b64_tr_b16 v[252:253], v4 offset:28672
  ds_read_b64_tr_b16 v[254:255], v4 offset:29696
  s_waitcnt lgkmcnt(11)
  v_mfma_f32_32x32x16_bf16 v[160:175], v[232:235], v[88:91], v[160:175]
  s_waitcnt lgkmcnt(2)
  s_barrier
  ds_read_b64_tr_b16 v[224:225], v1 offset:32768
  ds_read_b64_tr_b16 v[226:227], v1 offset:33792
  v_mfma_f32_32x32x16_bf16 v[176:191], v[236:239], v[88:91], v[176:191]
  ds_read_b64_tr_b16 v[228:229], v2 offset:32768
  ds_read_b64_tr_b16 v[230:231], v2 offset:33792
  s_add_u32 s28, s25, 0
  s_add_u32 m0, s23, 65536
  s_nop 0
  buffer_load_dwordx4 v20, s[8:11], s28 offen lds
  buffer_load_dwordx4 v[88:91], v22, s[16:19], s29 offen offset:2048
  ds_read_b32 v120, v126 offset:3840
  ds_read_b32 v121, v126 offset:3856
  v_mfma_f32_32x32x16_bf16 v[128:143], v[240:243], v[92:95], v[128:143]
  ds_read_b64_tr_b16 v[232:233], v3 offset:32768
  ds_read_b64_tr_b16 v[234:235], v3 offset:33792
  ds_read_b32 v122, v126 offset:1280
  ds_read_b32 v123, v126 offset:1296
  v_mfma_f32_32x32x16_bf16 v[144:159], v[244:247], v[92:95], v[144:159]
  ds_read_b64_tr_b16 v[236:237], v4 offset:32768
  ds_read_b64_tr_b16 v[238:239], v4 offset:33792
  s_add_u32 s28, s25, 0
  s_add_u32 m0, s23, 65536
  s_nop 0
  buffer_load_dwordx4 v21, s[8:11], s28 offen offset:1024 lds
  s_waitcnt vmcnt(29)
  v_lshlrev_b32 v104, 16, v200
  v_and_b32 v105, s37, v200
  s_waitcnt lgkmcnt(2)
  v_pk_fma_f32 v[112:113], v[104:105], v[122:123], v[112:113] op_sel:[0,0,0] op_sel_hi:[1,0,1]
  v_mfma_f32_32x32x16_bf16 v[160:175], v[248:251], v[92:95], v[160:175]
  ds_read_b64_tr_b16 v[240:241], v1 offset:36864
  ds_read_b64_tr_b16 v[242:243], v1 offset:37888
  v_pk_mul_f32 v[104:105], v[104:105], v[120:121] op_sel:[0,0] op_sel_hi:[1,0]
  v_cvt_pk_bf16_f32 v96, v104, v105
  v_lshlrev_b32 v106, 16, v201
  v_and_b32 v107, s37, v201
  v_pk_fma_f32 v[114:115], v[106:107], v[122:123], v[114:115] op_sel:[0,0,0] op_sel_hi:[1,0,1]
  v_mfma_f32_32x32x16_bf16 v[176:191], v[252:255], v[92:95], v[176:191]
  ds_read_b64_tr_b16 v[244:245], v2 offset:36864
  ds_read_b64_tr_b16 v[246:247], v2 offset:37888
  buffer_load_dwordx4 v[92:95], v22, s[16:19], s29 offen offset:3072
  v_pk_mul_f32 v[106:107], v[106:107], v[120:121] op_sel:[0,0] op_sel_hi:[1,0]
  v_cvt_pk_bf16_f32 v97, v106, v107
  v_lshlrev_b32 v108, 16, v202
  v_and_b32 v109, s37, v202
  v_mfma_f32_32x32x16_bf16 v[128:143], v[224:227], v[32:35], v[128:143]
  ds_read_b64_tr_b16 v[248:249], v3 offset:36864
  ds_read_b64_tr_b16 v[250:251], v3 offset:37888
  v_pk_fma_f32 v[116:117], v[108:109], v[122:123], v[116:117] op_sel:[0,0,0] op_sel_hi:[1,0,1]
  v_pk_mul_f32 v[108:109], v[108:109], v[120:121] op_sel:[0,0] op_sel_hi:[1,0]
  v_cvt_pk_bf16_f32 v98, v108, v109
  v_lshlrev_b32 v110, 16, v203
  v_and_b32 v111, s37, v203
  v_mfma_f32_32x32x16_bf16 v[144:159], v[228:231], v[32:35], v[144:159]
  ds_read_b64_tr_b16 v[252:253], v4 offset:36864
  ds_read_b64_tr_b16 v[254:255], v4 offset:37888
  v_pk_fma_f32 v[118:119], v[110:111], v[122:123], v[118:119] op_sel:[0,0,0] op_sel_hi:[1,0,1]
  v_pk_mul_f32 v[110:111], v[110:111], v[120:121] op_sel:[0,0] op_sel_hi:[1,0]
  v_cvt_pk_bf16_f32 v99, v110, v111
  ds_write_b128 v19, v[96:99] offset:49152
  s_mov_b32 s28, 4718592
  buffer_load_dwordx4 v[200:203], v17, s[4:7], s28 offen
  v_mfma_f32_32x32x16_bf16 v[160:175], v[232:235], v[32:35], v[160:175]
  ds_read_b64_tr_b16 v[224:225], v1 offset:40960
  ds_read_b64_tr_b16 v[226:227], v1 offset:41984
  s_waitcnt vmcnt(29)
  v_lshlrev_b32 v104, 16, v204
  v_and_b32 v105, s37, v204
  v_pk_fma_f32 v[112:113], v[104:105], v[122:123], v[112:113] op_sel:[0,1,0] op_sel_hi:[1,1,1]
  v_pk_mul_f32 v[104:105], v[104:105], v[120:121] op_sel:[0,1] op_sel_hi:[1,1]
  v_cvt_pk_bf16_f32 v100, v104, v105
  s_waitcnt lgkmcnt(11)
  v_mfma_f32_32x32x16_bf16 v[176:191], v[236:239], v[32:35], v[176:191]
  ds_read_b64_tr_b16 v[228:229], v2 offset:40960
  ds_read_b64_tr_b16 v[230:231], v2 offset:41984
  s_add_u32 s29, s24, 32768
  buffer_load_dwordx4 v[32:35], v22, s[16:19], s29 offen offset:0
  v_lshlrev_b32 v106, 16, v205
  v_and_b32 v107, s37, v205
  v_pk_fma_f32 v[114:115], v[106:107], v[122:123], v[114:115] op_sel:[0,1,0] op_sel_hi:[1,1,1]
  v_pk_mul_f32 v[106:107], v[106:107], v[120:121] op_sel:[0,1] op_sel_hi:[1,1]
  s_waitcnt lgkmcnt(11)
  v_mfma_f32_32x32x16_bf16 v[128:143], v[240:243], v[36:39], v[128:143]
  ds_read_b64_tr_b16 v[232:233], v3 offset:40960
  ds_read_b64_tr_b16 v[234:235], v3 offset:41984
  v_cvt_pk_bf16_f32 v101, v106, v107
  v_lshlrev_b32 v108, 16, v206
  v_and_b32 v109, s37, v206
  v_pk_fma_f32 v[116:117], v[108:109], v[122:123], v[116:117] op_sel:[0,1,0] op_sel_hi:[1,1,1]
  v_pk_mul_f32 v[108:109], v[108:109], v[120:121] op_sel:[0,1] op_sel_hi:[1,1]
  s_waitcnt lgkmcnt(11)
  v_mfma_f32_32x32x16_bf16 v[144:159], v[244:247], v[36:39], v[144:159]
  ds_read_b64_tr_b16 v[236:237], v4 offset:40960
  ds_read_b64_tr_b16 v[238:239], v4 offset:41984
  v_cvt_pk_bf16_f32 v102, v108, v109
  v_lshlrev_b32 v110, 16, v207
  v_and_b32 v111, s37, v207
  v_pk_fma_f32 v[118:119], v[110:111], v[122:123], v[118:119] op_sel:[0,1,0] op_sel_hi:[1,1,1]
  v_pk_mul_f32 v[110:111], v[110:111], v[120:121] op_sel:[0,1] op_sel_hi:[1,1]
  s_waitcnt lgkmcnt(11)
  v_mfma_f32_32x32x16_bf16 v[160:175], v[248:251], v[36:39], v[160:175]
  ds_read_b64_tr_b16 v[240:241], v1 offset:45056
  ds_read_b64_tr_b16 v[242:243], v1 offset:46080
  v_cvt_pk_bf16_f32 v103, v110, v111
  ds_write_b128 v19, v[100:103] offset:50176
  s_mov_b32 s28, 4718592
  buffer_load_dwordx4 v[204:207], v18, s[4:7], s28 offen
  s_waitcnt lgkmcnt(12)
  v_mfma_f32_32x32x16_bf16 v[176:191], v[252:255], v[36:39], v[176:191]
  ds_read_b64_tr_b16 v[244:245], v2 offset:45056
  ds_read_b64_tr_b16 v[246:247], v2 offset:46080
  buffer_load_dwordx4 v[36:39], v22, s[16:19], s29 offen offset:1024
  s_waitcnt vmcnt(31) lgkmcnt(11)
  v_mfma_f32_32x32x16_bf16 v[128:143], v[224:227], v[40:43], v[128:143]
  ds_read_b64_tr_b16 v[248:249], v3 offset:45056
  ds_read_b64_tr_b16 v[250:251], v3 offset:46080
  s_waitcnt lgkmcnt(11)
  v_mfma_f32_32x32x16_bf16 v[144:159], v[228:231], v[40:43], v[144:159]
  ds_read_b64_tr_b16 v[252:253], v4 offset:45056
  ds_read_b64_tr_b16 v[254:255], v4 offset:46080
  s_waitcnt lgkmcnt(11)
  v_mfma_f32_32x32x16_bf16 v[160:175], v[232:235], v[40:43], v[160:175]
  s_waitcnt lgkmcnt(6)
  s_barrier
  ds_read_b64_tr_b16 v[224:225], v1 offset:49152
  ds_read_b64_tr_b16 v[226:227], v1 offset:50176
  v_mfma_f32_32x32x16_bf16 v[176:191], v[236:239], v[40:43], v[176:191]
  ds_read_b64_tr_b16 v[228:229], v2 offset:49152
  ds_read_b64_tr_b16 v[230:231], v2 offset:50176
  s_add_u32 s28, s25, 16384
  s_add_u32 m0, s23, 81920
  s_nop 0
  buffer_load_dwordx4 v20, s[8:11], s28 offen lds
  buffer_load_dwordx4 v[40:43], v22, s[16:19], s29 offen offset:2048
  ds_read_b32 v120, v126 offset:4096
  ds_read_b32 v121, v126 offset:4112
  s_waitcnt vmcnt(31)
  v_mfma_f32_32x32x16_bf16 v[128:143], v[240:243], v[44:47], v[128:143]
  ds_read_b64_tr_b16 v[232:233], v3 offset:49152
  ds_read_b64_tr_b16 v[234:235], v3 offset:50176
  ds_read_b32 v122, v126 offset:1536
  ds_read_b32 v123, v126 offset:1552
  v_bfe_u32 v27, v0, 4, 2
  v_bfe_u32 v28, v0, 2, 2
  v_lshl_add_u32 v27, v27, 3, v28
  v_mul_u32_u24 v27, 1344, v27
  v_add_u32 v27, s43, v27
  v_and_b32 v29, 3, v0
  s_waitcnt lgkmcnt(14)
  v_mfma_f32_32x32x16_bf16 v[144:159], v[244:247], v[44:47], v[144:159]
  ds_read_b64_tr_b16 v[236:237], v4 offset:49152
  ds_read_b64_tr_b16 v[238:239], v4 offset:50176
  s_add_u32 s28, s25, 16384
  s_add_u32 m0, s23, 81920
  s_nop 0
  buffer_load_dwordx4 v21, s[8:11], s28 offen offset:1024 lds
  v_lshl_add_u32 v124, v29, 4, v27
  v_lshl_add_u32 v125, v29, 3, v27
  s_cmp_eq_u32 s44, 1
  s_cselect_b64 vcc, -1, 0
  s_cselect_b32 s32, 0, 0x40000000
  v_cndmask_b32 v127, v125, v124, vcc
  s_waitcnt lgkmcnt(14)
  v_mfma_f32_32x32x16_bf16 v[160:175], v[248:251], v[44:47], v[160:175]
  ds_read_b64_tr_b16 v[240:241], v1 offset:53248
  ds_read_b64_tr_b16 v[242:243], v1 offset:54272
  s_cmp_lt_u32 s20, s45
  s_cselect_b32 s33, 0, 0x40000000
  s_cmp_lt_u32 s2, 242
  s_cselect_b32 s33, s33, 0x40000000
  v_or_b32 v27, s33, v22
  v_or_b32 v28, s32, v27
  s_waitcnt vmcnt(29)
  v_lshlrev_b32 v104, 16, v208
  v_and_b32 v105, s37, v208
  s_waitcnt lgkmcnt(14)
  v_mfma_f32_32x32x16_bf16 v[176:191], v[252:255], v[44:47], v[176:191]
  ds_read_b64_tr_b16 v[244:245], v2 offset:53248
  ds_read_b64_tr_b16 v[246:247], v2 offset:54272
  buffer_load_dwordx4 v[44:47], v22, s[16:19], s29 offen offset:3072
  s_waitcnt lgkmcnt(6)
  v_pk_fma_f32 v[112:113], v[104:105], v[122:123], v[112:113] op_sel:[0,0,0] op_sel_hi:[1,0,1]
  v_pk_mul_f32 v[104:105], v[104:105], v[120:121] op_sel:[0,0] op_sel_hi:[1,0]
  v_cvt_pk_bf16_f32 v96, v104, v105
  v_lshlrev_b32 v106, 16, v209
  v_mfma_f32_32x32x16_bf16 v[128:143], v[224:227], v[48:51], v[128:143]
  ds_read_b64_tr_b16 v[248:249], v3 offset:53248
  ds_read_b64_tr_b16 v[250:251], v3 offset:54272
  v_and_b32 v107, s37, v209
  v_pk_fma_f32 v[114:115], v[106:107], v[122:123], v[114:115] op_sel:[0,0,0] op_sel_hi:[1,0,1]
  v_pk_mul_f32 v[106:107], v[106:107], v[120:121] op_sel:[0,0] op_sel_hi:[1,0]
  v_cvt_pk_bf16_f32 v97, v106, v107
  v_lshlrev_b32 v108, 16, v210
  v_mfma_f32_32x32x16_bf16 v[144:159], v[228:231], v[48:51], v[144:159]
  ds_read_b64_tr_b16 v[252:253], v4 offset:53248
  ds_read_b64_tr_b16 v[254:255], v4 offset:54272
  v_and_b32 v109, s37, v210
  v_pk_fma_f32 v[116:117], v[108:109], v[122:123], v[116:117] op_sel:[0,0,0] op_sel_hi:[1,0,1]
  v_pk_mul_f32 v[108:109], v[108:109], v[120:121] op_sel:[0,0] op_sel_hi:[1,0]
  v_cvt_pk_bf16_f32 v98, v108, v109
  v_lshlrev_b32 v110, 16, v211
  v_mfma_f32_32x32x16_bf16 v[160:175], v[232:235], v[48:51], v[160:175]
  ds_read_b64_tr_b16 v[224:225], v1 offset:57344
  ds_read_b64_tr_b16 v[226:227], v1 offset:58368
  v_and_b32 v111, s37, v211
  v_pk_fma_f32 v[118:119], v[110:111], v[122:123], v[118:119] op_sel:[0,0,0] op_sel_hi:[1,0,1]
  v_pk_mul_f32 v[110:111], v[110:111], v[120:121] op_sel:[0,0] op_sel_hi:[1,0]
  v_cvt_pk_bf16_f32 v99, v110, v111
  ds_write_b128 v19, v[96:99] offset:16384
  s_waitcnt lgkmcnt(11)
  v_mfma_f32_32x32x16_bf16 v[176:191], v[236:239], v[48:51], v[176:191]
  ds_read_b64_tr_b16 v[228:229], v2 offset:57344
  ds_read_b64_tr_b16 v[230:231], v2 offset:58368
  s_add_u32 s29, s24, 36864
  buffer_load_dwordx4 v[48:51], v22, s[16:19], s29 offen offset:0
  s_waitcnt vmcnt(29)
  v_lshlrev_b32 v104, 16, v212
  v_and_b32 v105, s37, v212
  v_pk_fma_f32 v[112:113], v[104:105], v[122:123], v[112:113] op_sel:[0,1,0] op_sel_hi:[1,1,1]
  v_pk_mul_f32 v[104:105], v[104:105], v[120:121] op_sel:[0,1] op_sel_hi:[1,1]
  s_waitcnt lgkmcnt(11)
  v_mfma_f32_32x32x16_bf16 v[128:143], v[240:243], v[52:55], v[128:143]
  ds_read_b64_tr_b16 v[232:233], v3 offset:57344
  ds_read_b64_tr_b16 v[234:235], v3 offset:58368
  v_cvt_pk_bf16_f32 v100, v104, v105
  v_lshlrev_b32 v106, 16, v213
  v_and_b32 v107, s37, v213
  v_pk_fma_f32 v[114:115], v[106:107], v[122:123], v[114:115] op_sel:[0,1,0] op_sel_hi:[1,1,1]
  v_pk_mul_f32 v[106:107], v[106:107], v[120:121] op_sel:[0,1] op_sel_hi:[1,1]
  s_waitcnt lgkmcnt(11)
  v_mfma_f32_32x32x16_bf16 v[144:159], v[244:247], v[52:55], v[144:159]
  ds_read_b64_tr_b16 v[236:237], v4 offset:57344
  ds_read_b64_tr_b16 v[238:239], v4 offset:58368
  v_cvt_pk_bf16_f32 v101, v106, v107
  v_lshlrev_b32 v108, 16, v214
  v_and_b32 v109, s37, v214
  v_pk_fma_f32 v[116:117], v[108:109], v[122:123], v[116:117] op_sel:[0,1,0] op_sel_hi:[1,1,1]
  v_pk_mul_f32 v[108:109], v[108:109], v[120:121] op_sel:[0,1] op_sel_hi:[1,1]
  s_waitcnt lgkmcnt(11)
  v_mfma_f32_32x32x16_bf16 v[160:175], v[248:251], v[52:55], v[160:175]
  ds_read_b64_tr_b16 v[240:241], v1 offset:61440
  ds_read_b64_tr_b16 v[242:243], v1 offset:62464
  v_cvt_pk_bf16_f32 v102, v108, v109
  v_lshlrev_b32 v110, 16, v215
  v_and_b32 v111, s37, v215
  v_pk_fma_f32 v[118:119], v[110:111], v[122:123], v[118:119] op_sel:[0,1,0] op_sel_hi:[1,1,1]
  v_pk_mul_f32 v[110:111], v[110:111], v[120:121] op_sel:[0,1] op_sel_hi:[1,1]
  s_waitcnt lgkmcnt(11)
  v_mfma_f32_32x32x16_bf16 v[176:191], v[252:255], v[52:55], v[176:191]
  ds_read_b64_tr_b16 v[244:245], v2 offset:61440
  ds_read_b64_tr_b16 v[246:247], v2 offset:62464
  buffer_load_dwordx4 v[52:55], v22, s[16:19], s29 offen offset:1024
  v_cvt_pk_bf16_f32 v103, v110, v111
  ds_write_b128 v19, v[100:103] offset:17408
  s_waitcnt vmcnt(29) lgkmcnt(12)
  v_mfma_f32_32x32x16_bf16 v[128:143], v[224:227], v[56:59], v[128:143]
  ds_read_b64_tr_b16 v[248:249], v3 offset:61440
  ds_read_b64_tr_b16 v[250:251], v3 offset:62464
  s_waitcnt lgkmcnt(11)
  v_mfma_f32_32x32x16_bf16 v[144:159], v[228:231], v[56:59], v[144:159]
  ds_read_b64_tr_b16 v[252:253], v4 offset:61440
  ds_read_b64_tr_b16 v[254:255], v4 offset:62464
  s_waitcnt lgkmcnt(11)
  v_mfma_f32_32x32x16_bf16 v[160:175], v[232:235], v[56:59], v[160:175]
  s_waitcnt vmcnt(18)
  s_waitcnt lgkmcnt(4)
  s_barrier
  ds_read_b64_tr_b16 v[224:225], v1 offset:16384
  ds_read_b64_tr_b16 v[226:227], v1 offset:17408
  v_mfma_f32_32x32x16_bf16 v[176:191], v[236:239], v[56:59], v[176:191]
  ds_read_b64_tr_b16 v[228:229], v2 offset:16384
  ds_read_b64_tr_b16 v[230:231], v2 offset:17408
  s_add_u32 s28, s25, 0
  s_add_u32 m0, s23, 0
  s_nop 0
  buffer_load_dwordx4 v19, s[12:15], s28 offen lds
  buffer_load_dwordx4 v[56:59], v22, s[16:19], s29 offen offset:2048
  ds_read_b32 v120, v126 offset:4352
  ds_read_b32 v121, v126 offset:4368
  v_mfma_f32_32x32x16_bf16 v[128:143], v[240:243], v[60:63], v[128:143]
  ds_read_b64_tr_b16 v[232:233], v3 offset:16384
  ds_read_b64_tr_b16 v[234:235], v3 offset:17408
  ds_read_b32 v122, v126 offset:1792
  ds_read_b32 v123, v126 offset:1808
  v_mfma_f32_32x32x16_bf16 v[144:159], v[244:247], v[60:63], v[144:159]
  ds_read_b64_tr_b16 v[236:237], v4 offset:16384
  ds_read_b64_tr_b16 v[238:239], v4 offset:17408
  s_add_u32 s28, s25, 0
  s_add_u32 m0, s23, 0
  s_nop 0
  buffer_load_dwordx4 v19, s[12:15], s28 offen offset:1024 lds
  v_lshlrev_b32 v104, 16, v216
  v_and_b32 v105, s37, v216
  s_waitcnt lgkmcnt(2)
  v_pk_fma_f32 v[112:113], v[104:105], v[122:123], v[112:113] op_sel:[0,0,0] op_sel_hi:[1,0,1]
  v_mfma_f32_32x32x16_bf16 v[160:175], v[248:251], v[60:63], v[160:175]
  ds_read_b64_tr_b16 v[240:241], v1 offset:20480
  ds_read_b64_tr_b16 v[242:243], v1 offset:21504
  v_pk_mul_f32 v[104:105], v[104:105], v[120:121] op_sel:[0,0] op_sel_hi:[1,0]
  v_cvt_pk_bf16_f32 v96, v104, v105
  v_lshlrev_b32 v106, 16, v217
  v_and_b32 v107, s37, v217
  v_pk_fma_f32 v[114:115], v[106:107], v[122:123], v[114:115] op_sel:[0,0,0] op_sel_hi:[1,0,1]
  v_mfma_f32_32x32x16_bf16 v[176:191], v[252:255], v[60:63], v[176:191]
  ds_read_b64_tr_b16 v[244:245], v2 offset:20480
  ds_read_b64_tr_b16 v[246:247], v2 offset:21504
  buffer_load_dwordx4 v[60:63], v22, s[16:19], s29 offen offset:3072
  v_pk_mul_f32 v[106:107], v[106:107], v[120:121] op_sel:[0,0] op_sel_hi:[1,0]
  v_cvt_pk_bf16_f32 v97, v106, v107
  v_lshlrev_b32 v108, 16, v218
  v_and_b32 v109, s37, v218
  v_mfma_f32_32x32x16_bf16 v[128:143], v[224:227], v[64:67], v[128:143]
  ds_read_b64_tr_b16 v[248:249], v3 offset:20480
  ds_read_b64_tr_b16 v[250:251], v3 offset:21504
  v_pk_fma_f32 v[116:117], v[108:109], v[122:123], v[116:117] op_sel:[0,0,0] op_sel_hi:[1,0,1]
  v_pk_mul_f32 v[108:109], v[108:109], v[120:121] op_sel:[0,0] op_sel_hi:[1,0]
  v_cvt_pk_bf16_f32 v98, v108, v109
  v_lshlrev_b32 v110, 16, v219
  v_and_b32 v111, s37, v219
  v_mfma_f32_32x32x16_bf16 v[144:159], v[228:231], v[64:67], v[144:159]
  ds_read_b64_tr_b16 v[252:253], v4 offset:20480
  ds_read_b64_tr_b16 v[254:255], v4 offset:21504
  v_pk_fma_f32 v[118:119], v[110:111], v[122:123], v[118:119] op_sel:[0,0,0] op_sel_hi:[1,0,1]
  v_pk_mul_f32 v[110:111], v[110:111], v[120:121] op_sel:[0,0] op_sel_hi:[1,0]
  v_cvt_pk_bf16_f32 v99, v110, v111
  ds_write_b128 v19, v[96:99] offset:32768
  v_lshlrev_b32 v104, 16, v220
  v_mfma_f32_32x32x16_bf16 v[160:175], v[232:235], v[64:67], v[160:175]
  ds_read_b64_tr_b16 v[224:225], v1 offset:24576
  ds_read_b64_tr_b16 v[226:227], v1 offset:25600
  v_and_b32 v105, s37, v220
  v_pk_fma_f32 v[112:113], v[104:105], v[122:123], v[112:113] op_sel:[0,1,0] op_sel_hi:[1,1,1]
  v_pk_mul_f32 v[104:105], v[104:105], v[120:121] op_sel:[0,1] op_sel_hi:[1,1]
  v_cvt_pk_bf16_f32 v100, v104, v105
  v_lshlrev_b32 v106, 16, v221
  s_waitcnt lgkmcnt(11)
  v_mfma_f32_32x32x16_bf16 v[176:191], v[236:239], v[64:67], v[176:191]
  ds_read_b64_tr_b16 v[228:229], v2 offset:24576
  ds_read_b64_tr_b16 v[230:231], v2 offset:25600
  v_and_b32 v107, s37, v221
  v_pk_fma_f32 v[114:115], v[106:107], v[122:123], v[114:115] op_sel:[0,1,0] op_sel_hi:[1,1,1]
  v_pk_mul_f32 v[106:107], v[106:107], v[120:121] op_sel:[0,1] op_sel_hi:[1,1]
  v_cvt_pk_bf16_f32 v101, v106, v107
  v_lshlrev_b32 v108, 16, v222
  s_waitcnt lgkmcnt(11)
  v_mfma_f32_32x32x16_bf16 v[128:143], v[240:243], v[68:71], v[128:143]
  ds_read_b64_tr_b16 v[232:233], v3 offset:24576
  ds_read_b64_tr_b16 v[234:235], v3 offset:25600
  v_and_b32 v109, s37, v222
  v_pk_fma_f32 v[116:117], v[108:109], v[122:123], v[116:117] op_sel:[0,1,0] op_sel_hi:[1,1,1]
  v_pk_mul_f32 v[108:109], v[108:109], v[120:121] op_sel:[0,1] op_sel_hi:[1,1]
  v_cvt_pk_bf16_f32 v102, v108, v109
  v_lshlrev_b32 v110, 16, v223
  s_waitcnt lgkmcnt(11)
  v_mfma_f32_32x32x16_bf16 v[144:159], v[244:247], v[68:71], v[144:159]
  ds_read_b64_tr_b16 v[236:237], v4 offset:24576
  ds_read_b64_tr_b16 v[238:239], v4 offset:25600
  v_and_b32 v111, s37, v223
  v_pk_fma_f32 v[118:119], v[110:111], v[122:123], v[118:119] op_sel:[0,1,0] op_sel_hi:[1,1,1]
  v_pk_mul_f32 v[110:111], v[110:111], v[120:121] op_sel:[0,1] op_sel_hi:[1,1]
  v_cvt_pk_bf16_f32 v103, v110, v111
  s_waitcnt lgkmcnt(11)
  v_mfma_f32_32x32x16_bf16 v[160:175], v[248:251], v[68:71], v[160:175]
  ds_read_b64_tr_b16 v[240:241], v1 offset:28672
  ds_read_b64_tr_b16 v[242:243], v1 offset:29696
  ds_read_b64_tr_b16 v[64:65], v124 offset:0
  ds_read_b64_tr_b16 v[66:67], v124 offset:5376
  ds_write_b128 v19, v[100:103] offset:33792
  s_waitcnt lgkmcnt(14)
  v_mfma_f32_32x32x16_bf16 v[176:191], v[252:255], v[68:71], v[176:191]
  ds_read_b64_tr_b16 v[244:245], v2 offset:28672
  ds_read_b64_tr_b16 v[246:247], v2 offset:29696
  s_waitcnt lgkmcnt(13)
  v_mfma_f32_32x32x16_bf16 v[128:143], v[224:227], v[72:75], v[128:143]
  ds_read_b64_tr_b16 v[248:249], v3 offset:28672
  ds_read_b64_tr_b16 v[250:251], v3 offset:29696
  s_waitcnt lgkmcnt(13)
  v_mfma_f32_32x32x16_bf16 v[144:159], v[228:231], v[72:75], v[144:159]
  ds_read_b64_tr_b16 v[252:253], v4 offset:28672
  ds_read_b64_tr_b16 v[254:255], v4 offset:29696
  s_waitcnt lgkmcnt(7)
  buffer_store_dwordx4 v[64:67], v27, s[16:19], s42 offen offset:0 sc1
  v_mfma_f32_32x32x16_bf16 v[160:175], v[232:235], v[72:75], v[160:175]
  s_waitcnt lgkmcnt(6)
  s_barrier
  ds_read_b64_tr_b16 v[224:225], v1 offset:32768
  ds_read_b64_tr_b16 v[226:227], v1 offset:33792
  ds_read_b64_tr_b16 v[68:69], v124 offset:8
  ds_read_b64_tr_b16 v[70:71], v124 offset:5384
  v_mfma_f32_32x32x16_bf16 v[176:191], v[236:239], v[72:75], v[176:191]
  ds_read_b64_tr_b16 v[228:229], v2 offset:32768
  ds_read_b64_tr_b16 v[230:231], v2 offset:33792
  ds_read_b32 v120, v126 offset:4608
  ds_read_b32 v121, v126 offset:4624
  ds_read_b32 v122, v126 offset:2048
  ds_read_b32 v123, v126 offset:2064
  v_mfma_f32_32x32x16_bf16 v[128:143], v[240:243], v[76:79], v[128:143]
  ds_read_b64_tr_b16 v[232:233], v3 offset:32768
  ds_read_b64_tr_b16 v[234:235], v3 offset:33792
  s_waitcnt lgkmcnt(15)
  v_mfma_f32_32x32x16_bf16 v[144:159], v[244:247], v[76:79], v[144:159]
  ds_read_b64_tr_b16 v[236:237], v4 offset:32768
  ds_read_b64_tr_b16 v[238:239], v4 offset:33792
  s_waitcnt lgkmcnt(10)
  buffer_store_dwordx4 v[68:71], v27, s[16:19], s42 offen offset:1024 sc1
  s_waitcnt vmcnt(22)
  v_lshlrev_b32 v104, 16, v192
  v_mfma_f32_32x32x16_bf16 v[160:175], v[248:251], v[76:79], v[160:175]
  ds_read_b64_tr_b16 v[240:241], v1 offset:36864
  ds_read_b64_tr_b16 v[242:243], v1 offset:37888
  ds_read_b64_tr_b16 v[72:73], v124 offset:64
  ds_read_b64_tr_b16 v[74:75], v124 offset:5440
  v_and_b32 v105, s37, v192
  s_waitcnt lgkmcnt(8)
  v_pk_fma_f32 v[112:113], v[104:105], v[122:123], v[112:113] op_sel:[0,0,0] op_sel_hi:[1,0,1]
  v_pk_mul_f32 v[104:105], v[104:105], v[120:121] op_sel:[0,0] op_sel_hi:[1,0]
  v_mfma_f32_32x32x16_bf16 v[176:191], v[252:255], v[76:79], v[176:191]
  ds_read_b64_tr_b16 v[244:245], v2 offset:36864
  ds_read_b64_tr_b16 v[246:247], v2 offset:37888
  v_cvt_pk_bf16_f32 v96, v104, v105
  v_lshlrev_b32 v106, 16, v193
  v_and_b32 v107, s37, v193
  v_pk_fma_f32 v[114:115], v[106:107], v[122:123], v[114:115] op_sel:[0,0,0] op_sel_hi:[1,0,1]
  v_pk_mul_f32 v[106:107], v[106:107], v[120:121] op_sel:[0,0] op_sel_hi:[1,0]
  v_mfma_f32_32x32x16_bf16 v[128:143], v[224:227], v[80:83], v[128:143]
  ds_read_b64_tr_b16 v[248:249], v3 offset:36864
  ds_read_b64_tr_b16 v[250:251], v3 offset:37888
  v_cvt_pk_bf16_f32 v97, v106, v107
  v_lshlrev_b32 v108, 16, v194
  v_and_b32 v109, s37, v194
  v_pk_fma_f32 v[116:117], v[108:109], v[122:123], v[116:117] op_sel:[0,0,0] op_sel_hi:[1,0,1]
  v_pk_mul_f32 v[108:109], v[108:109], v[120:121] op_sel:[0,0] op_sel_hi:[1,0]
  v_mfma_f32_32x32x16_bf16 v[144:159], v[228:231], v[80:83], v[144:159]
  ds_read_b64_tr_b16 v[252:253], v4 offset:36864
  ds_read_b64_tr_b16 v[254:255], v4 offset:37888
  v_cvt_pk_bf16_f32 v98, v108, v109
  v_lshlrev_b32 v110, 16, v195
  s_waitcnt lgkmcnt(6)
  buffer_store_dwordx4 v[72:75], v27, s[16:19], s42 offen offset:2048 sc1
  v_and_b32 v111, s37, v195
  v_mfma_f32_32x32x16_bf16 v[160:175], v[232:235], v[80:83], v[160:175]
  ds_read_b64_tr_b16 v[224:225], v1 offset:40960
  ds_read_b64_tr_b16 v[226:227], v1 offset:41984
  v_pk_fma_f32 v[118:119], v[110:111], v[122:123], v[118:119] op_sel:[0,0,0] op_sel_hi:[1,0,1]
  v_pk_mul_f32 v[110:111], v[110:111], v[120:121] op_sel:[0,0] op_sel_hi:[1,0]
  v_cvt_pk_bf16_f32 v99, v110, v111
  ds_write_b128 v19, v[96:99] offset:49152
  ds_read_b64_tr_b16 v[76:77], v124 offset:72
  v_mfma_f32_32x32x16_bf16 v[176:191], v[236:239], v[80:83], v[176:191]
  ds_read_b64_tr_b16 v[228:229], v2 offset:40960
  ds_read_b64_tr_b16 v[230:231], v2 offset:41984
  ds_read_b64_tr_b16 v[78:79], v124 offset:5448
  s_waitcnt vmcnt(21)
  v_lshlrev_b32 v104, 16, v196
  v_and_b32 v105, s37, v196
  v_pk_fma_f32 v[112:113], v[104:105], v[122:123], v[112:113] op_sel:[0,1,0] op_sel_hi:[1,1,1]
  v_pk_mul_f32 v[104:105], v[104:105], v[120:121] op_sel:[0,1] op_sel_hi:[1,1]
  v_mfma_f32_32x32x16_bf16 v[128:143], v[240:243], v[84:87], v[128:143]
  ds_read_b64_tr_b16 v[232:233], v3 offset:40960
  ds_read_b64_tr_b16 v[234:235], v3 offset:41984
  v_cvt_pk_bf16_f32 v100, v104, v105
  v_lshlrev_b32 v106, 16, v197
  v_and_b32 v107, s37, v197
  v_pk_fma_f32 v[114:115], v[106:107], v[122:123], v[114:115] op_sel:[0,1,0] op_sel_hi:[1,1,1]
  v_pk_mul_f32 v[106:107], v[106:107], v[120:121] op_sel:[0,1] op_sel_hi:[1,1]
  s_waitcnt lgkmcnt(13)
  v_mfma_f32_32x32x16_bf16 v[144:159], v[244:247], v[84:87], v[144:159]
  ds_read_b64_tr_b16 v[236:237], v4 offset:40960
  ds_read_b64_tr_b16 v[238:239], v4 offset:41984
  v_cvt_pk_bf16_f32 v101, v106, v107
  v_lshlrev_b32 v108, 16, v198
  v_and_b32 v109, s37, v198
  v_pk_fma_f32 v[116:117], v[108:109], v[122:123], v[116:117] op_sel:[0,1,0] op_sel_hi:[1,1,1]
  v_pk_mul_f32 v[108:109], v[108:109], v[120:121] op_sel:[0,1] op_sel_hi:[1,1]
  s_waitcnt lgkmcnt(13)
  v_mfma_f32_32x32x16_bf16 v[160:175], v[248:251], v[84:87], v[160:175]
  ds_read_b64_tr_b16 v[240:241], v1 offset:45056
  ds_read_b64_tr_b16 v[242:243], v1 offset:46080
  v_cvt_pk_bf16_f32 v102, v108, v109
  s_waitcnt lgkmcnt(6)
  buffer_store_dwordx4 v[76:79], v27, s[16:19], s42 offen offset:3072 sc1
  v_lshlrev_b32 v110, 16, v199
  v_and_b32 v111, s37, v199
  v_mfma_f32_32x32x16_bf16 v[176:191], v[252:255], v[84:87], v[176:191]
  ds_read_b64_tr_b16 v[244:245], v2 offset:45056
  ds_read_b64_tr_b16 v[246:247], v2 offset:46080
  v_pk_fma_f32 v[118:119], v[110:111], v[122:123], v[118:119] op_sel:[0,1,0] op_sel_hi:[1,1,1]
  v_pk_mul_f32 v[110:111], v[110:111], v[120:121] op_sel:[0,1] op_sel_hi:[1,1]
  v_cvt_pk_bf16_f32 v103, v110, v111
  ds_read_b64_tr_b16 v[80:81], v127 offset:128
  ds_read_b64_tr_b16 v[82:83], v127 offset:5504
  s_waitcnt vmcnt(20)
  v_mfma_f32_32x32x16_bf16 v[128:143], v[224:227], v[88:91], v[128:143]
  ds_read_b64_tr_b16 v[248:249], v3 offset:45056
  ds_read_b64_tr_b16 v[250:251], v3 offset:46080
  ds_write_b128 v19, v[100:103] offset:50176
  v_mfma_f32_32x32x16_bf16 v[144:159], v[228:231], v[88:91], v[144:159]
  ds_read_b64_tr_b16 v[252:253], v4 offset:45056
  ds_read_b64_tr_b16 v[254:255], v4 offset:46080
  s_waitcnt lgkmcnt(5)
  buffer_store_dwordx4 v[80:83], v27, s[16:19], s47 offen offset:0 sc1
  v_mfma_f32_32x32x16_bf16 v[160:175], v[232:235], v[88:91], v[160:175]
  s_waitcnt lgkmcnt(2)
  s_barrier
  ds_read_b64_tr_b16 v[224:225], v1 offset:49152
  ds_read_b64_tr_b16 v[226:227], v1 offset:50176
  ds_read_b64_tr_b16 v[84:85], v124 offset:136
  ds_read_b64_tr_b16 v[86:87], v124 offset:5512
  v_mfma_f32_32x32x16_bf16 v[176:191], v[236:239], v[88:91], v[176:191]
  ds_read_b64_tr_b16 v[228:229], v2 offset:49152
  ds_read_b64_tr_b16 v[230:231], v2 offset:50176
  ds_read_b32 v120, v126 offset:4864
  ds_read_b32 v121, v126 offset:4880
  ds_read_b32 v122, v126 offset:2304
  ds_read_b32 v123, v126 offset:2320
  s_waitcnt vmcnt(19)
  v_mfma_f32_32x32x16_bf16 v[128:143], v[240:243], v[92:95], v[128:143]
  ds_read_b64_tr_b16 v[232:233], v3 offset:49152
  ds_read_b64_tr_b16 v[234:235], v3 offset:50176
  v_mfma_f32_32x32x16_bf16 v[144:159], v[244:247], v[92:95], v[144:159]
  ds_read_b64_tr_b16 v[236:237], v4 offset:49152
  ds_read_b64_tr_b16 v[238:239], v4 offset:50176
  s_waitcnt lgkmcnt(10)
  buffer_store_dwordx4 v[84:87], v28, s[16:19], s47 offen offset:1024 sc1
  s_waitcnt vmcnt(19)
  v_lshlrev_b32 v104, 16, v200
  v_mfma_f32_32x32x16_bf16 v[160:175], v[248:251], v[92:95], v[160:175]
  ds_read_b64_tr_b16 v[240:241], v1 offset:53248
  ds_read_b64_tr_b16 v[242:243], v1 offset:54272
  ds_read_b64_tr_b16 v[88:89], v125 offset:192
  ds_read_b64_tr_b16 v[90:91], v125 offset:5568
  v_and_b32 v105, s37, v200
  s_waitcnt lgkmcnt(8)
  v_pk_fma_f32 v[112:113], v[104:105], v[122:123], v[112:113] op_sel:[0,0,0] op_sel_hi:[1,0,1]
  v_pk_mul_f32 v[104:105], v[104:105], v[120:121] op_sel:[0,0] op_sel_hi:[1,0]
  v_mfma_f32_32x32x16_bf16 v[176:191], v[252:255], v[92:95], v[176:191]
  ds_read_b64_tr_b16 v[244:245], v2 offset:53248
  ds_read_b64_tr_b16 v[246:247], v2 offset:54272
  v_cvt_pk_bf16_f32 v96, v104, v105
  v_lshlrev_b32 v106, 16, v201
  v_and_b32 v107, s37, v201
  v_pk_fma_f32 v[114:115], v[106:107], v[122:123], v[114:115] op_sel:[0,0,0] op_sel_hi:[1,0,1]
  v_pk_mul_f32 v[106:107], v[106:107], v[120:121] op_sel:[0,0] op_sel_hi:[1,0]
  s_waitcnt vmcnt(18)
  v_mfma_f32_32x32x16_bf16 v[128:143], v[224:227], v[32:35], v[128:143]
  ds_read_b64_tr_b16 v[248:249], v3 offset:53248
  ds_read_b64_tr_b16 v[250:251], v3 offset:54272
  v_cvt_pk_bf16_f32 v97, v106, v107
  v_lshlrev_b32 v108, 16, v202
  v_and_b32 v109, s37, v202
  v_pk_fma_f32 v[116:117], v[108:109], v[122:123], v[116:117] op_sel:[0,0,0] op_sel_hi:[1,0,1]
  v_pk_mul_f32 v[108:109], v[108:109], v[120:121] op_sel:[0,0] op_sel_hi:[1,0]
  v_mfma_f32_32x32x16_bf16 v[144:159], v[228:231], v[32:35], v[144:159]
  ds_read_b64_tr_b16 v[252:253], v4 offset:53248
  ds_read_b64_tr_b16 v[254:255], v4 offset:54272
  v_cvt_pk_bf16_f32 v98, v108, v109
  v_lshlrev_b32 v110, 16, v203
  s_waitcnt lgkmcnt(6)
  buffer_store_dwordx4 v[88:91], v28, s[16:19], s47 offen offset:2048 sc1
  v_and_b32 v111, s37, v203
  v_mfma_f32_32x32x16_bf16 v[160:175], v[232:235], v[32:35], v[160:175]
  ds_read_b64_tr_b16 v[224:225], v1 offset:57344
  ds_read_b64_tr_b16 v[226:227], v1 offset:58368
  v_pk_fma_f32 v[118:119], v[110:111], v[122:123], v[118:119] op_sel:[0,0,0] op_sel_hi:[1,0,1]
  v_pk_mul_f32 v[110:111], v[110:111], v[120:121] op_sel:[0,0] op_sel_hi:[1,0]
  v_cvt_pk_bf16_f32 v99, v110, v111
  ds_write_b128 v19, v[96:99] offset:16384
  s_waitcnt vmcnt(18)
  v_lshlrev_b32 v104, 16, v204
  v_mfma_f32_32x32x16_bf16 v[176:191], v[236:239], v[32:35], v[176:191]
  ds_read_b64_tr_b16 v[228:229], v2 offset:57344
  ds_read_b64_tr_b16 v[230:231], v2 offset:58368
  v_and_b32 v105, s37, v204
  v_pk_fma_f32 v[112:113], v[104:105], v[122:123], v[112:113] op_sel:[0,1,0] op_sel_hi:[1,1,1]
  v_pk_mul_f32 v[104:105], v[104:105], v[120:121] op_sel:[0,1] op_sel_hi:[1,1]
  v_cvt_pk_bf16_f32 v100, v104, v105
  v_lshlrev_b32 v106, 16, v205
  s_waitcnt vmcnt(17)
  v_mfma_f32_32x32x16_bf16 v[128:143], v[240:243], v[36:39], v[128:143]
  ds_read_b64_tr_b16 v[232:233], v3 offset:57344
  ds_read_b64_tr_b16 v[234:235], v3 offset:58368
  v_and_b32 v107, s37, v205
  v_pk_fma_f32 v[114:115], v[106:107], v[122:123], v[114:115] op_sel:[0,1,0] op_sel_hi:[1,1,1]
  v_pk_mul_f32 v[106:107], v[106:107], v[120:121] op_sel:[0,1] op_sel_hi:[1,1]
  v_cvt_pk_bf16_f32 v101, v106, v107
  v_lshlrev_b32 v108, 16, v206
  s_waitcnt lgkmcnt(11)
  v_mfma_f32_32x32x16_bf16 v[144:159], v[244:247], v[36:39], v[144:159]
  ds_read_b64_tr_b16 v[236:237], v4 offset:57344
  ds_read_b64_tr_b16 v[238:239], v4 offset:58368
  v_and_b32 v109, s37, v206
  v_pk_fma_f32 v[116:117], v[108:109], v[122:123], v[116:117] op_sel:[0,1,0] op_sel_hi:[1,1,1]
  v_pk_mul_f32 v[108:109], v[108:109], v[120:121] op_sel:[0,1] op_sel_hi:[1,1]
  v_cvt_pk_bf16_f32 v102, v108, v109
  v_lshlrev_b32 v110, 16, v207
  s_waitcnt lgkmcnt(11)
  v_mfma_f32_32x32x16_bf16 v[160:175], v[248:251], v[36:39], v[160:175]
  ds_read_b64_tr_b16 v[240:241], v1 offset:61440
  ds_read_b64_tr_b16 v[242:243], v1 offset:62464
  v_and_b32 v111, s37, v207
  v_pk_fma_f32 v[118:119], v[110:111], v[122:123], v[118:119] op_sel:[0,1,0] op_sel_hi:[1,1,1]
  v_pk_mul_f32 v[110:111], v[110:111], v[120:121] op_sel:[0,1] op_sel_hi:[1,1]
  v_cvt_pk_bf16_f32 v103, v110, v111
  ds_write_b128 v19, v[100:103] offset:17408
  s_waitcnt lgkmcnt(12)
  v_mfma_f32_32x32x16_bf16 v[176:191], v[252:255], v[36:39], v[176:191]
  ds_read_b64_tr_b16 v[244:245], v2 offset:61440
  ds_read_b64_tr_b16 v[246:247], v2 offset:62464
  v_permlane32_swap_b32 v112, v116
  v_permlane32_swap_b32 v113, v117
  v_permlane32_swap_b32 v114, v118
  v_permlane32_swap_b32 v115, v119
  v_and_b32 v104, 15, v0
  s_waitcnt vmcnt(15) lgkmcnt(12)
  v_mfma_f32_32x32x16_bf16 v[128:143], v[224:227], v[40:43], v[128:143]
  ds_read_b64_tr_b16 v[248:249], v3 offset:61440
  ds_read_b64_tr_b16 v[250:251], v3 offset:62464
  v_lshlrev_b32 v104, 5, v104
  v_bfe_u32 v105, v0, 4, 2
  v_lshl_add_u32 v104, v105, 3, v104
  v_add_f32 v112, v112, v116
  v_add_f32 v113, v113, v117
  s_waitcnt lgkmcnt(11)
  v_mfma_f32_32x32x16_bf16 v[144:159], v[228:231], v[40:43], v[144:159]
  ds_read_b64_tr_b16 v[252:253], v4 offset:61440
  ds_read_b64_tr_b16 v[254:255], v4 offset:62464
  v_add_f32 v114, v114, v118
  v_add_f32 v115, v115, v119
  v_add_u32 v104, 152832, v104
  s_lshr_b32 s32, s23, 2
  v_add_u32 v105, s32, v104
  v_permlane16_swap_b32 v112, v114
  v_permlane16_swap_b32 v113, v115
  v_bfe_u32 v31, v0, 5, 1
  v_lshlrev_b32 v31, 5, v31
  v_add_f32 v112, v112, v114
  v_add_f32 v113, v113, v115
  ds_write_b64 v105, v[112:113]
  s_add_u32 s32, s32, 156928
  v_add_u32 v31, s32, v31
  s_waitcnt lgkmcnt(12)
  v_mfma_f32_32x32x16_bf16 v[160:175], v[232:235], v[40:43], v[160:175]
  s_waitcnt lgkmcnt(0)
  s_barrier
  ds_read_b64_tr_b16 v[224:225], v1 offset:16384
  ds_read_b64_tr_b16 v[226:227], v1 offset:17408
  v_mfma_f32_32x32x16_bf16 v[176:191], v[236:239], v[40:43], v[176:191]
  ds_read_b64_tr_b16 v[228:229], v1 offset:20480
  ds_read_b64_tr_b16 v[230:231], v1 offset:21504
  s_add_u32 s28, s25, 32768
  s_add_u32 m0, s23, 98304
  s_nop 0
  buffer_load_dwordx4 v20, s[8:11], s28 offen lds
  ds_read_b64 v[112:113], v104 offset:0
  ds_read_b64 v[114:115], v104 offset:512
  ds_read_b64 v[116:117], v104 offset:1024
  s_waitcnt vmcnt(14)
  v_mfma_f32_32x32x16_bf16 v[128:143], v[240:243], v[44:47], v[128:143]
  ds_read_b64_tr_b16 v[232:233], v1 offset:24576
  ds_read_b64_tr_b16 v[234:235], v1 offset:25600
  ds_read_b64 v[118:119], v104 offset:1536
  ds_read_b64 v[120:121], v104 offset:2048
  ds_read_b64 v[122:123], v104 offset:2560
  ds_read_b64 v[96:97], v104 offset:3072
  ds_read_b64 v[98:99], v104 offset:3584
  v_mfma_f32_32x32x16_bf16 v[144:159], v[244:247], v[44:47], v[144:159]
  ds_read_b64_tr_b16 v[236:237], v1 offset:28672
  ds_read_b64_tr_b16 v[238:239], v1 offset:29696
  s_add_u32 s28, s25, 32768
  s_add_u32 m0, s23, 98304
  s_nop 0
  buffer_load_dwordx4 v21, s[8:11], s28 offen offset:1024 lds
  v_mfma_f32_32x32x16_bf16 v[160:175], v[248:251], v[44:47], v[160:175]
  ds_read_b64_tr_b16 v[240:241], v2 offset:16384
  ds_read_b64_tr_b16 v[242:243], v2 offset:17408
  v_mfma_f32_32x32x16_bf16 v[176:191], v[252:255], v[44:47], v[176:191]
  ds_read_b64_tr_b16 v[244:245], v2 offset:20480
  ds_read_b64_tr_b16 v[246:247], v2 offset:21504
  s_add_u32 s28, s25, 49152
  s_add_u32 m0, s23, 114688
  s_nop 0
  buffer_load_dwordx4 v20, s[8:11], s28 offen lds
  s_waitcnt lgkmcnt(14)
  v_pk_add_f32 v[112:113], v[112:113], v[114:115]
  s_waitcnt lgkmcnt(10)
  v_pk_add_f32 v[116:117], v[116:117], v[118:119]
  s_waitcnt lgkmcnt(8)
  v_pk_add_f32 v[120:121], v[120:121], v[122:123]
  s_waitcnt vmcnt(15)
  v_mfma_f32_32x32x16_bf16 v[128:143], v[224:227], v[48:51], v[128:143]
  ds_read_b64_tr_b16 v[248:249], v2 offset:24576
  ds_read_b64_tr_b16 v[250:251], v2 offset:25600
  s_waitcnt lgkmcnt(8)
  v_pk_add_f32 v[96:97], v[96:97], v[98:99]
  v_pk_add_f32 v[112:113], v[112:113], v[116:117]
  v_pk_add_f32 v[96:97], v[96:97], v[120:121]
  v_pk_add_f32 v[112:113], v[112:113], v[96:97]
  v_mul_f32 v112, s30, v112
  s_waitcnt vmcnt(14)
  v_mfma_f32_32x32x16_bf16 v[128:143], v[228:231], v[52:55], v[128:143]
  ds_read_b64_tr_b16 v[252:253], v2 offset:28672
  ds_read_b64_tr_b16 v[254:255], v2 offset:29696
  s_add_u32 s28, s25, 49152
  s_add_u32 m0, s23, 114688
  s_nop 0
  buffer_load_dwordx4 v21, s[8:11], s28 offen offset:1024 lds
  v_mul_f32 v113, s30, v113
  ds_write_b64 v105, v[112:113] offset:4096
  s_waitcnt vmcnt(13)
  v_mfma_f32_32x32x16_bf16 v[128:143], v[232:235], v[56:59], v[128:143]
  ds_read_b64_tr_b16 v[224:225], v3 offset:16384
  ds_read_b64_tr_b16 v[226:227], v3 offset:17408
  ds_read_b128 v[96:99], v31 offset:0
  ds_read_b128 v[100:103], v31 offset:16
  ds_read_b128 v[104:107], v31 offset:64
  ds_read_b128 v[108:111], v31 offset:80
  s_waitcnt vmcnt(11) lgkmcnt(15)
  v_mfma_f32_32x32x16_bf16 v[128:143], v[236:239], v[60:63], v[128:143]
  ds_read_b64_tr_b16 v[228:229], v3 offset:20480
  ds_read_b64_tr_b16 v[230:231], v3 offset:21504
  ds_read_b128 v[112:115], v31 offset:128
  ds_read_b128 v[116:119], v31 offset:144
  ds_read_b128 v[120:123], v31 offset:192
  ds_read_b128 v[124:127], v31 offset:208
  s_waitcnt lgkmcnt(15)
  v_mfma_f32_32x32x16_bf16 v[144:159], v[240:243], v[48:51], v[144:159]
  ds_read_b64_tr_b16 v[232:233], v3 offset:24576
  ds_read_b64_tr_b16 v[234:235], v3 offset:25600
  ds_read_b128 v[64:67], v31 offset:256
  ds_read_b128 v[68:71], v31 offset:272
  ds_read_b128 v[72:75], v31 offset:320
  ds_read_b128 v[76:79], v31 offset:336
  v_mfma_f32_32x32x16_bf16 v[144:159], v[244:247], v[52:55], v[144:159]
  ds_read_b64_tr_b16 v[236:237], v3 offset:28672
  ds_read_b64_tr_b16 v[238:239], v3 offset:29696
  ds_read_b128 v[80:83], v31 offset:384
  ds_read_b128 v[84:87], v31 offset:400
  ds_read_b128 v[88:91], v31 offset:448
  ds_read_b128 v[92:95], v31 offset:464
  s_waitcnt lgkmcnt(15)
  v_fma_f32 v128, v128, s30, v96
  v_mfma_f32_32x32x16_bf16 v[144:159], v[248:251], v[56:59], v[144:159]
  ds_read_b64_tr_b16 v[240:241], v4 offset:16384
  ds_read_b64_tr_b16 v[242:243], v4 offset:17408
  v_fma_f32 v129, v129, s30, v97
  v_fma_f32 v130, v130, s30, v98
  v_fma_f32 v131, v131, s30, v99
  v_fma_f32 v132, v132, s30, v100
  v_fma_f32 v133, v133, s30, v101
  v_mfma_f32_32x32x16_bf16 v[144:159], v[252:255], v[60:63], v[144:159]
  ds_read_b64_tr_b16 v[244:245], v4 offset:20480
  ds_read_b64_tr_b16 v[246:247], v4 offset:21504
  v_fma_f32 v134, v134, s30, v102
  v_fma_f32 v135, v135, s30, v103
  v_cvt_pk_bf16_f32 v192, v128, v129
  v_cvt_pk_bf16_f32 v193, v130, v131
  v_cvt_pk_bf16_f32 v194, v132, v133
  v_mfma_f32_32x32x16_bf16 v[160:175], v[224:227], v[48:51], v[160:175]
  ds_read_b64_tr_b16 v[248:249], v4 offset:24576
  ds_read_b64_tr_b16 v[250:251], v4 offset:25600
  v_cvt_pk_bf16_f32 v195, v134, v135
  v_fma_f32 v136, v136, s30, v104
  v_fma_f32 v137, v137, s30, v105
  v_fma_f32 v138, v138, s30, v106
  v_fma_f32 v139, v139, s30, v107
  v_mfma_f32_32x32x16_bf16 v[160:175], v[228:231], v[52:55], v[160:175]
  ds_read_b64_tr_b16 v[252:253], v4 offset:28672
  ds_read_b64_tr_b16 v[254:255], v4 offset:29696
  v_fma_f32 v140, v140, s30, v108
  v_fma_f32 v141, v141, s30, v109
  v_fma_f32 v142, v142, s30, v110
  v_fma_f32 v143, v143, s30, v111
  v_cvt_pk_bf16_f32 v196, v136, v137
  s_waitcnt lgkmcnt(15)
  v_mfma_f32_32x32x16_bf16 v[160:175], v[232:235], v[56:59], v[160:175]
  s_barrier
  ds_read_b128 v[224:227], v9 offset:0
  v_cvt_pk_bf16_f32 v197, v138, v139
  v_cvt_pk_bf16_f32 v198, v140, v141
  v_cvt_pk_bf16_f32 v199, v142, v143
  v_fma_f32 v144, v144, s30, v112
  v_fma_f32 v145, v145, s30, v113
  s_waitcnt lgkmcnt(13)
  v_mfma_f32_32x32x16_bf16 v[160:175], v[236:239], v[60:63], v[160:175]
  ds_read_b128 v[228:231], v10 offset:0
  s_add_u32 s28, s25, 32768
  s_add_u32 m0, s23, 32768
  s_nop 0
  buffer_load_dwordx4 v19, s[12:15], s28 offen lds
  v_fma_f32 v146, v146, s30, v114
  v_fma_f32 v147, v147, s30, v115
  v_fma_f32 v148, v148, s30, v116
  s_waitcnt lgkmcnt(8)
  v_mfma_f32_32x32x16_bf16 v[176:191], v[240:243], v[48:51], v[176:191]
  ds_read_b128 v[232:235], v11 offset:0
  v_fma_f32 v149, v149, s30, v117
  v_fma_f32 v150, v150, s30, v118
  v_fma_f32 v151, v151, s30, v119
  v_cvt_pk_bf16_f32 v200, v144, v145
  v_cvt_pk_bf16_f32 v201, v146, v147
  s_waitcnt lgkmcnt(7)
  v_mfma_f32_32x32x16_bf16 v[176:191], v[244:247], v[52:55], v[176:191]
  ds_read_b128 v[236:239], v12 offset:0
  s_add_u32 s28, s25, 32768
  s_add_u32 m0, s23, 32768
  s_nop 0
  buffer_load_dwordx4 v19, s[12:15], s28 offen offset:1024 lds
  v_cvt_pk_bf16_f32 v202, v148, v149
  v_cvt_pk_bf16_f32 v203, v150, v151
  v_fma_f32 v152, v152, s30, v120
  s_waitcnt lgkmcnt(6)
  v_mfma_f32_32x32x16_bf16 v[176:191], v[248:251], v[56:59], v[176:191]
  ds_read_b128 v[240:243], v13 offset:0
  v_fma_f32 v153, v153, s30, v121
  v_fma_f32 v154, v154, s30, v122
  v_fma_f32 v155, v155, s30, v123
  v_fma_f32 v156, v156, s30, v124
  v_fma_f32 v157, v157, s30, v125
  s_waitcnt lgkmcnt(5)
  v_mfma_f32_32x32x16_bf16 v[176:191], v[252:255], v[60:63], v[176:191]
  ds_read_b128 v[244:247], v14 offset:0
  v_fma_f32 v158, v158, s30, v126
  v_fma_f32 v159, v159, s30, v127
  v_cvt_pk_bf16_f32 v204, v152, v153
  v_cvt_pk_bf16_f32 v205, v154, v155
  v_cvt_pk_bf16_f32 v206, v156, v157
  s_waitcnt lgkmcnt(5)
  v_mfma_f32_32x32x16_bf16 v[48:63], v[224:227], v[192:195], 0
  ds_read_b128 v[248:251], v15 offset:0
  v_cvt_pk_bf16_f32 v207, v158, v159
  v_fma_f32 v160, v160, s30, v64
  v_fma_f32 v161, v161, s30, v65
  v_fma_f32 v162, v162, s30, v66
  v_fma_f32 v163, v163, s30, v67
  s_waitcnt lgkmcnt(5)
  v_mfma_f32_32x32x16_bf16 v[48:63], v[228:231], v[196:199], v[48:63]
  ds_read_b128 v[252:255], v16 offset:0
  v_fma_f32 v164, v164, s30, v68
  v_fma_f32 v165, v165, s30, v69
  v_fma_f32 v166, v166, s30, v70
  v_fma_f32 v167, v167, s30, v71
  v_cvt_pk_bf16_f32 v208, v160, v161
  s_waitcnt lgkmcnt(5)
  v_mfma_f32_32x32x16_bf16 v[48:63], v[232:235], v[200:203], v[48:63]
  ds_read_b128 v[224:227], v9 offset:8192
  v_cvt_pk_bf16_f32 v209, v162, v163
  v_cvt_pk_bf16_f32 v210, v164, v165
  v_cvt_pk_bf16_f32 v211, v166, v167
  v_fma_f32 v168, v168, s30, v72
  v_fma_f32 v169, v169, s30, v73
  s_waitcnt lgkmcnt(5)
  v_mfma_f32_32x32x16_bf16 v[48:63], v[236:239], v[204:207], v[48:63]
  ds_read_b128 v[228:231], v10 offset:8192
  v_fma_f32 v170, v170, s30, v74
  v_fma_f32 v171, v171, s30, v75
  v_fma_f32 v172, v172, s30, v76
  v_fma_f32 v173, v173, s30, v77
  v_fma_f32 v174, v174, s30, v78
  s_waitcnt lgkmcnt(5)
  v_mfma_f32_32x32x16_bf16 v[48:63], v[240:243], v[208:211], v[48:63]
  ds_read_b128 v[232:235], v11 offset:8192
  v_fma_f32 v175, v175, s30, v79
  v_cvt_pk_bf16_f32 v212, v168, v169
  v_cvt_pk_bf16_f32 v213, v170, v171
  v_cvt_pk_bf16_f32 v214, v172, v173
  v_cvt_pk_bf16_f32 v215, v174, v175
  s_waitcnt lgkmcnt(5)
  s_nop 0
  v_mfma_f32_32x32x16_bf16 v[48:63], v[244:247], v[212:215], v[48:63]
  ds_read_b128 v[236:239], v12 offset:8192
  v_fma_f32 v176, v176, s30, v80
  v_fma_f32 v177, v177, s30, v81
  v_fma_f32 v178, v178, s30, v82
  v_fma_f32 v179, v179, s30, v83
  v_fma_f32 v180, v180, s30, v84
  v_fma_f32 v181, v181, s30, v85
  v_fma_f32 v182, v182, s30, v86
  v_fma_f32 v183, v183, s30, v87
  v_cvt_pk_bf16_f32 v216, v176, v177
  v_cvt_pk_bf16_f32 v217, v178, v179
  v_cvt_pk_bf16_f32 v218, v180, v181
  v_cvt_pk_bf16_f32 v219, v182, v183
  s_waitcnt lgkmcnt(5)
  s_nop 0
  v_mfma_f32_32x32x16_bf16 v[48:63], v[248:251], v[216:219], v[48:63]
  ds_read_b128 v[240:243], v13 offset:8192
  v_fma_f32 v184, v184, s30, v88
  v_fma_f32 v185, v185, s30, v89
  v_fma_f32 v186, v186, s30, v90
  v_fma_f32 v187, v187, s30, v91
  v_fma_f32 v188, v188, s30, v92
  v_fma_f32 v189, v189, s30, v93
  v_fma_f32 v190, v190, s30, v94
  v_fma_f32 v191, v191, s30, v95
  v_cvt_pk_bf16_f32 v220, v184, v185
  v_cvt_pk_bf16_f32 v221, v186, v187
  v_cvt_pk_bf16_f32 v222, v188, v189
  v_cvt_pk_bf16_f32 v223, v190, v191
  s_waitcnt lgkmcnt(5)
  s_nop 0
  v_mfma_f32_32x32x16_bf16 v[48:63], v[252:255], v[220:223], v[48:63]
  ds_read_b128 v[244:247], v14 offset:8192
  s_waitcnt lgkmcnt(5)
  v_mfma_f32_32x32x16_bf16 v[64:79], v[224:227], v[192:195], 0
  ds_read_b128 v[248:251], v15 offset:8192
  s_waitcnt lgkmcnt(5)
  v_mfma_f32_32x32x16_bf16 v[64:79], v[228:231], v[196:199], v[64:79]
  ds_read_b128 v[252:255], v16 offset:8192
  s_waitcnt lgkmcnt(5)
  v_mfma_f32_32x32x16_bf16 v[64:79], v[232:235], v[200:203], v[64:79]
  s_barrier
  ds_read_b128 v[224:227], v9 offset:16384
  s_waitcnt lgkmcnt(5)
  v_mfma_f32_32x32x16_bf16 v[64:79], v[236:239], v[204:207], v[64:79]
  ds_read_b128 v[228:231], v10 offset:16384
  s_add_u32 s28, s25, 16384
  s_add_u32 m0, s23, 16384
  s_nop 0
  buffer_load_dwordx4 v19, s[12:15], s28 offen lds
  v_max3_f32 v27, v48, v49, v50
  v_max3_f32 v28, v51, v52, v53
  v_max3_f32 v27, v27, v54, v55
  s_waitcnt lgkmcnt(5)
  v_mfma_f32_32x32x16_bf16 v[64:79], v[240:243], v[208:211], v[64:79]
  ds_read_b128 v[232:235], v11 offset:16384
  v_max3_f32 v28, v28, v56, v57
  v_max3_f32 v27, v27, v58, v59
  v_max3_f32 v28, v28, v60, v61
  v_max3_f32 v27, v27, v62, v63
  v_max3_f32 v27, v27, v28, v25
  s_waitcnt lgkmcnt(5)
  v_mfma_f32_32x32x16_bf16 v[64:79], v[244:247], v[212:215], v[64:79]
  ds_read_b128 v[236:239], v12 offset:16384
  s_add_u32 s28, s25, 16384
  s_add_u32 m0, s23, 16384
  s_nop 0
  buffer_load_dwordx4 v19, s[12:15], s28 offen offset:1024 lds
  v_mov_b32 v28, v27
  s_waitcnt lgkmcnt(5)
  v_mfma_f32_32x32x16_bf16 v[64:79], v[248:251], v[216:219], v[64:79]
  ds_read_b128 v[240:243], v13 offset:16384
  v_permlane32_swap_b32 v27, v28
  v_max_f32 v27, v27, v28
  v_cndmask_b32_e64 v27, v27, 0, s[34:35]
  v_sub_f32 v32, 0, v27
  v_sub_f32 v33, 0, v27
  s_waitcnt lgkmcnt(5)
  v_mfma_f32_32x32x16_bf16 v[64:79], v[252:255], v[220:223], v[64:79]
  ds_read_b128 v[244:247], v14 offset:16384
  v_sub_f32 v34, 0, v27
  v_sub_f32 v35, 0, v27
  v_sub_f32 v36, 0, v27
  v_sub_f32 v37, 0, v27
  v_sub_f32 v38, 0, v27
  v_sub_f32 v39, 0, v27
  v_sub_f32 v40, 0, v27
  v_sub_f32 v41, 0, v27
  v_sub_f32 v42, 0, v27
  v_sub_f32 v43, 0, v27
  v_sub_f32 v44, 0, v27
  v_sub_f32 v45, 0, v27
  v_sub_f32 v46, 0, v27
  v_sub_f32 v47, 0, v27
  s_waitcnt lgkmcnt(5)
  s_nop 0
  v_mfma_f32_32x32x16_bf16 v[80:95], v[224:227], v[192:195], v[32:47]
  ds_read_b128 v[248:251], v15 offset:16384
  s_cmp_eq_u32 s27, 1
  s_cbranch_scc1 K2_SIDE0
K2_BACK0:
  v_sub_f32 v48, v48, v27
  v_sub_f32 v49, v49, v27
  v_exp_f32 v48, v48
  s_waitcnt lgkmcnt(5)
  v_mfma_f32_32x32x16_bf16 v[80:95], v[228:231], v[196:199], v[80:95]
  ds_read_b128 v[252:255], v16 offset:16384
  v_exp_f32 v49, v49
  v_sub_f32 v50, v50, v27
  v_sub_f32 v51, v51, v27
  v_exp_f32 v50, v50
  s_waitcnt lgkmcnt(5)
  v_mfma_f32_32x32x16_bf16 v[80:95], v[232:235], v[200:203], v[80:95]
  ds_read_b128 v[224:227], v9 offset:24576
  v_exp_f32 v51, v51
  v_cvt_pk_bf16_f32 v96, v48, v49
  v_add_f32 v23, v23, v48
  v_add_f32 v24, v24, v49
  s_waitcnt lgkmcnt(5)
  v_mfma_f32_32x32x16_bf16 v[80:95], v[236:239], v[204:207], v[80:95]
  ds_read_b128 v[228:231], v10 offset:24576
  v_sub_f32 v52, v52, v27
  v_sub_f32 v53, v53, v27
  v_exp_f32 v52, v52
  v_exp_f32 v53, v53
  s_waitcnt lgkmcnt(5)
  v_mfma_f32_32x32x16_bf16 v[80:95], v[240:243], v[208:211], v[80:95]
  ds_read_b128 v[232:235], v11 offset:24576
  v_cvt_pk_bf16_f32 v97, v50, v51
  v_add_f32 v23, v23, v50
  v_add_f32 v24, v24, v51
  v_sub_f32 v54, v54, v27
  v_sub_f32 v55, v55, v27
  s_waitcnt lgkmcnt(5)
  v_mfma_f32_32x32x16_bf16 v[80:95], v[244:247], v[212:215], v[80:95]
  ds_read_b128 v[236:239], v12 offset:24576
  v_exp_f32 v54, v54
  v_exp_f32 v55, v55
  v_cvt_pk_bf16_f32 v98, v52, v53
  s_waitcnt lgkmcnt(5)
  v_mfma_f32_32x32x16_bf16 v[80:95], v[248:251], v[216:219], v[80:95]
  ds_read_b128 v[240:243], v13 offset:24576
  v_add_f32 v23, v23, v52
  v_add_f32 v24, v24, v53
  v_add_f32 v23, v23, v54
  v_cvt_pk_bf16_f32 v99, v54, v55
  v_add_f32 v24, v24, v55
  s_waitcnt lgkmcnt(5)
  v_mfma_f32_32x32x16_bf16 v[80:95], v[252:255], v[220:223], v[80:95]
  ds_read_b128 v[244:247], v14 offset:24576
  v_sub_f32 v56, v56, v27
  v_sub_f32 v57, v57, v27
  v_exp_f32 v56, v56
  v_exp_f32 v57, v57
  v_sub_f32 v58, v58, v27
  v_sub_f32 v59, v59, v27
  v_exp_f32 v58, v58
  v_exp_f32 v59, v59
  v_cvt_pk_bf16_f32 v100, v56, v57
  v_add_f32 v23, v23, v56
  v_add_f32 v24, v24, v57
  v_sub_f32 v60, v60, v27
  v_sub_f32 v61, v61, v27
  v_exp_f32 v60, v60
  v_exp_f32 v61, v61
  v_cvt_pk_bf16_f32 v101, v58, v59
  v_add_f32 v23, v23, v58
  v_add_f32 v24, v24, v59
  v_sub_f32 v62, v62, v27
  v_sub_f32 v63, v63, v27
  v_exp_f32 v62, v62
  v_exp_f32 v63, v63
  v_cvt_pk_bf16_f32 v102, v60, v61
  v_add_f32 v23, v23, v60
  v_add_f32 v24, v24, v61
  v_add_f32 v23, v23, v62
  v_cvt_pk_bf16_f32 v103, v62, v63
  v_add_f32 v24, v24, v63
  s_waitcnt lgkmcnt(5)
  v_mfma_f32_32x32x16_bf16 v[48:63], v[224:227], v[192:195], v[32:47]
  ds_read_b128 v[248:251], v15 offset:24576
  s_cmp_eq_u32 s27, 1
  s_cbranch_scc1 K2_SIDE1
K2_BACK1:
  v_sub_f32 v64, v64, v27
  v_sub_f32 v65, v65, v27
  v_exp_f32 v64, v64
  s_waitcnt lgkmcnt(5)
  v_mfma_f32_32x32x16_bf16 v[48:63], v[228:231], v[196:199], v[48:63]
  ds_read_b128 v[252:255], v16 offset:24576
  v_exp_f32 v65, v65
  v_sub_f32 v66, v66, v27
  v_sub_f32 v67, v67, v27
  v_exp_f32 v66, v66
  s_waitcnt lgkmcnt(5)
  v_mfma_f32_32x32x16_bf16 v[48:63], v[232:235], v[200:203], v[48:63]
  s_barrier
  ds_read_b64_tr_b16 v[224:225], v1 offset:0
  ds_read_b64_tr_b16 v[226:227], v1 offset:1024
  v_exp_f32 v67, v67
  v_cvt_pk_bf16_f32 v104, v64, v65
  v_add_f32 v23, v23, v64
  v_add_f32 v24, v24, v65
  s_waitcnt lgkmcnt(6)
  v_mfma_f32_32x32x16_bf16 v[48:63], v[236:239], v[204:207], v[48:63]
  ds_read_b64_tr_b16 v[228:229], v2 offset:0
  ds_read_b64_tr_b16 v[230:231], v2 offset:1024
  s_add_u32 s28, s25, 65536
  s_add_u32 m0, s23, 65536
  s_nop 0
  buffer_load_dwordx4 v20, s[8:11], s28 offen lds
  v_sub_f32 v68, v68, v27
  v_sub_f32 v69, v69, v27
  v_exp_f32 v68, v68
  s_waitcnt lgkmcnt(7)
  v_mfma_f32_32x32x16_bf16 v[48:63], v[240:243], v[208:211], v[48:63]
  ds_read_b64_tr_b16 v[232:233], v3 offset:0
  ds_read_b64_tr_b16 v[234:235], v3 offset:1024
  v_exp_f32 v69, v69
  v_cvt_pk_bf16_f32 v105, v66, v67
  v_add_f32 v23, v23, v66
  v_add_f32 v24, v24, v67
  s_waitcnt lgkmcnt(8)
  v_mfma_f32_32x32x16_bf16 v[48:63], v[244:247], v[212:215], v[48:63]
  ds_read_b64_tr_b16 v[236:237], v4 offset:0
  ds_read_b64_tr_b16 v[238:239], v4 offset:1024
  s_add_u32 s28, s25, 65536
  s_add_u32 m0, s23, 65536
  s_nop 0
  buffer_load_dwordx4 v21, s[8:11], s28 offen offset:1024 lds
  v_sub_f32 v70, v70, v27
  v_sub_f32 v71, v71, v27
  v_exp_f32 v70, v70
  s_waitcnt lgkmcnt(9)
  v_mfma_f32_32x32x16_bf16 v[48:63], v[248:251], v[216:219], v[48:63]
  ds_read_b64_tr_b16 v[240:241], v1 offset:4096
  ds_read_b64_tr_b16 v[242:243], v1 offset:5120
  v_exp_f32 v71, v71
  v_cvt_pk_bf16_f32 v106, v68, v69
  v_add_f32 v23, v23, v68
  v_add_f32 v24, v24, v69
  s_waitcnt lgkmcnt(10)
  v_mfma_f32_32x32x16_bf16 v[48:63], v[252:255], v[220:223], v[48:63]
  ds_read_b64_tr_b16 v[244:245], v2 offset:4096
  ds_read_b64_tr_b16 v[246:247], v2 offset:5120
  s_add_u32 s28, s25, 49152
  s_add_u32 m0, s23, 49152
  s_nop 0
  buffer_load_dwordx4 v19, s[12:15], s28 offen lds
  v_add_f32 v23, v23, v70
  v_cvt_pk_bf16_f32 v107, v70, v71
  v_add_f32 v24, v24, v71
  s_waitcnt lgkmcnt(10)
  v_mfma_f32_32x32x16_bf16 v[128:143], v[224:227], v[96:99], 0
  ds_read_b64_tr_b16 v[248:249], v3 offset:4096
  ds_read_b64_tr_b16 v[250:251], v3 offset:5120
  v_sub_f32 v72, v72, v27
  v_sub_f32 v73, v73, v27
  v_exp_f32 v72, v72
  v_exp_f32 v73, v73
  s_waitcnt lgkmcnt(10)
  v_mfma_f32_32x32x16_bf16 v[144:159], v[228:231], v[96:99], 0
  ds_read_b64_tr_b16 v[252:253], v4 offset:4096
  ds_read_b64_tr_b16 v[254:255], v4 offset:5120
  s_add_u32 s28, s25, 49152
  s_add_u32 m0, s23, 49152
  s_nop 0
  buffer_load_dwordx4 v19, s[12:15], s28 offen offset:1024 lds
  v_sub_f32 v74, v74, v27
  v_sub_f32 v75, v75, v27
  v_exp_f32 v74, v74
  s_waitcnt lgkmcnt(10)
  v_mfma_f32_32x32x16_bf16 v[160:175], v[232:235], v[96:99], 0
  ds_read_b64_tr_b16 v[224:225], v1 offset:8192
  ds_read_b64_tr_b16 v[226:227], v1 offset:9216
  v_exp_f32 v75, v75
  v_cvt_pk_bf16_f32 v108, v72, v73
  v_add_f32 v23, v23, v72
  v_add_f32 v24, v24, v73
  s_waitcnt lgkmcnt(10)
  v_mfma_f32_32x32x16_bf16 v[176:191], v[236:239], v[96:99], 0
  ds_read_b64_tr_b16 v[228:229], v2 offset:8192
  ds_read_b64_tr_b16 v[230:231], v2 offset:9216
  v_sub_f32 v76, v76, v27
  v_sub_f32 v77, v77, v27
  v_exp_f32 v76, v76
  v_exp_f32 v77, v77
  s_waitcnt lgkmcnt(10)
  v_mfma_f32_32x32x16_bf16 v[128:143], v[240:243], v[100:103], v[128:143]
  ds_read_b64_tr_b16 v[232:233], v3 offset:8192
  ds_read_b64_tr_b16 v[234:235], v3 offset:9216
  v_cvt_pk_bf16_f32 v109, v74, v75
  v_add_f32 v23, v23, v74
  v_add_f32 v24, v24, v75
  v_sub_f32 v78, v78, v27
  v_sub_f32 v79, v79, v27
  s_waitcnt lgkmcnt(10)
  v_mfma_f32_32x32x16_bf16 v[144:159], v[244:247], v[100:103], v[144:159]
  ds_read_b64_tr_b16 v[236:237], v4 offset:8192
  ds_read_b64_tr_b16 v[238:239], v4 offset:9216
  v_exp_f32 v78, v78
  v_exp_f32 v79, v79
  v_cvt_pk_bf16_f32 v110, v76, v77
  s_waitcnt lgkmcnt(10)
  v_mfma_f32_32x32x16_bf16 v[160:175], v[248:251], v[100:103], v[160:175]
  ds_read_b64_tr_b16 v[240:241], v1 offset:12288
  ds_read_b64_tr_b16 v[242:243], v1 offset:13312
  v_add_f32 v23, v23, v76
  v_add_f32 v24, v24, v77
  v_add_f32 v23, v23, v78
  v_cvt_pk_bf16_f32 v111, v78, v79
  v_add_f32 v24, v24, v79
  s_waitcnt lgkmcnt(10)
  v_mfma_f32_32x32x16_bf16 v[176:191], v[252:255], v[100:103], v[176:191]
  ds_read_b64_tr_b16 v[244:245], v2 offset:12288
  ds_read_b64_tr_b16 v[246:247], v2 offset:13312
  s_cmp_eq_u32 s27, 1
  s_cbranch_scc1 K2_SIDE2
K2_BACK2:
  v_exp_f32 v80, v80
  v_exp_f32 v81, v81
  s_waitcnt lgkmcnt(10)
  v_mfma_f32_32x32x16_bf16 v[128:143], v[224:227], v[104:107], v[128:143]
  ds_read_b64_tr_b16 v[248:249], v3 offset:12288
  ds_read_b64_tr_b16 v[250:251], v3 offset:13312
  v_exp_f32 v82, v82
  v_exp_f32 v83, v83
  v_cvt_pk_bf16_f32 v112, v80, v81
  s_waitcnt lgkmcnt(10)
  v_mfma_f32_32x32x16_bf16 v[144:159], v[228:231], v[104:107], v[144:159]
  ds_read_b64_tr_b16 v[252:253], v4 offset:12288
  ds_read_b64_tr_b16 v[254:255], v4 offset:13312
  v_add_f32 v23, v23, v80
  v_add_f32 v24, v24, v81
  v_exp_f32 v84, v84
  v_exp_f32 v85, v85
  s_waitcnt lgkmcnt(10)
  v_mfma_f32_32x32x16_bf16 v[160:175], v[232:235], v[104:107], v[160:175]
  s_waitcnt vmcnt(10)
  s_barrier
  ds_read_b128 v[224:227], v9 offset:32768
  v_cvt_pk_bf16_f32 v113, v82, v83
  v_add_f32 v23, v23, v82
  v_add_f32 v24, v24, v83
  v_exp_f32 v86, v86
  s_waitcnt lgkmcnt(9)
  v_mfma_f32_32x32x16_bf16 v[176:191], v[236:239], v[104:107], v[176:191]
  ds_read_b128 v[228:231], v10 offset:32768
  s_add_u32 s28, s25, 81920
  s_add_u32 m0, s23, 81920
  s_nop 0
  buffer_load_dwordx4 v20, s[8:11], s28 offen lds
  v_exp_f32 v87, v87
  v_cvt_pk_bf16_f32 v114, v84, v85
  s_waitcnt lgkmcnt(8)
  v_mfma_f32_32x32x16_bf16 v[128:143], v[240:243], v[108:111], v[128:143]
  ds_read_b128 v[232:235], v11 offset:32768
  v_add_f32 v23, v23, v84
  v_add_f32 v24, v24, v85
  v_add_f32 v23, v23, v86
  v_cvt_pk_bf16_f32 v115, v86, v87
  v_add_f32 v24, v24, v87
  s_waitcnt lgkmcnt(7)
  v_mfma_f32_32x32x16_bf16 v[144:159], v[244:247], v[108:111], v[144:159]
  ds_read_b128 v[236:239], v12 offset:32768
  s_add_u32 s28, s25, 81920
  s_add_u32 m0, s23, 81920
  s_nop 0
  buffer_load_dwordx4 v21, s[8:11], s28 offen offset:1024 lds
  v_exp_f32 v88, v88
  v_exp_f32 v89, v89
  s_waitcnt lgkmcnt(6)
  v_mfma_f32_32x32x16_bf16 v[160:175], v[248:251], v[108:111], v[160:175]
  ds_read_b128 v[240:243], v13 offset:32768
  v_exp_f32 v90, v90
  v_exp_f32 v91, v91
  v_cvt_pk_bf16_f32 v116, v88, v89
  s_waitcnt lgkmcnt(5)
  v_mfma_f32_32x32x16_bf16 v[176:191], v[252:255], v[108:111], v[176:191]
  ds_read_b128 v[244:247], v14 offset:32768
  v_add_f32 v23, v23, v88
  v_add_f32 v24, v24, v89
  v_exp_f32 v92, v92
  v_exp_f32 v93, v93
  s_waitcnt lgkmcnt(5)
  v_mfma_f32_32x32x16_bf16 v[64:79], v[224:227], v[192:195], v[32:47]
  ds_read_b128 v[248:251], v15 offset:32768
  v_cvt_pk_bf16_f32 v117, v90, v91
  v_add_f32 v23, v23, v90
  v_add_f32 v24, v24, v91
  v_exp_f32 v94, v94
  s_waitcnt lgkmcnt(5)
  v_mfma_f32_32x32x16_bf16 v[64:79], v[228:231], v[196:199], v[64:79]
  ds_read_b128 v[252:255], v16 offset:32768
  v_exp_f32 v95, v95
  v_cvt_pk_bf16_f32 v118, v92, v93
  v_add_f32 v23, v23, v92
  v_add_f32 v24, v24, v93
  s_waitcnt lgkmcnt(5)
  v_mfma_f32_32x32x16_bf16 v[64:79], v[232:235], v[200:203], v[64:79]
  ds_read_b128 v[224:227], v9 offset:40960
  v_add_f32 v23, v23, v94
  v_cvt_pk_bf16_f32 v119, v94, v95
  v_add_f32 v24, v24, v95
  s_cmp_eq_u32 s27, 1
  s_cbranch_scc1 K2_SIDE3
K2_BACK3:
  v_exp_f32 v48, v48
  s_waitcnt lgkmcnt(5)
  v_mfma_f32_32x32x16_bf16 v[64:79], v[236:239], v[204:207], v[64:79]
  ds_read_b128 v[228:231], v10 offset:40960
  v_exp_f32 v49, v49
  v_exp_f32 v50, v50
  v_exp_f32 v51, v51
  s_waitcnt lgkmcnt(5)
  v_mfma_f32_32x32x16_bf16 v[64:79], v[240:243], v[208:211], v[64:79]
  ds_read_b128 v[232:235], v11 offset:40960
  v_cvt_pk_bf16_f32 v120, v48, v49
  v_add_f32 v23, v23, v48
  v_add_f32 v24, v24, v49
  v_exp_f32 v52, v52
  s_waitcnt lgkmcnt(5)
  v_mfma_f32_32x32x16_bf16 v[64:79], v[244:247], v[212:215], v[64:79]
  ds_read_b128 v[236:239], v12 offset:40960
  v_exp_f32 v53, v53
  v_cvt_pk_bf16_f32 v121, v50, v51
  v_add_f32 v23, v23, v50
  v_add_f32 v24, v24, v51
  s_waitcnt lgkmcnt(5)
  v_mfma_f32_32x32x16_bf16 v[64:79], v[248:251], v[216:219], v[64:79]
  ds_read_b128 v[240:243], v13 offset:40960
  v_exp_f32 v54, v54
  v_exp_f32 v55, v55
  v_cvt_pk_bf16_f32 v122, v52, v53
  s_waitcnt lgkmcnt(5)
  v_mfma_f32_32x32x16_bf16 v[64:79], v[252:255], v[220:223], v[64:79]
  ds_read_b128 v[244:247], v14 offset:40960
  v_add_f32 v23, v23, v52
  v_add_f32 v24, v24, v53
  v_add_f32 v23, v23, v54
  v_cvt_pk_bf16_f32 v123, v54, v55
  v_add_f32 v24, v24, v55
  s_waitcnt lgkmcnt(5)
  v_mfma_f32_32x32x16_bf16 v[80:95], v[224:227], v[192:195], v[32:47]
  ds_read_b128 v[248:251], v15 offset:40960
  v_exp_f32 v56, v56
  v_exp_f32 v57, v57
  v_exp_f32 v58, v58
  s_waitcnt lgkmcnt(5)
  v_mfma_f32_32x32x16_bf16 v[80:95], v[228:231], v[196:199], v[80:95]
  ds_read_b128 v[252:255], v16 offset:40960
  v_exp_f32 v59, v59
  v_cvt_pk_bf16_f32 v124, v56, v57
  v_add_f32 v23, v23, v56
  v_add_f32 v24, v24, v57
  s_waitcnt lgkmcnt(5)
  v_mfma_f32_32x32x16_bf16 v[80:95], v[232:235], v[200:203], v[80:95]
  s_waitcnt vmcnt(6)
  s_barrier
  ds_read_b64_tr_b16 v[224:225], v1 offset:16384
  ds_read_b64_tr_b16 v[226:227], v1 offset:17408
  v_exp_f32 v60, v60
  v_exp_f32 v61, v61
  v_cvt_pk_bf16_f32 v125, v58, v59
  s_waitcnt lgkmcnt(6)
  v_mfma_f32_32x32x16_bf16 v[80:95], v[236:239], v[204:207], v[80:95]
  ds_read_b64_tr_b16 v[228:229], v2 offset:16384
  ds_read_b64_tr_b16 v[230:231], v2 offset:17408
  s_add_u32 s28, s25, 65536
  s_add_u32 m0, s23, 0
  s_nop 0
  buffer_load_dwordx4 v19, s[12:15], s28 offen lds
  v_add_f32 v23, v23, v58
  v_add_f32 v24, v24, v59
  v_exp_f32 v62, v62
  s_waitcnt lgkmcnt(7)
  v_mfma_f32_32x32x16_bf16 v[80:95], v[240:243], v[208:211], v[80:95]
  ds_read_b64_tr_b16 v[232:233], v3 offset:16384
  ds_read_b64_tr_b16 v[234:235], v3 offset:17408
  v_exp_f32 v63, v63
  v_cvt_pk_bf16_f32 v126, v60, v61
  v_add_f32 v23, v23, v60
  v_add_f32 v24, v24, v61
  s_waitcnt lgkmcnt(8)
  v_mfma_f32_32x32x16_bf16 v[80:95], v[244:247], v[212:215], v[80:95]
  ds_read_b64_tr_b16 v[236:237], v4 offset:16384
  ds_read_b64_tr_b16 v[238:239], v4 offset:17408
  s_add_u32 s28, s25, 65536
  s_add_u32 m0, s23, 0
  s_nop 0
  buffer_load_dwordx4 v19, s[12:15], s28 offen offset:1024 lds
  v_add_f32 v23, v23, v62
  v_cvt_pk_bf16_f32 v127, v62, v63
  v_add_f32 v24, v24, v63
  s_waitcnt lgkmcnt(9)
  v_mfma_f32_32x32x16_bf16 v[80:95], v[248:251], v[216:219], v[80:95]
  ds_read_b64_tr_b16 v[240:241], v1 offset:20480
  ds_read_b64_tr_b16 v[242:243], v1 offset:21504
  s_cmp_eq_u32 s27, 1
  s_cbranch_scc1 K2_SIDE4
K2_BACK4:
  v_exp_f32 v64, v64
  v_exp_f32 v65, v65
  s_waitcnt lgkmcnt(10)
  v_mfma_f32_32x32x16_bf16 v[80:95], v[252:255], v[220:223], v[80:95]
  ds_read_b64_tr_b16 v[244:245], v2 offset:20480
  ds_read_b64_tr_b16 v[246:247], v2 offset:21504
  v_exp_f32 v66, v66
  v_exp_f32 v67, v67
  v_cvt_pk_bf16_f32 v96, v64, v65
  s_waitcnt lgkmcnt(10)
  v_mfma_f32_32x32x16_bf16 v[128:143], v[224:227], v[112:115], v[128:143]
  ds_read_b64_tr_b16 v[248:249], v3 offset:20480
  ds_read_b64_tr_b16 v[250:251], v3 offset:21504
  v_add_f32 v23, v23, v64
  v_add_f32 v24, v24, v65
  v_exp_f32 v68, v68
  v_exp_f32 v69, v69
  s_waitcnt lgkmcnt(10)
  v_mfma_f32_32x32x16_bf16 v[144:159], v[228:231], v[112:115], v[144:159]
  ds_read_b64_tr_b16 v[252:253], v4 offset:20480
  ds_read_b64_tr_b16 v[254:255], v4 offset:21504
  v_cvt_pk_bf16_f32 v97, v66, v67
  v_add_f32 v23, v23, v66
  v_add_f32 v24, v24, v67
  v_exp_f32 v70, v70
  s_waitcnt lgkmcnt(10)
  v_mfma_f32_32x32x16_bf16 v[160:175], v[232:235], v[112:115], v[160:175]
  ds_read_b64_tr_b16 v[224:225], v1 offset:24576
  ds_read_b64_tr_b16 v[226:227], v1 offset:25600
  v_exp_f32 v71, v71
  v_cvt_pk_bf16_f32 v98, v68, v69
  v_add_f32 v23, v23, v68
  v_add_f32 v24, v24, v69
  s_waitcnt lgkmcnt(10)
  v_mfma_f32_32x32x16_bf16 v[176:191], v[236:239], v[112:115], v[176:191]
  ds_read_b64_tr_b16 v[228:229], v2 offset:24576
  ds_read_b64_tr_b16 v[230:231], v2 offset:25600
  v_add_f32 v23, v23, v70
  v_cvt_pk_bf16_f32 v99, v70, v71
  v_add_f32 v24, v24, v71
  v_exp_f32 v72, v72
  s_waitcnt lgkmcnt(10)
  v_mfma_f32_32x32x16_bf16 v[128:143], v[240:243], v[116:119], v[128:143]
  ds_read_b64_tr_b16 v[232:233], v3 offset:24576
  ds_read_b64_tr_b16 v[234:235], v3 offset:25600
  v_exp_f32 v73, v73
  v_exp_f32 v74, v74
  v_exp_f32 v75, v75
  s_waitcnt lgkmcnt(10)
  v_mfma_f32_32x32x16_bf16 v[144:159], v[244:247], v[116:119], v[144:159]
  ds_read_b64_tr_b16 v[236:237], v4 offset:24576
  ds_read_b64_tr_b16 v[238:239], v4 offset:25600
  v_cvt_pk_bf16_f32 v100, v72, v73
  v_add_f32 v23, v23, v72
  v_add_f32 v24, v24, v73
  v_exp_f32 v76, v76
  s_waitcnt lgkmcnt(10)
  v_mfma_f32_32x32x16_bf16 v[160:175], v[248:251], v[116:119], v[160:175]
  ds_read_b64_tr_b16 v[240:241], v1 offset:28672
  ds_read_b64_tr_b16 v[242:243], v1 offset:29696
  v_exp_f32 v77, v77
  v_cvt_pk_bf16_f32 v101, v74, v75
  v_add_f32 v23, v23, v74
  v_add_f32 v24, v24, v75
  s_waitcnt lgkmcnt(10)
  v_mfma_f32_32x32x16_bf16 v[176:191], v[252:255], v[116:119], v[176:191]
  ds_read_b64_tr_b16 v[244:245], v2 offset:28672
  ds_read_b64_tr_b16 v[246:247], v2 offset:29696
  v_exp_f32 v78, v78
  v_exp_f32 v79, v79
  v_cvt_pk_bf16_f32 v102, v76, v77
  s_waitcnt lgkmcnt(10)
  v_mfma_f32_32x32x16_bf16 v[128:143], v[224:227], v[120:123], v[128:143]
  ds_read_b64_tr_b16 v[248:249], v3 offset:28672
  ds_read_b64_tr_b16 v[250:251], v3 offset:29696
  v_add_f32 v23, v23, v76
  v_add_f32 v24, v24, v77
  v_add_f32 v23, v23, v78
  v_cvt_pk_bf16_f32 v103, v78, v79
  v_add_f32 v24, v24, v79
  s_waitcnt lgkmcnt(10)
  v_mfma_f32_32x32x16_bf16 v[144:159], v[228:231], v[120:123], v[144:159]
  ds_read_b64_tr_b16 v[252:253], v4 offset:28672
  ds_read_b64_tr_b16 v[254:255], v4 offset:29696
  s_cmp_eq_u32 s27, 1
  s_cbranch_scc1 K2_SIDE5
K2_BACK5:
  v_exp_f32 v80, v80
  v_exp_f32 v81, v81
  s_waitcnt lgkmcnt(10)
  v_mfma_f32_32x32x16_bf16 v[160:175], v[232:235], v[120:123], v[160:175]
  s_barrier
  ds_read_b128 v[224:227], v9 offset:49152
  v_exp_f32 v82, v82
  v_exp_f32 v83, v83
  v_cvt_pk_bf16_f32 v104, v80, v81
  s_waitcnt lgkmcnt(9)
  v_mfma_f32_32x32x16_bf16 v[176:191], v[236:239], v[120:123], v[176:191]
  ds_read_b128 v[228:231], v10 offset:49152
  s_add_u32 s28, s25, 98304
  s_add_u32 m0, s23, 98304
  s_nop 0
  buffer_load_dwordx4 v20, s[8:11], s28 offen lds
  v_add_f32 v23, v23, v80
  v_add_f32 v24, v24, v81
  v_exp_f32 v84, v84
  s_waitcnt lgkmcnt(8)
  v_mfma_f32_32x32x16_bf16 v[128:143], v[240:243], v[124:127], v[128:143]
  ds_read_b128 v[232:235], v11 offset:49152
  v_exp_f32 v85, v85
  v_cvt_pk_bf16_f32 v105, v82, v83
  v_add_f32 v23, v23, v82
  v_add_f32 v24, v24, v83
  s_waitcnt lgkmcnt(7)
  v_mfma_f32_32x32x16_bf16 v[144:159], v[244:247], v[124:127], v[144:159]
  ds_read_b128 v[236:239], v12 offset:49152
  s_add_u32 s28, s25, 98304
  s_add_u32 m0, s23, 98304
  s_nop 0
  buffer_load_dwordx4 v21, s[8:11], s28 offen offset:1024 lds
  v_exp_f32 v86, v86
  v_exp_f32 v87, v87
  s_waitcnt lgkmcnt(6)
  v_mfma_f32_32x32x16_bf16 v[160:175], v[248:251], v[124:127], v[160:175]
  ds_read_b128 v[240:243], v13 offset:49152
  v_cvt_pk_bf16_f32 v106, v84, v85
  v_add_f32 v23, v23, v84
  v_add_f32 v24, v24, v85
  v_add_f32 v23, v23, v86
  v_cvt_pk_bf16_f32 v107, v86, v87
  s_waitcnt lgkmcnt(5)
  v_mfma_f32_32x32x16_bf16 v[176:191], v[252:255], v[124:127], v[176:191]
  ds_read_b128 v[244:247], v14 offset:49152
  v_add_f32 v24, v24, v87
  v_exp_f32 v88, v88
  v_exp_f32 v89, v89
  s_waitcnt lgkmcnt(5)
  v_mfma_f32_32x32x16_bf16 v[48:63], v[224:227], v[192:195], v[32:47]
  ds_read_b128 v[248:251], v15 offset:49152
  v_exp_f32 v90, v90
  v_exp_f32 v91, v91
  v_cvt_pk_bf16_f32 v108, v88, v89
  s_waitcnt lgkmcnt(5)
  v_mfma_f32_32x32x16_bf16 v[48:63], v[228:231], v[196:199], v[48:63]
  ds_read_b128 v[252:255], v16 offset:49152
  v_add_f32 v23, v23, v88
  v_add_f32 v24, v24, v89
  v_exp_f32 v92, v92
  v_exp_f32 v93, v93
  s_waitcnt lgkmcnt(5)
  v_mfma_f32_32x32x16_bf16 v[48:63], v[232:235], v[200:203], v[48:63]
  ds_read_b128 v[224:227], v9 offset:57344
  v_cvt_pk_bf16_f32 v109, v90, v91
  v_add_f32 v23, v23, v90
  v_add_f32 v24, v24, v91
  v_exp_f32 v94, v94
  s_waitcnt lgkmcnt(5)
  v_mfma_f32_32x32x16_bf16 v[48:63], v[236:239], v[204:207], v[48:63]
  ds_read_b128 v[228:231], v10 offset:57344
  v_exp_f32 v95, v95
  v_cvt_pk_bf16_f32 v110, v92, v93
  v_add_f32 v23, v23, v92
  v_add_f32 v24, v24, v93
  s_waitcnt lgkmcnt(5)
  v_mfma_f32_32x32x16_bf16 v[48:63], v[240:243], v[208:211], v[48:63]
  ds_read_b128 v[232:235], v11 offset:57344
  v_add_f32 v23, v23, v94
  v_cvt_pk_bf16_f32 v111, v94, v95
  v_add_f32 v24, v24, v95
  s_waitcnt lgkmcnt(5)
  v_mfma_f32_32x32x16_bf16 v[48:63], v[244:247], v[212:215], v[48:63]
  ds_read_b128 v[236:239], v12 offset:57344
  s_waitcnt lgkmcnt(5)
  v_mfma_f32_32x32x16_bf16 v[48:63], v[248:251], v[216:219], v[48:63]
  ds_read_b128 v[240:243], v13 offset:57344
  s_waitcnt lgkmcnt(5)
  v_mfma_f32_32x32x16_bf16 v[48:63], v[252:255], v[220:223], v[48:63]
  ds_read_b128 v[244:247], v14 offset:57344
  s_waitcnt lgkmcnt(5)
  v_mfma_f32_32x32x16_bf16 v[64:79], v[224:227], v[192:195], v[32:47]
  ds_read_b128 v[248:251], v15 offset:57344
  s_cmp_eq_u32 s27, 1
  s_cbranch_scc1 K2_SIDE6
K2_BACK6:
  s_waitcnt lgkmcnt(5)
  v_mfma_f32_32x32x16_bf16 v[64:79], v[228:231], v[196:199], v[64:79]
  ds_read_b128 v[252:255], v16 offset:57344
  s_waitcnt lgkmcnt(5)
  v_mfma_f32_32x32x16_bf16 v[64:79], v[232:235], v[200:203], v[64:79]
  s_barrier
  ds_read_b64_tr_b16 v[224:225], v1 offset:32768
  ds_read_b64_tr_b16 v[226:227], v1 offset:33792
  v_exp_f32 v48, v48
  v_exp_f32 v49, v49
  v_exp_f32 v50, v50
  s_waitcnt lgkmcnt(6)
  v_mfma_f32_32x32x16_bf16 v[64:79], v[236:239], v[204:207], v[64:79]
  ds_read_b64_tr_b16 v[228:229], v2 offset:32768
  ds_read_b64_tr_b16 v[230:231], v2 offset:33792
  s_add_u32 s28, s25, 81920
  s_add_u32 m0, s23, 16384
  s_nop 0
  buffer_load_dwordx4 v19, s[12:15], s28 offen lds
  v_exp_f32 v51, v51
  v_cvt_pk_bf16_f32 v112, v48, v49
  s_waitcnt lgkmcnt(7)
  v_mfma_f32_32x32x16_bf16 v[64:79], v[240:243], v[208:211], v[64:79]
  ds_read_b64_tr_b16 v[232:233], v3 offset:32768
  ds_read_b64_tr_b16 v[234:235], v3 offset:33792
  v_add_f32 v23, v23, v48
  v_add_f32 v24, v24, v49
  v_exp_f32 v52, v52
  v_exp_f32 v53, v53
  s_waitcnt lgkmcnt(8)
  v_mfma_f32_32x32x16_bf16 v[64:79], v[244:247], v[212:215], v[64:79]
  ds_read_b64_tr_b16 v[236:237], v4 offset:32768
  ds_read_b64_tr_b16 v[238:239], v4 offset:33792
  s_add_u32 s28, s25, 81920
  s_add_u32 m0, s23, 16384
  s_nop 0
  buffer_load_dwordx4 v19, s[12:15], s28 offen offset:1024 lds
  v_cvt_pk_bf16_f32 v113, v50, v51
  v_add_f32 v23, v23, v50
  v_add_f32 v24, v24, v51
  s_waitcnt lgkmcnt(9)
  v_mfma_f32_32x32x16_bf16 v[64:79], v[248:251], v[216:219], v[64:79]
  ds_read_b64_tr_b16 v[240:241], v1 offset:36864
  ds_read_b64_tr_b16 v[242:243], v1 offset:37888
  v_exp_f32 v54, v54
  v_exp_f32 v55, v55
  v_cvt_pk_bf16_f32 v114, v52, v53
  s_waitcnt lgkmcnt(10)
  v_mfma_f32_32x32x16_bf16 v[64:79], v[252:255], v[220:223], v[64:79]
  ds_read_b64_tr_b16 v[244:245], v2 offset:36864
  ds_read_b64_tr_b16 v[246:247], v2 offset:37888
  v_add_f32 v23, v23, v52
  v_add_f32 v24, v24, v53
  v_add_f32 v23, v23, v54
  v_cvt_pk_bf16_f32 v115, v54, v55
  v_add_f32 v24, v24, v55
  s_waitcnt lgkmcnt(10)
  v_mfma_f32_32x32x16_bf16 v[128:143], v[224:227], v[96:99], v[128:143]
  ds_read_b64_tr_b16 v[248:249], v3 offset:36864
  ds_read_b64_tr_b16 v[250:251], v3 offset:37888
  v_exp_f32 v56, v56
  v_exp_f32 v57, v57
  v_exp_f32 v58, v58
  s_waitcnt lgkmcnt(10)
  v_mfma_f32_32x32x16_bf16 v[144:159], v[228:231], v[96:99], v[144:159]
  ds_read_b64_tr_b16 v[252:253], v4 offset:36864
  ds_read_b64_tr_b16 v[254:255], v4 offset:37888
  v_exp_f32 v59, v59
  v_cvt_pk_bf16_f32 v116, v56, v57
  v_add_f32 v23, v23, v56
  v_add_f32 v24, v24, v57
  s_waitcnt lgkmcnt(10)
  v_mfma_f32_32x32x16_bf16 v[160:175], v[232:235], v[96:99], v[160:175]
  ds_read_b64_tr_b16 v[224:225], v1 offset:40960
  ds_read_b64_tr_b16 v[226:227], v1 offset:41984
  v_exp_f32 v60, v60
  v_exp_f32 v61, v61
  v_cvt_pk_bf16_f32 v117, v58, v59
  s_waitcnt lgkmcnt(10)
  v_mfma_f32_32x32x16_bf16 v[176:191], v[236:239], v[96:99], v[176:191]
  ds_read_b64_tr_b16 v[228:229], v2 offset:40960
  ds_read_b64_tr_b16 v[230:231], v2 offset:41984
  v_add_f32 v23, v23, v58
  v_add_f32 v24, v24, v59
  v_exp_f32 v62, v62
  v_exp_f32 v63, v63
  s_waitcnt lgkmcnt(10)
  v_mfma_f32_32x32x16_bf16 v[128:143], v[240:243], v[100:103], v[128:143]
  ds_read_b64_tr_b16 v[232:233], v3 offset:40960
  ds_read_b64_tr_b16 v[234:235], v3 offset:41984
  v_cvt_pk_bf16_f32 v118, v60, v61
  v_add_f32 v23, v23, v60
  v_add_f32 v24, v24, v61
  v_add_f32 v23, v23, v62
  v_cvt_pk_bf16_f32 v119, v62, v63
  s_waitcnt lgkmcnt(10)
  v_mfma_f32_32x32x16_bf16 v[144:159], v[244:247], v[100:103], v[144:159]
  ds_read_b64_tr_b16 v[236:237], v4 offset:40960
  ds_read_b64_tr_b16 v[238:239], v4 offset:41984
  v_add_f32 v24, v24, v63
  s_cmp_eq_u32 s27, 1
  s_cbranch_scc1 K2_SIDE7
K2_BACK7:
  v_exp_f32 v64, v64
  v_exp_f32 v65, v65
  s_waitcnt lgkmcnt(10)
  v_mfma_f32_32x32x16_bf16 v[160:175], v[248:251], v[100:103], v[160:175]
  ds_read_b64_tr_b16 v[240:241], v1 offset:45056
  ds_read_b64_tr_b16 v[242:243], v1 offset:46080
  v_exp_f32 v66, v66
  v_exp_f32 v67, v67
  v_cvt_pk_bf16_f32 v120, v64, v65
  s_waitcnt lgkmcnt(10)
  v_mfma_f32_32x32x16_bf16 v[176:191], v[252:255], v[100:103], v[176:191]
  ds_read_b64_tr_b16 v[244:245], v2 offset:45056
  ds_read_b64_tr_b16 v[246:247], v2 offset:46080
  v_add_f32 v23, v23, v64
  v_add_f32 v24, v24, v65
  v_exp_f32 v68, v68
  v_exp_f32 v69, v69
  s_waitcnt lgkmcnt(10)
  v_mfma_f32_32x32x16_bf16 v[128:143], v[224:227], v[104:107], v[128:143]
  ds_read_b64_tr_b16 v[248:249], v3 offset:45056
  ds_read_b64_tr_b16 v[250:251], v3 offset:46080
  v_cvt_pk_bf16_f32 v121, v66, v67
  v_add_f32 v23, v23, v66
  v_add_f32 v24, v24, v67
  v_exp_f32 v70, v70
  s_waitcnt lgkmcnt(10)
  v_mfma_f32_32x32x16_bf16 v[144:159], v[228:231], v[104:107], v[144:159]
  ds_read_b64_tr_b16 v[252:253], v4 offset:45056
  ds_read_b64_tr_b16 v[254:255], v4 offset:46080
  v_exp_f32 v71, v71
  v_cvt_pk_bf16_f32 v122, v68, v69
  v_add_f32 v23, v23, v68
  v_add_f32 v24, v24, v69
  s_waitcnt lgkmcnt(10)
  v_mfma_f32_32x32x16_bf16 v[160:175], v[232:235], v[104:107], v[160:175]
  s_waitcnt vmcnt(10)
  s_barrier
  ds_read_b128 v[224:227], v9 offset:0
  v_add_f32 v23, v23, v70
  v_cvt_pk_bf16_f32 v123, v70, v71
  v_add_f32 v24, v24, v71
  v_exp_f32 v72, v72
  s_waitcnt lgkmcnt(9)
  v_mfma_f32_32x32x16_bf16 v[176:191], v[236:239], v[104:107], v[176:191]
  ds_read_b128 v[228:231], v10 offset:0
  s_add_u32 s28, s25, 114688
  s_add_u32 m0, s23, 114688
  s_nop 0
  buffer_load_dwordx4 v20, s[8:11], s28 offen lds
  v_exp_f32 v73, v73
  v_exp_f32 v74, v74
  s_waitcnt lgkmcnt(8)
  v_mfma_f32_32x32x16_bf16 v[128:143], v[240:243], v[108:111], v[128:143]
  ds_read_b128 v[232:235], v11 offset:0
  v_exp_f32 v75, v75
  v_cvt_pk_bf16_f32 v124, v72, v73
  v_add_f32 v23, v23, v72
  v_add_f32 v24, v24, v73
  s_waitcnt lgkmcnt(7)
  v_mfma_f32_32x32x16_bf16 v[144:159], v[244:247], v[108:111], v[144:159]
  ds_read_b128 v[236:239], v12 offset:0
  s_add_u32 s28, s25, 114688
  s_add_u32 m0, s23, 114688
  s_nop 0
  buffer_load_dwordx4 v21, s[8:11], s28 offen offset:1024 lds
  v_exp_f32 v76, v76
  v_exp_f32 v77, v77
  s_waitcnt lgkmcnt(6)
  v_mfma_f32_32x32x16_bf16 v[160:175], v[248:251], v[108:111], v[160:175]
  ds_read_b128 v[240:243], v13 offset:0
  v_cvt_pk_bf16_f32 v125, v74, v75
  v_add_f32 v23, v23, v74
  v_add_f32 v24, v24, v75
  v_exp_f32 v78, v78
  s_waitcnt lgkmcnt(5)
  v_mfma_f32_32x32x16_bf16 v[176:191], v[252:255], v[108:111], v[176:191]
  ds_read_b128 v[244:247], v14 offset:0
  v_exp_f32 v79, v79
  v_cvt_pk_bf16_f32 v126, v76, v77
  v_add_f32 v23, v23, v76
  v_add_f32 v24, v24, v77
  s_waitcnt lgkmcnt(5)
  v_mfma_f32_32x32x16_bf16 v[80:95], v[224:227], v[192:195], v[32:47]
  ds_read_b128 v[248:251], v15 offset:0
  v_add_f32 v23, v23, v78
  v_cvt_pk_bf16_f32 v127, v78, v79
  v_add_f32 v24, v24, v79
  s_waitcnt lgkmcnt(5)
  v_mfma_f32_32x32x16_bf16 v[80:95], v[228:231], v[196:199], v[80:95]
  ds_read_b128 v[252:255], v16 offset:0
  s_waitcnt lgkmcnt(5)
  v_mfma_f32_32x32x16_bf16 v[80:95], v[232:235], v[200:203], v[80:95]
  ds_read_b128 v[224:227], v9 offset:8192
  s_waitcnt lgkmcnt(5)
  v_mfma_f32_32x32x16_bf16 v[80:95], v[236:239], v[204:207], v[80:95]
  ds_read_b128 v[228:231], v10 offset:8192
  s_waitcnt lgkmcnt(5)
  v_mfma_f32_32x32x16_bf16 v[80:95], v[240:243], v[208:211], v[80:95]
  ds_read_b128 v[232:235], v11 offset:8192
  s_waitcnt lgkmcnt(5)
  v_mfma_f32_32x32x16_bf16 v[80:95], v[244:247], v[212:215], v[80:95]
  ds_read_b128 v[236:239], v12 offset:8192
  s_waitcnt lgkmcnt(5)
  v_mfma_f32_32x32x16_bf16 v[80:95], v[248:251], v[216:219], v[80:95]
  ds_read_b128 v[240:243], v13 offset:8192
  s_waitcnt lgkmcnt(5)
  v_mfma_f32_32x32x16_bf16 v[80:95], v[252:255], v[220:223], v[80:95]
  ds_read_b128 v[244:247], v14 offset:8192
  s_waitcnt lgkmcnt(5)
  v_mfma_f32_32x32x16_bf16 v[48:63], v[224:227], v[192:195], v[32:47]
  ds_read_b128 v[248:251], v15 offset:8192
  s_cmp_eq_u32 s27, 1
  s_cbranch_scc1 K2_SIDE8
K2_BACK8:
  s_waitcnt lgkmcnt(5)
  v_mfma_f32_32x32x16_bf16 v[48:63], v[228:231], v[196:199], v[48:63]
  ds_read_b128 v[252:255], v16 offset:8192
  s_waitcnt lgkmcnt(5)
  v_mfma_f32_32x32x16_bf16 v[48:63], v[232:235], v[200:203], v[48:63]
  s_waitcnt vmcnt(10)
  s_barrier
  ds_read_b64_tr_b16 v[224:225], v1 offset:49152
  ds_read_b64_tr_b16 v[226:227], v1 offset:50176
  v_exp_f32 v80, v80
  v_exp_f32 v81, v81
  v_exp_f32 v82, v82
  s_waitcnt lgkmcnt(6)
  v_mfma_f32_32x32x16_bf16 v[48:63], v[236:239], v[204:207], v[48:63]
  ds_read_b64_tr_b16 v[228:229], v2 offset:49152
  ds_read_b64_tr_b16 v[230:231], v2 offset:50176
  s_add_u32 s28, s25, 98304
  s_add_u32 m0, s23, 32768
  s_nop 0
  buffer_load_dwordx4 v19, s[12:15], s28 offen lds
  v_exp_f32 v83, v83
  v_cvt_pk_bf16_f32 v96, v80, v81
  s_waitcnt lgkmcnt(7)
  v_mfma_f32_32x32x16_bf16 v[48:63], v[240:243], v[208:211], v[48:63]
  ds_read_b64_tr_b16 v[232:233], v3 offset:49152
  ds_read_b64_tr_b16 v[234:235], v3 offset:50176
  v_add_f32 v23, v23, v80
  v_add_f32 v24, v24, v81
  v_exp_f32 v84, v84
  v_exp_f32 v85, v85
  s_waitcnt lgkmcnt(8)
  v_mfma_f32_32x32x16_bf16 v[48:63], v[244:247], v[212:215], v[48:63]
  ds_read_b64_tr_b16 v[236:237], v4 offset:49152
  ds_read_b64_tr_b16 v[238:239], v4 offset:50176
  s_add_u32 s28, s25, 98304
  s_add_u32 m0, s23, 32768
  s_nop 0
  buffer_load_dwordx4 v19, s[12:15], s28 offen offset:1024 lds
  v_cvt_pk_bf16_f32 v97, v82, v83
  v_add_f32 v23, v23, v82
  v_add_f32 v24, v24, v83
  s_waitcnt lgkmcnt(9)
  v_mfma_f32_32x32x16_bf16 v[48:63], v[248:251], v[216:219], v[48:63]
  ds_read_b64_tr_b16 v[240:241], v1 offset:53248
  ds_read_b64_tr_b16 v[242:243], v1 offset:54272
  v_exp_f32 v86, v86
  v_exp_f32 v87, v87
  v_cvt_pk_bf16_f32 v98, v84, v85
  s_waitcnt lgkmcnt(10)
  v_mfma_f32_32x32x16_bf16 v[48:63], v[252:255], v[220:223], v[48:63]
  ds_read_b64_tr_b16 v[244:245], v2 offset:53248
  ds_read_b64_tr_b16 v[246:247], v2 offset:54272
  v_add_f32 v23, v23, v84
  v_add_f32 v24, v24, v85
  v_add_f32 v23, v23, v86
  v_cvt_pk_bf16_f32 v99, v86, v87
  v_add_f32 v24, v24, v87
  s_waitcnt lgkmcnt(10)
  v_mfma_f32_32x32x16_bf16 v[128:143], v[224:227], v[112:115], v[128:143]
  ds_read_b64_tr_b16 v[248:249], v3 offset:53248
  ds_read_b64_tr_b16 v[250:251], v3 offset:54272
  v_exp_f32 v88, v88
  v_exp_f32 v89, v89
  v_exp_f32 v90, v90
  s_waitcnt lgkmcnt(10)
  v_mfma_f32_32x32x16_bf16 v[144:159], v[228:231], v[112:115], v[144:159]
  ds_read_b64_tr_b16 v[252:253], v4 offset:53248
  ds_read_b64_tr_b16 v[254:255], v4 offset:54272
  v_exp_f32 v91, v91
  v_cvt_pk_bf16_f32 v100, v88, v89
  v_add_f32 v23, v23, v88
  v_add_f32 v24, v24, v89
  s_waitcnt lgkmcnt(10)
  v_mfma_f32_32x32x16_bf16 v[160:175], v[232:235], v[112:115], v[160:175]
  ds_read_b64_tr_b16 v[224:225], v1 offset:57344
  ds_read_b64_tr_b16 v[226:227], v1 offset:58368
  v_exp_f32 v92, v92
  v_exp_f32 v93, v93
  v_cvt_pk_bf16_f32 v101, v90, v91
  s_waitcnt lgkmcnt(10)
  v_mfma_f32_32x32x16_bf16 v[176:191], v[236:239], v[112:115], v[176:191]
  ds_read_b64_tr_b16 v[228:229], v2 offset:57344
  ds_read_b64_tr_b16 v[230:231], v2 offset:58368
  v_add_f32 v23, v23, v90
  v_add_f32 v24, v24, v91
  v_exp_f32 v94, v94
  v_exp_f32 v95, v95
  s_waitcnt lgkmcnt(10)
  v_mfma_f32_32x32x16_bf16 v[128:143], v[240:243], v[116:119], v[128:143]
  ds_read_b64_tr_b16 v[232:233], v3 offset:57344
  ds_read_b64_tr_b16 v[234:235], v3 offset:58368
  v_cvt_pk_bf16_f32 v102, v92, v93
  v_add_f32 v23, v23, v92
  v_add_f32 v24, v24, v93
  v_add_f32 v23, v23, v94
  v_cvt_pk_bf16_f32 v103, v94, v95
  s_waitcnt lgkmcnt(10)
  v_mfma_f32_32x32x16_bf16 v[144:159], v[244:247], v[116:119], v[144:159]
  ds_read_b64_tr_b16 v[236:237], v4 offset:57344
  ds_read_b64_tr_b16 v[238:239], v4 offset:58368
  v_add_f32 v24, v24, v95
  s_cmp_eq_u32 s27, 1
  s_cbranch_scc1 K2_SIDE9
K2_BACK9:
  v_exp_f32 v48, v48
  v_exp_f32 v49, v49
  s_waitcnt lgkmcnt(10)
  v_mfma_f32_32x32x16_bf16 v[160:175], v[248:251], v[116:119], v[160:175]
  ds_read_b64_tr_b16 v[240:241], v1 offset:61440
  ds_read_b64_tr_b16 v[242:243], v1 offset:62464
  v_exp_f32 v50, v50
  v_exp_f32 v51, v51
  v_cvt_pk_bf16_f32 v104, v48, v49
  s_waitcnt lgkmcnt(10)
  v_mfma_f32_32x32x16_bf16 v[176:191], v[252:255], v[116:119], v[176:191]
  ds_read_b64_tr_b16 v[244:245], v2 offset:61440
  ds_read_b64_tr_b16 v[246:247], v2 offset:62464
  v_add_f32 v23, v23, v48
  v_add_f32 v24, v24, v49
  v_exp_f32 v52, v52
  v_exp_f32 v53, v53
  s_waitcnt lgkmcnt(10)
  v_mfma_f32_32x32x16_bf16 v[128:143], v[224:227], v[120:123], v[128:143]
  ds_read_b64_tr_b16 v[248:249], v3 offset:61440
  ds_read_b64_tr_b16 v[250:251], v3 offset:62464
  v_cvt_pk_bf16_f32 v105, v50, v51
  v_add_f32 v23, v23, v50
  v_add_f32 v24, v24, v51
  v_exp_f32 v54, v54
  s_waitcnt lgkmcnt(10)
  v_mfma_f32_32x32x16_bf16 v[144:159], v[228:231], v[120:123], v[144:159]
  ds_read_b64_tr_b16 v[252:253], v4 offset:61440
  ds_read_b64_tr_b16 v[254:255], v4 offset:62464
  v_exp_f32 v55, v55
  v_cvt_pk_bf16_f32 v106, v52, v53
  v_add_f32 v23, v23, v52
  v_add_f32 v24, v24, v53
  s_waitcnt lgkmcnt(10)
  v_mfma_f32_32x32x16_bf16 v[160:175], v[232:235], v[120:123], v[160:175]
  s_waitcnt vmcnt(10)
  s_barrier
  ds_read_b128 v[224:227], v9 offset:16384
  v_add_f32 v23, v23, v54
  v_cvt_pk_bf16_f32 v107, v54, v55
  v_add_f32 v24, v24, v55
  v_exp_f32 v56, v56
  s_waitcnt lgkmcnt(9)
  v_mfma_f32_32x32x16_bf16 v[176:191], v[236:239], v[120:123], v[176:191]
  ds_read_b128 v[228:231], v10 offset:16384
  v_exp_f32 v57, v57
  v_exp_f32 v58, v58
  v_exp_f32 v59, v59
  s_waitcnt lgkmcnt(8)
  v_mfma_f32_32x32x16_bf16 v[128:143], v[240:243], v[124:127], v[128:143]
  ds_read_b128 v[232:235], v11 offset:16384
  v_cvt_pk_bf16_f32 v108, v56, v57
  v_add_f32 v23, v23, v56
  v_add_f32 v24, v24, v57
  v_exp_f32 v60, v60
  s_waitcnt lgkmcnt(7)
  v_mfma_f32_32x32x16_bf16 v[144:159], v[244:247], v[124:127], v[144:159]
  ds_read_b128 v[236:239], v12 offset:16384
  v_exp_f32 v61, v61
  v_cvt_pk_bf16_f32 v109, v58, v59
  v_add_f32 v23, v23, v58
  v_add_f32 v24, v24, v59
  s_waitcnt lgkmcnt(6)
  v_mfma_f32_32x32x16_bf16 v[160:175], v[248:251], v[124:127], v[160:175]
  ds_read_b128 v[240:243], v13 offset:16384
  v_exp_f32 v62, v62
  v_exp_f32 v63, v63
  v_cvt_pk_bf16_f32 v110, v60, v61
  s_waitcnt lgkmcnt(5)
  v_mfma_f32_32x32x16_bf16 v[176:191], v[252:255], v[124:127], v[176:191]
  ds_read_b128 v[244:247], v14 offset:16384
  v_add_f32 v23, v23, v60
  v_add_f32 v24, v24, v61
  v_add_f32 v23, v23, v62
  v_cvt_pk_bf16_f32 v111, v62, v63
  v_add_f32 v24, v24, v63
  s_waitcnt lgkmcnt(5)
  v_mfma_f32_32x32x16_bf16 v[64:79], v[224:227], v[192:195], v[32:47]
  ds_read_b128 v[248:251], v15 offset:16384
  s_waitcnt lgkmcnt(5)
  v_mfma_f32_32x32x16_bf16 v[64:79], v[228:231], v[196:199], v[64:79]
  ds_read_b128 v[252:255], v16 offset:16384
  s_waitcnt lgkmcnt(5)
  v_mfma_f32_32x32x16_bf16 v[64:79], v[232:235], v[200:203], v[64:79]
  ds_read_b128 v[224:227], v9 offset:24576
  s_waitcnt lgkmcnt(5)
  v_mfma_f32_32x32x16_bf16 v[64:79], v[236:239], v[204:207], v[64:79]
  ds_read_b128 v[228:231], v10 offset:24576
  s_waitcnt lgkmcnt(5)
  v_mfma_f32_32x32x16_bf16 v[64:79], v[240:243], v[208:211], v[64:79]
  ds_read_b128 v[232:235], v11 offset:24576
  s_waitcnt lgkmcnt(5)
  v_mfma_f32_32x32x16_bf16 v[64:79], v[244:247], v[212:215], v[64:79]
  ds_read_b128 v[236:239], v12 offset:24576
  s_waitcnt lgkmcnt(5)
  v_mfma_f32_32x32x16_bf16 v[64:79], v[248:251], v[216:219], v[64:79]
  ds_read_b128 v[240:243], v13 offset:24576
  s_waitcnt lgkmcnt(5)
  v_mfma_f32_32x32x16_bf16 v[64:79], v[252:255], v[220:223], v[64:79]
  ds_read_b128 v[244:247], v14 offset:24576
  s_waitcnt lgkmcnt(5)
  v_mfma_f32_32x32x16_bf16 v[80:95], v[224:227], v[192:195], v[32:47]
  ds_read_b128 v[248:251], v15 offset:24576
  s_cmp_eq_u32 s27, 1
  s_cbranch_scc1 K2_SIDE10
K2_BACK10:
  s_waitcnt lgkmcnt(5)
  v_mfma_f32_32x32x16_bf16 v[80:95], v[228:231], v[196:199], v[80:95]
  ds_read_b128 v[252:255], v16 offset:24576
  s_waitcnt lgkmcnt(5)
  v_mfma_f32_32x32x16_bf16 v[80:95], v[232:235], v[200:203], v[80:95]
  s_waitcnt vmcnt(8)
  s_barrier
  ds_read_b64_tr_b16 v[224:225], v1 offset:0
  ds_read_b64_tr_b16 v[226:227], v1 offset:1024
  v_exp_f32 v64, v64
  v_exp_f32 v65, v65
  v_exp_f32 v66, v66
  s_waitcnt lgkmcnt(6)
  v_mfma_f32_32x32x16_bf16 v[80:95], v[236:239], v[204:207], v[80:95]
  ds_read_b64_tr_b16 v[228:229], v2 offset:0
  ds_read_b64_tr_b16 v[230:231], v2 offset:1024
  s_add_u32 s28, s25, 114688
  s_add_u32 m0, s23, 49152
  s_nop 0
  buffer_load_dwordx4 v19, s[12:15], s28 offen lds
  v_exp_f32 v67, v67
  v_cvt_pk_bf16_f32 v112, v64, v65
  s_waitcnt lgkmcnt(7)
  v_mfma_f32_32x32x16_bf16 v[80:95], v[240:243], v[208:211], v[80:95]
  ds_read_b64_tr_b16 v[232:233], v3 offset:0
  ds_read_b64_tr_b16 v[234:235], v3 offset:1024
  v_add_f32 v23, v23, v64
  v_add_f32 v24, v24, v65
  v_exp_f32 v68, v68
  v_exp_f32 v69, v69
  s_waitcnt lgkmcnt(8)
  v_mfma_f32_32x32x16_bf16 v[80:95], v[244:247], v[212:215], v[80:95]
  ds_read_b64_tr_b16 v[236:237], v4 offset:0
  ds_read_b64_tr_b16 v[238:239], v4 offset:1024
  s_add_u32 s28, s25, 114688
  s_add_u32 m0, s23, 49152
  s_nop 0
  buffer_load_dwordx4 v19, s[12:15], s28 offen offset:1024 lds
  v_cvt_pk_bf16_f32 v113, v66, v67
  v_add_f32 v23, v23, v66
  v_add_f32 v24, v24, v67
  s_waitcnt lgkmcnt(9)
  v_mfma_f32_32x32x16_bf16 v[80:95], v[248:251], v[216:219], v[80:95]
  ds_read_b64_tr_b16 v[240:241], v1 offset:4096
  ds_read_b64_tr_b16 v[242:243], v1 offset:5120
  v_exp_f32 v70, v70
  v_exp_f32 v71, v71
  v_cvt_pk_bf16_f32 v114, v68, v69
  s_waitcnt lgkmcnt(10)
  v_mfma_f32_32x32x16_bf16 v[80:95], v[252:255], v[220:223], v[80:95]
  ds_read_b64_tr_b16 v[244:245], v2 offset:4096
  ds_read_b64_tr_b16 v[246:247], v2 offset:5120
  v_add_f32 v23, v23, v68
  v_add_f32 v24, v24, v69
  v_add_f32 v23, v23, v70
  v_cvt_pk_bf16_f32 v115, v70, v71
  v_add_f32 v24, v24, v71
  s_waitcnt lgkmcnt(10)
  v_mfma_f32_32x32x16_bf16 v[128:143], v[224:227], v[96:99], v[128:143]
  ds_read_b64_tr_b16 v[248:249], v3 offset:4096
  ds_read_b64_tr_b16 v[250:251], v3 offset:5120
  v_exp_f32 v72, v72
  v_exp_f32 v73, v73
  v_exp_f32 v74, v74
  s_waitcnt lgkmcnt(10)
  v_mfma_f32_32x32x16_bf16 v[144:159], v[228:231], v[96:99], v[144:159]
  ds_read_b64_tr_b16 v[252:253], v4 offset:4096
  ds_read_b64_tr_b16 v[254:255], v4 offset:5120
  v_exp_f32 v75, v75
  v_cvt_pk_bf16_f32 v116, v72, v73
  v_add_f32 v23, v23, v72
  v_add_f32 v24, v24, v73
  s_waitcnt lgkmcnt(10)
  v_mfma_f32_32x32x16_bf16 v[160:175], v[232:235], v[96:99], v[160:175]
  ds_read_b64_tr_b16 v[224:225], v1 offset:8192
  ds_read_b64_tr_b16 v[226:227], v1 offset:9216
  v_exp_f32 v76, v76
  v_exp_f32 v77, v77
  v_cvt_pk_bf16_f32 v117, v74, v75
  s_waitcnt lgkmcnt(10)
  v_mfma_f32_32x32x16_bf16 v[176:191], v[236:239], v[96:99], v[176:191]
  ds_read_b64_tr_b16 v[228:229], v2 offset:8192
  ds_read_b64_tr_b16 v[230:231], v2 offset:9216
  v_add_f32 v23, v23, v74
  v_add_f32 v24, v24, v75
  v_exp_f32 v78, v78
  v_exp_f32 v79, v79
  s_waitcnt lgkmcnt(10)
  v_mfma_f32_32x32x16_bf16 v[128:143], v[240:243], v[100:103], v[128:143]
  ds_read_b64_tr_b16 v[232:233], v3 offset:8192
  ds_read_b64_tr_b16 v[234:235], v3 offset:9216
  v_cvt_pk_bf16_f32 v118, v76, v77
  v_add_f32 v23, v23, v76
  v_add_f32 v24, v24, v77
  v_add_f32 v23, v23, v78
  v_cvt_pk_bf16_f32 v119, v78, v79
  s_waitcnt lgkmcnt(10)
  v_mfma_f32_32x32x16_bf16 v[144:159], v[244:247], v[100:103], v[144:159]
  ds_read_b64_tr_b16 v[236:237], v4 offset:8192
  ds_read_b64_tr_b16 v[238:239], v4 offset:9216
  v_add_f32 v24, v24, v79
  s_cmp_eq_u32 s27, 1
  s_cbranch_scc1 K2_SIDE11
K2_BACK11:
  v_exp_f32 v80, v80
  v_exp_f32 v81, v81
  s_waitcnt lgkmcnt(10)
  v_mfma_f32_32x32x16_bf16 v[160:175], v[248:251], v[100:103], v[160:175]
  ds_read_b64_tr_b16 v[240:241], v1 offset:12288
  ds_read_b64_tr_b16 v[242:243], v1 offset:13312
  v_exp_f32 v82, v82
  v_exp_f32 v83, v83
  v_cvt_pk_bf16_f32 v120, v80, v81
  s_waitcnt lgkmcnt(10)
  v_mfma_f32_32x32x16_bf16 v[176:191], v[252:255], v[100:103], v[176:191]
  ds_read_b64_tr_b16 v[244:245], v2 offset:12288
  ds_read_b64_tr_b16 v[246:247], v2 offset:13312
  v_add_f32 v23, v23, v80
  v_add_f32 v24, v24, v81
  v_exp_f32 v84, v84
  v_exp_f32 v85, v85
  s_waitcnt lgkmcnt(10)
  v_mfma_f32_32x32x16_bf16 v[128:143], v[224:227], v[104:107], v[128:143]
  ds_read_b64_tr_b16 v[248:249], v3 offset:12288
  ds_read_b64_tr_b16 v[250:251], v3 offset:13312
  v_cvt_pk_bf16_f32 v121, v82, v83
  v_add_f32 v23, v23, v82
  v_add_f32 v24, v24, v83
  v_exp_f32 v86, v86
  s_waitcnt lgkmcnt(10)
  v_mfma_f32_32x32x16_bf16 v[144:159], v[228:231], v[104:107], v[144:159]
  ds_read_b64_tr_b16 v[252:253], v4 offset:12288
  ds_read_b64_tr_b16 v[254:255], v4 offset:13312
  v_exp_f32 v87, v87
  v_cvt_pk_bf16_f32 v122, v84, v85
  v_add_f32 v23, v23, v84
  v_add_f32 v24, v24, v85
  s_waitcnt lgkmcnt(10)
  v_mfma_f32_32x32x16_bf16 v[160:175], v[232:235], v[104:107], v[160:175]
  s_waitcnt vmcnt(8)
  s_barrier
  ds_read_b128 v[224:227], v9 offset:32768
  v_add_f32 v23, v23, v86
  v_cvt_pk_bf16_f32 v123, v86, v87
  v_add_f32 v24, v24, v87
  v_exp_f32 v88, v88
  s_waitcnt lgkmcnt(9)
  v_mfma_f32_32x32x16_bf16 v[176:191], v[236:239], v[104:107], v[176:191]
  ds_read_b128 v[228:231], v10 offset:32768
  v_exp_f32 v89, v89
  v_exp_f32 v90, v90
  v_exp_f32 v91, v91
  s_waitcnt lgkmcnt(8)
  v_mfma_f32_32x32x16_bf16 v[128:143], v[240:243], v[108:111], v[128:143]
  ds_read_b128 v[232:235], v11 offset:32768
  v_cvt_pk_bf16_f32 v124, v88, v89
  v_add_f32 v23, v23, v88
  v_add_f32 v24, v24, v89
  v_exp_f32 v92, v92
  s_waitcnt lgkmcnt(7)
  v_mfma_f32_32x32x16_bf16 v[144:159], v[244:247], v[108:111], v[144:159]
  ds_read_b128 v[236:239], v12 offset:32768
  v_exp_f32 v93, v93
  v_cvt_pk_bf16_f32 v125, v90, v91
  v_add_f32 v23, v23, v90
  v_add_f32 v24, v24, v91
  s_waitcnt lgkmcnt(6)
  v_mfma_f32_32x32x16_bf16 v[160:175], v[248:251], v[108:111], v[160:175]
  ds_read_b128 v[240:243], v13 offset:32768
  v_exp_f32 v94, v94
  v_exp_f32 v95, v95
  v_cvt_pk_bf16_f32 v126, v92, v93
  s_waitcnt lgkmcnt(5)
  v_mfma_f32_32x32x16_bf16 v[176:191], v[252:255], v[108:111], v[176:191]
  ds_read_b128 v[244:247], v14 offset:32768
  v_add_f32 v23, v23, v92
  v_add_f32 v24, v24, v93
  v_add_f32 v23, v23, v94
  v_cvt_pk_bf16_f32 v127, v94, v95
  v_add_f32 v24, v24, v95
  s_waitcnt lgkmcnt(5)
  v_mfma_f32_32x32x16_bf16 v[48:63], v[224:227], v[192:195], v[32:47]
  ds_read_b128 v[248:251], v15 offset:32768
  s_waitcnt lgkmcnt(5)
  v_mfma_f32_32x32x16_bf16 v[48:63], v[228:231], v[196:199], v[48:63]
  ds_read_b128 v[252:255], v16 offset:32768
  s_waitcnt lgkmcnt(5)
  v_mfma_f32_32x32x16_bf16 v[48:63], v[232:235], v[200:203], v[48:63]
  ds_read_b128 v[224:227], v9 offset:40960
  s_waitcnt lgkmcnt(5)
  v_mfma_f32_32x32x16_bf16 v[48:63], v[236:239], v[204:207], v[48:63]
  ds_read_b128 v[228:231], v10 offset:40960
  s_waitcnt lgkmcnt(5)
  v_mfma_f32_32x32x16_bf16 v[48:63], v[240:243], v[208:211], v[48:63]
  ds_read_b128 v[232:235], v11 offset:40960
  s_waitcnt lgkmcnt(5)
  v_mfma_f32_32x32x16_bf16 v[48:63], v[244:247], v[212:215], v[48:63]
  ds_read_b128 v[236:239], v12 offset:40960
  s_waitcnt lgkmcnt(5)
  v_mfma_f32_32x32x16_bf16 v[48:63], v[248:251], v[216:219], v[48:63]
  ds_read_b128 v[240:243], v13 offset:40960
  s_waitcnt lgkmcnt(5)
  v_mfma_f32_32x32x16_bf16 v[48:63], v[252:255], v[220:223], v[48:63]
  ds_read_b128 v[244:247], v14 offset:40960
  s_waitcnt lgkmcnt(5)
  v_mfma_f32_32x32x16_bf16 v[64:79], v[224:227], v[192:195], v[32:47]
  ds_read_b128 v[248:251], v15 offset:40960
  s_cmp_eq_u32 s27, 1
  s_cbranch_scc1 K2_SIDE12
K2_BACK12:
  s_waitcnt lgkmcnt(5)
  v_mfma_f32_32x32x16_bf16 v[64:79], v[228:231], v[196:199], v[64:79]
  ds_read_b128 v[252:255], v16 offset:40960
  s_waitcnt lgkmcnt(5)
  v_mfma_f32_32x32x16_bf16 v[64:79], v[232:235], v[200:203], v[64:79]
  s_waitcnt vmcnt(6)
  s_barrier
  ds_read_b64_tr_b16 v[224:225], v1 offset:16384
  ds_read_b64_tr_b16 v[226:227], v1 offset:17408
  v_exp_f32 v48, v48
  v_exp_f32 v49, v49
  v_exp_f32 v50, v50
  s_waitcnt lgkmcnt(6)
  v_mfma_f32_32x32x16_bf16 v[64:79], v[236:239], v[204:207], v[64:79]
  ds_read_b64_tr_b16 v[228:229], v2 offset:16384
  ds_read_b64_tr_b16 v[230:231], v2 offset:17408
  v_exp_f32 v51, v51
  v_cvt_pk_bf16_f32 v96, v48, v49
  v_add_f32 v23, v23, v48
  v_add_f32 v24, v24, v49
  s_waitcnt lgkmcnt(7)
  v_mfma_f32_32x32x16_bf16 v[64:79], v[240:243], v[208:211], v[64:79]
  ds_read_b64_tr_b16 v[232:233], v3 offset:16384
  ds_read_b64_tr_b16 v[234:235], v3 offset:17408
  v_exp_f32 v52, v52
  v_exp_f32 v53, v53
  v_cvt_pk_bf16_f32 v97, v50, v51
  s_waitcnt lgkmcnt(8)
  v_mfma_f32_32x32x16_bf16 v[64:79], v[244:247], v[212:215], v[64:79]
  ds_read_b64_tr_b16 v[236:237], v4 offset:16384
  ds_read_b64_tr_b16 v[238:239], v4 offset:17408
  v_add_f32 v23, v23, v50
  v_add_f32 v24, v24, v51
  v_exp_f32 v54, v54
  v_exp_f32 v55, v55
  s_waitcnt lgkmcnt(9)
  v_mfma_f32_32x32x16_bf16 v[64:79], v[248:251], v[216:219], v[64:79]
  ds_read_b64_tr_b16 v[240:241], v1 offset:20480
  ds_read_b64_tr_b16 v[242:243], v1 offset:21504
  v_cvt_pk_bf16_f32 v98, v52, v53
  v_add_f32 v23, v23, v52
  v_add_f32 v24, v24, v53
  v_add_f32 v23, v23, v54
  v_cvt_pk_bf16_f32 v99, v54, v55
  s_waitcnt lgkmcnt(10)
  v_mfma_f32_32x32x16_bf16 v[64:79], v[252:255], v[220:223], v[64:79]
  ds_read_b64_tr_b16 v[244:245], v2 offset:20480
  ds_read_b64_tr_b16 v[246:247], v2 offset:21504
  v_add_f32 v24, v24, v55
  v_exp_f32 v56, v56
  v_exp_f32 v57, v57
  s_waitcnt lgkmcnt(10)
  v_mfma_f32_32x32x16_bf16 v[128:143], v[224:227], v[112:115], v[128:143]
  ds_read_b64_tr_b16 v[248:249], v3 offset:20480
  ds_read_b64_tr_b16 v[250:251], v3 offset:21504
  v_exp_f32 v58, v58
  v_exp_f32 v59, v59
  v_cvt_pk_bf16_f32 v100, v56, v57
  s_waitcnt lgkmcnt(10)
  v_mfma_f32_32x32x16_bf16 v[144:159], v[228:231], v[112:115], v[144:159]
  ds_read_b64_tr_b16 v[252:253], v4 offset:20480
  ds_read_b64_tr_b16 v[254:255], v4 offset:21504
  v_add_f32 v23, v23, v56
  v_add_f32 v24, v24, v57
  v_exp_f32 v60, v60
  v_exp_f32 v61, v61
  s_waitcnt lgkmcnt(10)
  v_mfma_f32_32x32x16_bf16 v[160:175], v[232:235], v[112:115], v[160:175]
  ds_read_b64_tr_b16 v[224:225], v1 offset:24576
  ds_read_b64_tr_b16 v[226:227], v1 offset:25600
  v_cvt_pk_bf16_f32 v101, v58, v59
  v_add_f32 v23, v23, v58
  v_add_f32 v24, v24, v59
  v_exp_f32 v62, v62
  s_waitcnt lgkmcnt(10)
  v_mfma_f32_32x32x16_bf16 v[176:191], v[236:239], v[112:115], v[176:191]
  ds_read_b64_tr_b16 v[228:229], v2 offset:24576
  ds_read_b64_tr_b16 v[230:231], v2 offset:25600
  v_exp_f32 v63, v63
  v_cvt_pk_bf16_f32 v102, v60, v61
  v_add_f32 v23, v23, v60
  v_add_f32 v24, v24, v61
  s_waitcnt lgkmcnt(10)
  v_mfma_f32_32x32x16_bf16 v[128:143], v[240:243], v[116:119], v[128:143]
  ds_read_b64_tr_b16 v[232:233], v3 offset:24576
  ds_read_b64_tr_b16 v[234:235], v3 offset:25600
  v_add_f32 v23, v23, v62
  v_cvt_pk_bf16_f32 v103, v62, v63
  v_add_f32 v24, v24, v63
  s_cmp_eq_u32 s27, 1
  s_cbranch_scc1 K2_SIDE13
K2_BACK13:
  v_exp_f32 v64, v64
  s_waitcnt lgkmcnt(10)
  v_mfma_f32_32x32x16_bf16 v[144:159], v[244:247], v[116:119], v[144:159]
  ds_read_b64_tr_b16 v[236:237], v4 offset:24576
  ds_read_b64_tr_b16 v[238:239], v4 offset:25600
  v_exp_f32 v65, v65
  v_exp_f32 v66, v66
  v_exp_f32 v67, v67
  s_waitcnt lgkmcnt(10)
  v_mfma_f32_32x32x16_bf16 v[160:175], v[248:251], v[116:119], v[160:175]
  ds_read_b64_tr_b16 v[240:241], v1 offset:28672
  ds_read_b64_tr_b16 v[242:243], v1 offset:29696
  v_cvt_pk_bf16_f32 v104, v64, v65
  v_add_f32 v23, v23, v64
  v_add_f32 v24, v24, v65
  v_exp_f32 v68, v68
  s_waitcnt lgkmcnt(10)
  v_mfma_f32_32x32x16_bf16 v[176:191], v[252:255], v[116:119], v[176:191]
  ds_read_b64_tr_b16 v[244:245], v2 offset:28672
  ds_read_b64_tr_b16 v[246:247], v2 offset:29696
  v_exp_f32 v69, v69
  v_cvt_pk_bf16_f32 v105, v66, v67
  v_add_f32 v23, v23, v66
  v_add_f32 v24, v24, v67
  s_waitcnt lgkmcnt(10)
  v_mfma_f32_32x32x16_bf16 v[128:143], v[224:227], v[120:123], v[128:143]
  ds_read_b64_tr_b16 v[248:249], v3 offset:28672
  ds_read_b64_tr_b16 v[250:251], v3 offset:29696
  v_exp_f32 v70, v70
  v_exp_f32 v71, v71
  v_cvt_pk_bf16_f32 v106, v68, v69
  s_waitcnt lgkmcnt(10)
  v_mfma_f32_32x32x16_bf16 v[144:159], v[228:231], v[120:123], v[144:159]
  ds_read_b64_tr_b16 v[252:253], v4 offset:28672
  ds_read_b64_tr_b16 v[254:255], v4 offset:29696
  v_add_f32 v23, v23, v68
  v_add_f32 v24, v24, v69
  v_add_f32 v23, v23, v70
  v_cvt_pk_bf16_f32 v107, v70, v71
  v_add_f32 v24, v24, v71
  s_waitcnt lgkmcnt(10)
  v_mfma_f32_32x32x16_bf16 v[160:175], v[232:235], v[120:123], v[160:175]
  s_waitcnt vmcnt(4)
  s_barrier
  ds_read_b128 v[224:227], v9 offset:49152
  v_exp_f32 v72, v72
  v_exp_f32 v73, v73
  v_exp_f32 v74, v74
  s_waitcnt lgkmcnt(9)
  v_mfma_f32_32x32x16_bf16 v[176:191], v[236:239], v[120:123], v[176:191]
  ds_read_b128 v[228:231], v10 offset:49152
  v_exp_f32 v75, v75
  v_cvt_pk_bf16_f32 v108, v72, v73
  v_add_f32 v23, v23, v72
  v_add_f32 v24, v24, v73
  s_waitcnt lgkmcnt(8)
  v_mfma_f32_32x32x16_bf16 v[128:143], v[240:243], v[124:127], v[128:143]
  ds_read_b128 v[232:235], v11 offset:49152
  v_exp_f32 v76, v76
  v_exp_f32 v77, v77
  v_cvt_pk_bf16_f32 v109, v74, v75
  s_waitcnt lgkmcnt(7)
  v_mfma_f32_32x32x16_bf16 v[144:159], v[244:247], v[124:127], v[144:159]
  ds_read_b128 v[236:239], v12 offset:49152
  v_add_f32 v23, v23, v74
  v_add_f32 v24, v24, v75
  v_exp_f32 v78, v78
  v_exp_f32 v79, v79
  s_waitcnt lgkmcnt(6)
  v_mfma_f32_32x32x16_bf16 v[160:175], v[248:251], v[124:127], v[160:175]
  ds_read_b128 v[240:243], v13 offset:49152
  v_cvt_pk_bf16_f32 v110, v76, v77
  v_add_f32 v23, v23, v76
  v_add_f32 v24, v24, v77
  v_add_f32 v23, v23, v78
  v_cvt_pk_bf16_f32 v111, v78, v79
  s_waitcnt lgkmcnt(5)
  v_mfma_f32_32x32x16_bf16 v[176:191], v[252:255], v[124:127], v[176:191]
  ds_read_b128 v[244:247], v14 offset:49152
  v_add_f32 v24, v24, v79
  s_waitcnt lgkmcnt(5)
  v_mfma_f32_32x32x16_bf16 v[80:95], v[224:227], v[192:195], v[32:47]
  ds_read_b128 v[248:251], v15 offset:49152
  s_waitcnt lgkmcnt(5)
  v_mfma_f32_32x32x16_bf16 v[80:95], v[228:231], v[196:199], v[80:95]
  ds_read_b128 v[252:255], v16 offset:49152
  s_waitcnt lgkmcnt(5)
  v_mfma_f32_32x32x16_bf16 v[80:95], v[232:235], v[200:203], v[80:95]
  ds_read_b128 v[224:227], v9 offset:57344
  s_waitcnt lgkmcnt(5)
  v_mfma_f32_32x32x16_bf16 v[80:95], v[236:239], v[204:207], v[80:95]
  ds_read_b128 v[228:231], v10 offset:57344
  s_waitcnt lgkmcnt(5)
  v_mfma_f32_32x32x16_bf16 v[80:95], v[240:243], v[208:211], v[80:95]
  ds_read_b128 v[232:235], v11 offset:57344
  s_waitcnt lgkmcnt(5)
  v_mfma_f32_32x32x16_bf16 v[80:95], v[244:247], v[212:215], v[80:95]
  ds_read_b128 v[236:239], v12 offset:57344
  s_waitcnt lgkmcnt(5)
  v_mfma_f32_32x32x16_bf16 v[80:95], v[248:251], v[216:219], v[80:95]
  ds_read_b128 v[240:243], v13 offset:57344
  s_waitcnt lgkmcnt(5)
  v_mfma_f32_32x32x16_bf16 v[80:95], v[252:255], v[220:223], v[80:95]
  ds_read_b128 v[244:247], v14 offset:57344
  s_waitcnt lgkmcnt(5)
  v_mfma_f32_32x32x16_bf16 v[48:63], v[224:227], v[192:195], v[32:47]
  ds_read_b128 v[248:251], v15 offset:57344
  s_cmp_eq_u32 s27, 1
  s_cbranch_scc1 K2_SIDE14
K2_BACK14:
  s_waitcnt lgkmcnt(5)
  v_mfma_f32_32x32x16_bf16 v[48:63], v[228:231], v[196:199], v[48:63]
  ds_read_b128 v[252:255], v16 offset:57344
  s_waitcnt lgkmcnt(5)
  v_mfma_f32_32x32x16_bf16 v[48:63], v[232:235], v[200:203], v[48:63]
  s_waitcnt vmcnt(2)
  s_barrier
  ds_read_b64_tr_b16 v[224:225], v1 offset:32768
  ds_read_b64_tr_b16 v[226:227], v1 offset:33792
  v_exp_f32 v80, v80
  v_exp_f32 v81, v81
  v_exp_f32 v82, v82
  s_waitcnt lgkmcnt(6)
  v_mfma_f32_32x32x16_bf16 v[48:63], v[236:239], v[204:207], v[48:63]
  ds_read_b64_tr_b16 v[228:229], v2 offset:32768
  ds_read_b64_tr_b16 v[230:231], v2 offset:33792
  v_exp_f32 v83, v83
  v_cvt_pk_bf16_f32 v112, v80, v81
  v_add_f32 v23, v23, v80
  v_add_f32 v24, v24, v81
  s_waitcnt lgkmcnt(7)
  v_mfma_f32_32x32x16_bf16 v[48:63], v[240:243], v[208:211], v[48:63]
  ds_read_b64_tr_b16 v[232:233], v3 offset:32768
  ds_read_b64_tr_b16 v[234:235], v3 offset:33792
  v_exp_f32 v84, v84
  v_exp_f32 v85, v85
  v_cvt_pk_bf16_f32 v113, v82, v83
  s_waitcnt lgkmcnt(8)
  v_mfma_f32_32x32x16_bf16 v[48:63], v[244:247], v[212:215], v[48:63]
  ds_read_b64_tr_b16 v[236:237], v4 offset:32768
  ds_read_b64_tr_b16 v[238:239], v4 offset:33792
  v_add_f32 v23, v23, v82
  v_add_f32 v24, v24, v83
  v_exp_f32 v86, v86
  v_exp_f32 v87, v87
  s_waitcnt lgkmcnt(9)
  v_mfma_f32_32x32x16_bf16 v[48:63], v[248:251], v[216:219], v[48:63]
  ds_read_b64_tr_b16 v[240:241], v1 offset:36864
  ds_read_b64_tr_b16 v[242:243], v1 offset:37888
  v_cvt_pk_bf16_f32 v114, v84, v85
  v_add_f32 v23, v23, v84
  v_add_f32 v24, v24, v85
  v_add_f32 v23, v23, v86
  v_cvt_pk_bf16_f32 v115, v86, v87
  s_waitcnt lgkmcnt(10)
  v_mfma_f32_32x32x16_bf16 v[48:63], v[252:255], v[220:223], v[48:63]
  ds_read_b64_tr_b16 v[244:245], v2 offset:36864
  ds_read_b64_tr_b16 v[246:247], v2 offset:37888
  v_add_f32 v24, v24, v87
  v_exp_f32 v88, v88
  v_exp_f32 v89, v89
  s_waitcnt lgkmcnt(10)
  v_mfma_f32_32x32x16_bf16 v[128:143], v[224:227], v[96:99], v[128:143]
  ds_read_b64_tr_b16 v[248:249], v3 offset:36864
  ds_read_b64_tr_b16 v[250:251], v3 offset:37888
  v_exp_f32 v90, v90
  v_exp_f32 v91, v91
  v_cvt_pk_bf16_f32 v116, v88, v89
  s_waitcnt lgkmcnt(10)
  v_mfma_f32_32x32x16_bf16 v[144:159], v[228:231], v[96:99], v[144:159]
  ds_read_b64_tr_b16 v[252:253], v4 offset:36864
  ds_read_b64_tr_b16 v[254:255], v4 offset:37888
  v_add_f32 v23, v23, v88
  v_add_f32 v24, v24, v89
  v_exp_f32 v92, v92
  v_exp_f32 v93, v93
  s_waitcnt lgkmcnt(10)
  v_mfma_f32_32x32x16_bf16 v[160:175], v[232:235], v[96:99], v[160:175]
  ds_read_b64_tr_b16 v[224:225], v1 offset:40960
  ds_read_b64_tr_b16 v[226:227], v1 offset:41984
  v_cvt_pk_bf16_f32 v117, v90, v91
  v_add_f32 v23, v23, v90
  v_add_f32 v24, v24, v91
  v_exp_f32 v94, v94
  s_waitcnt lgkmcnt(10)
  v_mfma_f32_32x32x16_bf16 v[176:191], v[236:239], v[96:99], v[176:191]
  ds_read_b64_tr_b16 v[228:229], v2 offset:40960
  ds_read_b64_tr_b16 v[230:231], v2 offset:41984
  v_exp_f32 v95, v95
  v_cvt_pk_bf16_f32 v118, v92, v93
  v_add_f32 v23, v23, v92
  v_add_f32 v24, v24, v93
  s_waitcnt lgkmcnt(10)
  v_mfma_f32_32x32x16_bf16 v[128:143], v[240:243], v[100:103], v[128:143]
  ds_read_b64_tr_b16 v[232:233], v3 offset:40960
  ds_read_b64_tr_b16 v[234:235], v3 offset:41984
  v_add_f32 v23, v23, v94
  v_cvt_pk_bf16_f32 v119, v94, v95
  v_add_f32 v24, v24, v95
  s_cmp_eq_u32 s27, 1
  s_cbranch_scc1 K2_SIDE15
K2_BACK15:
  v_exp_f32 v48, v48
  s_waitcnt lgkmcnt(10)
  v_mfma_f32_32x32x16_bf16 v[144:159], v[244:247], v[100:103], v[144:159]
  ds_read_b64_tr_b16 v[236:237], v4 offset:40960
  ds_read_b64_tr_b16 v[238:239], v4 offset:41984
  v_exp_f32 v49, v49
  v_exp_f32 v50, v50
  v_exp_f32 v51, v51
  s_waitcnt lgkmcnt(10)
  v_mfma_f32_32x32x16_bf16 v[160:175], v[248:251], v[100:103], v[160:175]
  ds_read_b64_tr_b16 v[240:241], v1 offset:45056
  ds_read_b64_tr_b16 v[242:243], v1 offset:46080
  v_cvt_pk_bf16_f32 v120, v48, v49
  v_add_f32 v23, v23, v48
  v_add_f32 v24, v24, v49
  v_exp_f32 v52, v52
  s_waitcnt lgkmcnt(10)
  v_mfma_f32_32x32x16_bf16 v[176:191], v[252:255], v[100:103], v[176:191]
  ds_read_b64_tr_b16 v[244:245], v2 offset:45056
  ds_read_b64_tr_b16 v[246:247], v2 offset:46080
  v_exp_f32 v53, v53
  v_cvt_pk_bf16_f32 v121, v50, v51
  v_add_f32 v23, v23, v50
  v_add_f32 v24, v24, v51
  s_waitcnt lgkmcnt(10)
  v_mfma_f32_32x32x16_bf16 v[128:143], v[224:227], v[104:107], v[128:143]
  ds_read_b64_tr_b16 v[248:249], v3 offset:45056
  ds_read_b64_tr_b16 v[250:251], v3 offset:46080
  v_exp_f32 v54, v54
  v_exp_f32 v55, v55
  v_cvt_pk_bf16_f32 v122, v52, v53
  s_waitcnt lgkmcnt(10)
  v_mfma_f32_32x32x16_bf16 v[144:159], v[228:231], v[104:107], v[144:159]
  ds_read_b64_tr_b16 v[252:253], v4 offset:45056
  ds_read_b64_tr_b16 v[254:255], v4 offset:46080
  v_add_f32 v23, v23, v52
  v_add_f32 v24, v24, v53
  v_add_f32 v23, v23, v54
  v_cvt_pk_bf16_f32 v123, v54, v55
  v_add_f32 v24, v24, v55
  s_waitcnt lgkmcnt(10)
  v_mfma_f32_32x32x16_bf16 v[160:175], v[232:235], v[104:107], v[160:175]
  s_waitcnt vmcnt(0)
  s_barrier
  ds_read_b64_tr_b16 v[224:225], v1 offset:49152
  ds_read_b64_tr_b16 v[226:227], v1 offset:50176
  v_exp_f32 v56, v56
  v_exp_f32 v57, v57
  v_exp_f32 v58, v58
  s_waitcnt lgkmcnt(10)
  v_mfma_f32_32x32x16_bf16 v[176:191], v[236:239], v[104:107], v[176:191]
  ds_read_b64_tr_b16 v[228:229], v2 offset:49152
  ds_read_b64_tr_b16 v[230:231], v2 offset:50176
  v_exp_f32 v59, v59
  v_cvt_pk_bf16_f32 v124, v56, v57
  v_add_f32 v23, v23, v56
  v_add_f32 v24, v24, v57
  s_waitcnt lgkmcnt(10)
  v_mfma_f32_32x32x16_bf16 v[128:143], v[240:243], v[108:111], v[128:143]
  ds_read_b64_tr_b16 v[232:233], v3 offset:49152
  ds_read_b64_tr_b16 v[234:235], v3 offset:50176
  v_exp_f32 v60, v60
  v_exp_f32 v61, v61
  v_cvt_pk_bf16_f32 v125, v58, v59
  s_waitcnt lgkmcnt(10)
  v_mfma_f32_32x32x16_bf16 v[144:159], v[244:247], v[108:111], v[144:159]
  ds_read_b64_tr_b16 v[236:237], v4 offset:49152
  ds_read_b64_tr_b16 v[238:239], v4 offset:50176
  v_add_f32 v23, v23, v58
  v_add_f32 v24, v24, v59
  v_exp_f32 v62, v62
  v_exp_f32 v63, v63
  s_waitcnt lgkmcnt(10)
  v_mfma_f32_32x32x16_bf16 v[160:175], v[248:251], v[108:111], v[160:175]
  ds_read_b64_tr_b16 v[240:241], v1 offset:53248
  ds_read_b64_tr_b16 v[242:243], v1 offset:54272
  v_cvt_pk_bf16_f32 v126, v60, v61
  v_add_f32 v23, v23, v60
  v_add_f32 v24, v24, v61
  v_add_f32 v23, v23, v62
  v_cvt_pk_bf16_f32 v127, v62, v63
  s_waitcnt lgkmcnt(10)
  v_mfma_f32_32x32x16_bf16 v[176:191], v[252:255], v[108:111], v[176:191]
  ds_read_b64_tr_b16 v[244:245], v2 offset:53248
  ds_read_b64_tr_b16 v[246:247], v2 offset:54272
  v_add_f32 v24, v24, v63
  v_add_f32 v23, v23, v24
  v_mov_b32 v24, v23
  v_mov_b32 v48, 0
  v_mov_b32 v49, 0
  s_waitcnt lgkmcnt(10)
  v_mfma_f32_32x32x16_bf16 v[128:143], v[224:227], v[112:115], v[128:143]
  ds_read_b64_tr_b16 v[248:249], v3 offset:53248
  ds_read_b64_tr_b16 v[250:251], v3 offset:54272
  v_mov_b32 v50, 0
  v_mov_b32 v51, 0
  v_permlane32_swap_b32 v23, v24
  v_add_f32 v23, v23, v24
  v_rcp_f32 v24, v23
  s_waitcnt lgkmcnt(10)
  v_mfma_f32_32x32x16_bf16 v[144:159], v[228:231], v[112:115], v[144:159]
  ds_read_b64_tr_b16 v[252:253], v4 offset:53248
  ds_read_b64_tr_b16 v[254:255], v4 offset:54272
  v_cmp_nlt_f32_e64 s[32:33], v23, s36
  s_waitcnt lgkmcnt(10)
  v_mfma_f32_32x32x16_bf16 v[160:175], v[232:235], v[112:115], v[160:175]
  ds_read_b64_tr_b16 v[224:225], v1 offset:57344
  ds_read_b64_tr_b16 v[226:227], v1 offset:58368
  s_waitcnt lgkmcnt(10)
  v_mfma_f32_32x32x16_bf16 v[176:191], v[236:239], v[112:115], v[176:191]
  ds_read_b64_tr_b16 v[228:229], v1 offset:61440
  ds_read_b64_tr_b16 v[230:231], v1 offset:62464
  s_waitcnt lgkmcnt(10)
  v_mfma_f32_32x32x16_bf16 v[128:143], v[240:243], v[116:119], v[128:143]
  ds_read_b64_tr_b16 v[232:233], v2 offset:57344
  ds_read_b64_tr_b16 v[234:235], v2 offset:58368
  s_waitcnt lgkmcnt(10)
  v_mfma_f32_32x32x16_bf16 v[144:159], v[244:247], v[116:119], v[144:159]
  ds_read_b64_tr_b16 v[236:237], v2 offset:61440
  ds_read_b64_tr_b16 v[238:239], v2 offset:62464
  s_waitcnt lgkmcnt(10)
  v_mfma_f32_32x32x16_bf16 v[160:175], v[248:251], v[116:119], v[160:175]
  ds_read_b64_tr_b16 v[240:241], v3 offset:57344
  ds_read_b64_tr_b16 v[242:243], v3 offset:58368
  s_waitcnt lgkmcnt(10)
  v_mfma_f32_32x32x16_bf16 v[176:191], v[252:255], v[116:119], v[176:191]
  ds_read_b64_tr_b16 v[244:245], v3 offset:61440
  ds_read_b64_tr_b16 v[246:247], v3 offset:62464
  s_waitcnt lgkmcnt(10)
  v_mfma_f32_32x32x16_bf16 v[128:143], v[224:227], v[120:123], v[128:143]
  ds_read_b64_tr_b16 v[248:249], v4 offset:57344
  ds_read_b64_tr_b16 v[250:251], v4 offset:58368
  s_waitcnt lgkmcnt(10)
  v_mfma_f32_32x32x16_bf16 v[128:143], v[228:231], v[124:127], v[128:143]
  ds_read_b64_tr_b16 v[252:253], v4 offset:61440
  ds_read_b64_tr_b16 v[254:255], v4 offset:62464
  s_waitcnt lgkmcnt(10)
  v_mfma_f32_32x32x16_bf16 v[144:159], v[232:235], v[120:123], v[144:159]
  s_waitcnt lgkmcnt(8)
  v_mfma_f32_32x32x16_bf16 v[144:159], v[236:239], v[124:127], v[144:159]
  s_waitcnt lgkmcnt(6)
  v_mfma_f32_32x32x16_bf16 v[160:175], v[240:243], v[120:123], v[160:175]
  s_waitcnt lgkmcnt(4)
  v_mfma_f32_32x32x16_bf16 v[160:175], v[244:247], v[124:127], v[160:175]
  s_waitcnt lgkmcnt(2)
  v_mfma_f32_32x32x16_bf16 v[176:191], v[248:251], v[120:123], v[176:191]
  v_mul_f32 v128, v24, v128
  v_mul_f32 v129, v24, v129
  v_mul_f32 v130, v24, v130
  v_mul_f32 v131, v24, v131
  v_mul_f32 v132, v24, v132
  s_waitcnt lgkmcnt(0)
  v_mfma_f32_32x32x16_bf16 v[176:191], v[252:255], v[124:127], v[176:191]
  v_mul_f32 v133, v24, v133
  v_mul_f32 v134, v24, v134
  v_mul_f32 v135, v24, v135
  v_cvt_pk_bf16_f32 v192, v128, v129
  v_cvt_pk_bf16_f32 v193, v130, v131
  v_cvt_pk_bf16_f32 v194, v132, v133
  v_cvt_pk_bf16_f32 v195, v134, v135
  buffer_store_dwordx4 v[192:195], v22, s[16:19], s26 offen offset:0 sc1
  s_nop 0
  v_mfma_f32_16x16x32_bf16 v[52:55], v[48:51], v[192:195], 0
  v_mul_f32 v136, v24, v136
  v_mul_f32 v137, v24, v137
  v_mul_f32 v138, v24, v138
  v_mul_f32 v139, v24, v139
  v_mul_f32 v140, v24, v140
  v_mul_f32 v141, v24, v141
  v_mul_f32 v142, v24, v142
  v_mul_f32 v143, v24, v143
  v_cvt_pk_bf16_f32 v196, v136, v137
  v_cvt_pk_bf16_f32 v197, v138, v139
  v_cvt_pk_bf16_f32 v198, v140, v141
  v_cvt_pk_bf16_f32 v199, v142, v143
  buffer_store_dwordx4 v[196:199], v22, s[16:19], s26 offen offset:1024 sc1
  s_nop 0
  v_mfma_f32_16x16x32_bf16 v[52:55], v[48:51], v[196:199], v[52:55]
  v_mul_f32 v144, v24, v144
  v_mul_f32 v145, v24, v145
  v_mul_f32 v146, v24, v146
  v_mul_f32 v147, v24, v147
  v_mul_f32 v148, v24, v148
  v_mul_f32 v149, v24, v149
  v_mul_f32 v150, v24, v150
  v_mul_f32 v151, v24, v151
  v_cvt_pk_bf16_f32 v200, v144, v145
  v_cvt_pk_bf16_f32 v201, v146, v147
  v_cvt_pk_bf16_f32 v202, v148, v149
  v_cvt_pk_bf16_f32 v203, v150, v151
  buffer_store_dwordx4 v[200:203], v22, s[16:19], s26 offen offset:2048 sc1
  s_nop 0
  v_mfma_f32_16x16x32_bf16 v[52:55], v[48:51], v[200:203], v[52:55]
  v_mul_f32 v152, v24, v152
  v_mul_f32 v153, v24, v153
  v_mul_f32 v154, v24, v154
  v_mul_f32 v155, v24, v155
  v_mul_f32 v156, v24, v156
  v_mul_f32 v157, v24, v157
  v_mul_f32 v158, v24, v158
  v_mul_f32 v159, v24, v159
  v_cvt_pk_bf16_f32 v204, v152, v153
  v_cvt_pk_bf16_f32 v205, v154, v155
  v_cvt_pk_bf16_f32 v206, v156, v157
  v_cvt_pk_bf16_f32 v207, v158, v159
  buffer_store_dwordx4 v[204:207], v22, s[16:19], s26 offen offset:3072 sc1
  s_nop 0
  v_mfma_f32_16x16x32_bf16 v[52:55], v[48:51], v[204:207], v[52:55]
  v_mul_f32 v160, v24, v160
  v_mul_f32 v161, v24, v161
  v_mul_f32 v162, v24, v162
  v_mul_f32 v163, v24, v163
  v_mul_f32 v164, v24, v164
  v_mul_f32 v165, v24, v165
  v_mul_f32 v166, v24, v166
  v_mul_f32 v167, v24, v167
  v_cvt_pk_bf16_f32 v208, v160, v161
  v_cvt_pk_bf16_f32 v209, v162, v163
  v_cvt_pk_bf16_f32 v210, v164, v165
  v_cvt_pk_bf16_f32 v211, v166, v167
  buffer_store_dwordx4 v[208:211], v22, s[16:19], s31 offen offset:0 sc1
  s_nop 0
  v_mfma_f32_16x16x32_bf16 v[52:55], v[48:51], v[208:211], v[52:55]
  v_mul_f32 v168, v24, v168
  v_mul_f32 v169, v24, v169
  v_mul_f32 v170, v24, v170
  v_mul_f32 v171, v24, v171
  v_mul_f32 v172, v24, v172
  v_mul_f32 v173, v24, v173
  v_mul_f32 v174, v24, v174
  v_mul_f32 v175, v24, v175
  v_cvt_pk_bf16_f32 v212, v168, v169
  v_cvt_pk_bf16_f32 v213, v170, v171
  v_cvt_pk_bf16_f32 v214, v172, v173
  v_cvt_pk_bf16_f32 v215, v174, v175
  buffer_store_dwordx4 v[212:215], v22, s[16:19], s31 offen offset:1024 sc1
  s_nop 0
  v_mfma_f32_16x16x32_bf16 v[52:55], v[48:51], v[212:215], v[52:55]
  v_mul_f32 v176, v24, v176
  v_mul_f32 v177, v24, v177
  v_mul_f32 v178, v24, v178
  v_mul_f32 v179, v24, v179
  v_mul_f32 v180, v24, v180
  v_mul_f32 v181, v24, v181
  v_mul_f32 v182, v24, v182
  v_mul_f32 v183, v24, v183
  v_cvt_pk_bf16_f32 v216, v176, v177
  v_cvt_pk_bf16_f32 v217, v178, v179
  v_cvt_pk_bf16_f32 v218, v180, v181
  v_cvt_pk_bf16_f32 v219, v182, v183
  buffer_store_dwordx4 v[216:219], v22, s[16:19], s31 offen offset:2048 sc1
  s_nop 0
  v_mfma_f32_16x16x32_bf16 v[52:55], v[48:51], v[216:219], v[52:55]
  v_mul_f32 v184, v24, v184
  v_mul_f32 v185, v24, v185
  v_mul_f32 v186, v24, v186
  v_mul_f32 v187, v24, v187
  v_mul_f32 v188, v24, v188
  v_mul_f32 v189, v24, v189
  v_mul_f32 v190, v24, v190
  v_mul_f32 v191, v24, v191
  v_cvt_pk_bf16_f32 v220, v184, v185
  v_cvt_pk_bf16_f32 v221, v186, v187
  v_cvt_pk_bf16_f32 v222, v188, v189
  v_cvt_pk_bf16_f32 v223, v190, v191
  buffer_store_dwordx4 v[220:223], v22, s[16:19], s31 offen offset:3072 sc1
  s_nop 0
  v_mfma_f32_16x16x32_bf16 v[52:55], v[48:51], v[220:223], v[52:55]
  s_nop 7
  v_cmp_u_f32_e64 s[38:39], v52, v52
  s_nop 0
  s_or_b64 s[32:33], s[32:33], s[38:39]
  s_cmp_lg_u64 s[32:33], 0
  s_cselect_b32 s32, 1, 0
  s_lshl_b32 s33, s20, 2
  s_add_u32 s33, s33, 147456
  v_mov_b32 v29, s32
  v_mov_b32 v30, s33
  ds_write_b32 v30, v29
  s_waitcnt lgkmcnt(0)
  s_barrier
  s_cmp_eq_u32 s27, 2
  s_cbranch_scc1 K2_FIN
  s_cmp_eq_u32 s27, 1
  s_cbranch_scc1 K2_TO2
  v_bfe_u32 v30, v22, 2, 5
  v_add_u32 v30, 147456, v30
  ds_read_b32 v29, v30
  s_waitcnt lgkmcnt(0)
  v_cmp_ne_u32_e64 s[32:33], 0, v29
  s_nop 0
  s_cmp_eq_u64 s[32:33], 0
  s_cbranch_scc1 K2_FIN
  s_mov_b32 s27, 1
  s_mov_b64 s[34:35], -1
  s_waitcnt vmcnt(0)
  s_branch K2_START
K2_TO2:
  v_mov_b32 v28, v26
  s_nop 1
  v_permlane32_swap_b32 v26, v28
  v_max_f32 v25, v26, v28
  s_mov_b32 s27, 2
  s_mov_b64 s[34:35], 0
  s_waitcnt vmcnt(0) lgkmcnt(0)
  s_nop 7
  s_branch K2_START
K2_SIDE0:
  s_nop 15
  v_max3_f32 v26, v26, v48, v49
  v_max3_f32 v26, v26, v50, v51
  v_max3_f32 v26, v26, v52, v53
  v_max3_f32 v26, v26, v54, v55
  v_max3_f32 v26, v26, v56, v57
  v_max3_f32 v26, v26, v58, v59
  v_max3_f32 v26, v26, v60, v61
  v_max3_f32 v26, v26, v62, v63
  s_nop 7
  s_branch K2_BACK0
K2_SIDE1:
  s_nop 15
  v_max3_f32 v26, v26, v64, v65
  v_max3_f32 v26, v26, v66, v67
  v_max3_f32 v26, v26, v68, v69
  v_max3_f32 v26, v26, v70, v71
  v_max3_f32 v26, v26, v72, v73
  v_max3_f32 v26, v26, v74, v75
  v_max3_f32 v26, v26, v76, v77
  v_max3_f32 v26, v26, v78, v79
  s_nop 7
  s_branch K2_BACK1
K2_SIDE2:
  s_nop 15
  v_max3_f32 v26, v26, v80, v81
  v_max3_f32 v26, v26, v82, v83
  v_max3_f32 v26, v26, v84, v85
  v_max3_f32 v26, v26, v86, v87
  v_max3_f32 v26, v26, v88, v89
  v_max3_f32 v26, v26, v90, v91
  v_max3_f32 v26, v26, v92, v93
  v_max3_f32 v26, v26, v94, v95
  s_nop 7
  s_branch K2_BACK2
K2_SIDE3:
  s_nop 15
  v_max3_f32 v26, v26, v48, v49
  v_max3_f32 v26, v26, v50, v51
  v_max3_f32 v26, v26, v52, v53
  v_max3_f32 v26, v26, v54, v55
  v_max3_f32 v26, v26, v56, v57
  v_max3_f32 v26, v26, v58, v59
  v_max3_f32 v26, v26, v60, v61
  v_max3_f32 v26, v26, v62, v63
  s_nop 7
  s_branch K2_BACK3
K2_SIDE4:
  s_nop 15
  v_max3_f32 v26, v26, v64, v65
  v_max3_f32 v26, v26, v66, v67
  v_max3_f32 v26, v26, v68, v69
  v_max3_f32 v26, v26, v70, v71
  v_max3_f32 v26, v26, v72, v73
  v_max3_f32 v26, v26, v74, v75
  v_max3_f32 v26, v26, v76, v77
  v_max3_f32 v26, v26, v78, v79
  s_nop 7
  s_branch K2_BACK4
K2_SIDE5:
  s_nop 15
  v_max3_f32 v26, v26, v80, v81
  v_max3_f32 v26, v26, v82, v83
  v_max3_f32 v26, v26, v84, v85
  v_max3_f32 v26, v26, v86, v87
  v_max3_f32 v26, v26, v88, v89
  v_max3_f32 v26, v26, v90, v91
  v_max3_f32 v26, v26, v92, v93
  v_max3_f32 v26, v26, v94, v95
  s_nop 7
  s_branch K2_BACK5
K2_SIDE6:
  s_nop 15
  v_max3_f32 v26, v26, v48, v49
  v_max3_f32 v26, v26, v50, v51
  v_max3_f32 v26, v26, v52, v53
  v_max3_f32 v26, v26, v54, v55
  v_max3_f32 v26, v26, v56, v57
  v_max3_f32 v26, v26, v58, v59
  v_max3_f32 v26, v26, v60, v61
  v_max3_f32 v26, v26, v62, v63
  s_nop 7
  s_branch K2_BACK6
K2_SIDE7:
  s_nop 15
  v_max3_f32 v26, v26, v64, v65
  v_max3_f32 v26, v26, v66, v67
  v_max3_f32 v26, v26, v68, v69
  v_max3_f32 v26, v26, v70, v71
  v_max3_f32 v26, v26, v72, v73
  v_max3_f32 v26, v26, v74, v75
  v_max3_f32 v26, v26, v76, v77
  v_max3_f32 v26, v26, v78, v79
  s_nop 7
  s_branch K2_BACK7
K2_SIDE8:
  s_nop 15
  v_max3_f32 v26, v26, v80, v81
  v_max3_f32 v26, v26, v82, v83
  v_max3_f32 v26, v26, v84, v85
  v_max3_f32 v26, v26, v86, v87
  v_max3_f32 v26, v26, v88, v89
  v_max3_f32 v26, v26, v90, v91
  v_max3_f32 v26, v26, v92, v93
  v_max3_f32 v26, v26, v94, v95
  s_nop 7
  s_branch K2_BACK8
K2_SIDE9:
  s_nop 15
  v_max3_f32 v26, v26, v48, v49
  v_max3_f32 v26, v26, v50, v51
  v_max3_f32 v26, v26, v52, v53
  v_max3_f32 v26, v26, v54, v55
  v_max3_f32 v26, v26, v56, v57
  v_max3_f32 v26, v26, v58, v59
  v_max3_f32 v26, v26, v60, v61
  v_max3_f32 v26, v26, v62, v63
  s_nop 7
  s_branch K2_BACK9
K2_SIDE10:
  s_nop 15
  v_max3_f32 v26, v26, v64, v65
  v_max3_f32 v26, v26, v66, v67
  v_max3_f32 v26, v26, v68, v69
  v_max3_f32 v26, v26, v70, v71
  v_max3_f32 v26, v26, v72, v73
  v_max3_f32 v26, v26, v74, v75
  v_max3_f32 v26, v26, v76, v77
  v_max3_f32 v26, v26, v78, v79
  s_nop 7
  s_branch K2_BACK10
K2_SIDE11:
  s_nop 15
  v_max3_f32 v26, v26, v80, v81
  v_max3_f32 v26, v26, v82, v83
  v_max3_f32 v26, v26, v84, v85
  v_max3_f32 v26, v26, v86, v87
  v_max3_f32 v26, v26, v88, v89
  v_max3_f32 v26, v26, v90, v91
  v_max3_f32 v26, v26, v92, v93
  v_max3_f32 v26, v26, v94, v95
  s_nop 7
  s_branch K2_BACK11
K2_SIDE12:
  s_nop 15
  v_max3_f32 v26, v26, v48, v49
  v_max3_f32 v26, v26, v50, v51
  v_max3_f32 v26, v26, v52, v53
  v_max3_f32 v26, v26, v54, v55
  v_max3_f32 v26, v26, v56, v57
  v_max3_f32 v26, v26, v58, v59
  v_max3_f32 v26, v26, v60, v61
  v_max3_f32 v26, v26, v62, v63
  s_nop 7
  s_branch K2_BACK12
K2_SIDE13:
  s_nop 15
  v_max3_f32 v26, v26, v64, v65
  v_max3_f32 v26, v26, v66, v67
  v_max3_f32 v26, v26, v68, v69
  v_max3_f32 v26, v26, v70, v71
  v_max3_f32 v26, v26, v72, v73
  v_max3_f32 v26, v26, v74, v75
  v_max3_f32 v26, v26, v76, v77
  v_max3_f32 v26, v26, v78, v79
  s_nop 7
  s_branch K2_BACK13
K2_SIDE14:
  s_nop 15
  v_max3_f32 v26, v26, v80, v81
  v_max3_f32 v26, v26, v82, v83
  v_max3_f32 v26, v26, v84, v85
  v_max3_f32 v26, v26, v86, v87
  v_max3_f32 v26, v26, v88, v89
  v_max3_f32 v26, v26, v90, v91
  v_max3_f32 v26, v26, v92, v93
  v_max3_f32 v26, v26, v94, v95
  s_nop 7
  s_branch K2_BACK14
K2_SIDE15:
  s_nop 15
  v_max3_f32 v26, v26, v48, v49
  v_max3_f32 v26, v26, v50, v51
  v_max3_f32 v26, v26, v52, v53
  v_max3_f32 v26, v26, v54, v55
  v_max3_f32 v26, v26, v56, v57
  v_max3_f32 v26, v26, v58, v59
  v_max3_f32 v26, v26, v60, v61
  v_max3_f32 v26, v26, v62, v63
  s_nop 7
  s_branch K2_BACK15
K2_FIN:
  v_lshlrev_b32 v2, 2, v0
  v_cmp_lt_u32 vcc, 63, v0
  v_bfrev_b32 v1, 2
  s_nop 0
  v_cndmask_b32 v2, v2, v1, vcc
  v_mov_b32 v1, 0
  s_lshl_b32 s60, s2, 8
  s_add_u32 s60, s60, 56623104
  buffer_store_dword v1, v2, s[16:19], s60 offen sc1
K2_END:
  s_endpgm
.globl kf_kernel
.p2align 8
.type kf_kernel,@function
kf_kernel:
  s_cmp_ge_u32 s2, 256
  s_cbranch_scc1 KF_END
  s_load_dwordx2 s[16:17], s[0:1], 112
  s_load_dwordx2 s[4:5], s[0:1], 0
  s_load_dwordx2 s[8:9], s[0:1], 56
  s_load_dwordx2 s[12:13], s[0:1], 72
  s_load_dwordx2 s[48:49], s[0:1], 96
  s_mov_b32 s18, 268435456
  s_mov_b32 s19, 0x00020000
  s_mov_b32 s6, 2621440
  s_mov_b32 s7, 0x00020000
  s_mov_b32 s10, 3456
  s_mov_b32 s11, 0x00020000
  s_mov_b32 s14, 1280
  s_mov_b32 s15, 0x00020000
  s_mov_b32 s50, 2621440
  s_mov_b32 s51, 0x00020000
  s_mov_b32 s30, 0xffff0000
  v_readfirstlane_b32 s20, v0
  s_nop 0
  s_lshr_b32 s20, s20, 6
  s_and_b32 s22, s2, 7
  s_lshl_b32 s22, s22, 2
  s_bfe_u32 s25, s2, 0x20003
  s_add_u32 s22, s22, s25
  s_lshr_b32 s21, s2, 5
  s_lshl_b32 s25, s20, 5
  s_mul_i32 s23, s21, 128
  s_add_u32 s23, s23, s25
  s_mul_i32 s23, s23, 5120
  s_add_u32 s23, s23, 41943040
  s_mul_i32 s24, s22, 524288
  s_lshl_b32 s26, s25, 11
  s_add_u32 s24, s24, s26
  s_add_u32 s24, s24, 16777216
  v_and_b32 v14, 63, v0
  v_lshrrev_b32 v15, 4, v14
  v_and_b32 v16, 15, v0
  v_lshlrev_b32 v5, 4, v14
  v_add_u32 v6, 4096, v5
  v_lshlrev_b32 v17, 9, v15
  v_lshl_add_u32 v17, v16, 4, v17
  s_add_u32 s26, s20, 0
  s_and_b32 s26, s26, 3
  s_lshr_b32 s27, s26, 1
  s_mul_i32 s27, s27, 262144
  s_and_b32 s28, s26, 1
  s_lshl_b32 s28, s28, 8
  s_add_u32 s27, s27, s28
  v_add_u32 v1, s27, v17
  s_add_u32 s26, s20, 1
  s_and_b32 s26, s26, 3
  s_lshr_b32 s27, s26, 1
  s_mul_i32 s27, s27, 262144
  s_and_b32 s28, s26, 1
  s_lshl_b32 s28, s28, 8
  s_add_u32 s27, s27, s28
  v_add_u32 v2, s27, v17
  s_mul_i32 s26, s26, 15360
  s_add_u32 s26, s26, 102400
  v_add_u32 v7, s26, v5
  s_add_u32 s26, s20, 2
  s_and_b32 s26, s26, 3
  s_lshr_b32 s27, s26, 1
  s_mul_i32 s27, s27, 262144
  s_and_b32 s28, s26, 1
  s_lshl_b32 s28, s28, 8
  s_add_u32 s27, s27, s28
  v_add_u32 v3, s27, v17
  s_mul_i32 s26, s26, 15360
  s_add_u32 s26, s26, 107520
  v_add_u32 v8, s26, v5
  s_add_u32 s26, s20, 3
  s_and_b32 s26, s26, 3
  s_lshr_b32 s27, s26, 1
  s_mul_i32 s27, s27, 262144
  s_and_b32 s28, s26, 1
  s_lshl_b32 s28, s28, 8
  s_add_u32 s27, s27, s28
  v_add_u32 v4, s27, v17
  s_mul_i32 s26, s26, 15360
  s_add_u32 s26, s26, 112640
  v_add_u32 v9, s26, v5
  s_add_u32 s32, s23, 0
  s_add_u32 s33, s24, 0
  s_waitcnt lgkmcnt(0)
  buffer_load_dwordx4 a[16:19], v5, s[16:19], s32 offen offset:0
  buffer_load_dwordx4 a[0:3], v1, s[16:19], s33 offen
  buffer_load_dwordx4 a[20:23], v5, s[16:19], s32 offen offset:1024
  buffer_load_dwordx4 a[4:7], v2, s[16:19], s33 offen
  buffer_load_dwordx4 a[24:27], v5, s[16:19], s32 offen offset:2048
  buffer_load_dwordx4 a[8:11], v3, s[16:19], s33 offen
  buffer_load_dwordx4 a[28:31], v5, s[16:19], s32 offen offset:3072
  buffer_load_dwordx4 a[12:15], v4, s[16:19], s33 offen
  buffer_load_dwordx4 a[32:35], v6, s[16:19], s32 offen offset:0
  s_add_u32 s34, s23, 5120
  s_add_u32 s35, s24, 2048
  buffer_load_dwordx4 a[52:55], v5, s[16:19], s34 offen offset:0
  buffer_load_dwordx4 a[36:39], v1, s[16:19], s35 offen
  buffer_load_dwordx4 a[56:59], v5, s[16:19], s34 offen offset:1024
  buffer_load_dwordx4 a[40:43], v2, s[16:19], s35 offen
  buffer_load_dwordx4 a[60:63], v5, s[16:19], s34 offen offset:2048
  buffer_load_dwordx4 a[44:47], v3, s[16:19], s35 offen
  buffer_load_dwordx4 a[64:67], v5, s[16:19], s34 offen offset:3072
  buffer_load_dwordx4 a[48:51], v4, s[16:19], s35 offen
  buffer_load_dwordx4 a[68:71], v6, s[16:19], s34 offen offset:0
  s_add_u32 s32, s23, 10240
  s_add_u32 s33, s24, 4096
  buffer_load_dwordx4 a[88:91], v5, s[16:19], s32 offen offset:0
  buffer_load_dwordx4 a[72:75], v1, s[16:19], s33 offen
  buffer_load_dwordx4 a[92:95], v5, s[16:19], s32 offen offset:1024
  buffer_load_dwordx4 a[76:79], v2, s[16:19], s33 offen
  buffer_load_dwordx4 a[96:99], v5, s[16:19], s32 offen offset:2048
  buffer_load_dwordx4 a[80:83], v3, s[16:19], s33 offen
  buffer_load_dwordx4 a[100:103], v5, s[16:19], s32 offen offset:3072
  buffer_load_dwordx4 a[84:87], v4, s[16:19], s33 offen
  buffer_load_dwordx4 a[104:107], v6, s[16:19], s32 offen offset:0
  s_mul_i32 s26, s20, 15360
  s_add_u32 s26, s26, 102400
  v_add_u32 v10, s26, v5
  s_mul_i32 s41, s2, 9363
  s_lshr_b32 s41, s41, 16
  s_mul_i32 s42, s41, 7
  s_sub_u32 s42, s2, s42
  s_lshr_b32 s43, s22, 1
  s_lshl_b32 s43, s43, 12
  s_and_b32 s44, s22, 1
  s_lshl_b32 s44, s44, 5
  s_add_u32 s43, s43, s44
  s_lshl_b32 s44, s21, 2
  s_add_u32 s43, s43, s44
  s_lshl_b32 s44, s41, 8
  s_lshl_b32 s45, s42, 2
  s_add_u32 s44, s44, s45
  s_add_u32 s44, s44, 64
  s_cmp_lt_u32 s2, 112
  s_cselect_b32 s44, s44, 0x40000000
  v_lshlrev_b32 v240, 8, v16
  v_add_u32 v240, s43, v240
  v_lshlrev_b32 v241, 12, v16
  v_add_u32 v241, s44, v241
  v_cmp_lt_u32 vcc, 15, v0
  s_nop 1
  v_cndmask_b32 v240, v240, v241, vcc
  v_cmp_lt_u32 vcc, 31, v0
  v_bfrev_b32 v241, 2
  s_nop 0
  v_cndmask_b32 v240, v240, v241, vcc
  s_lshr_b32 s52, s2, 4
  s_mul_i32 s52, s52, 143360
  s_add_u32 s52, s52, 51380224
  s_mul_i32 s53, s20, 7168
  s_add_u32 s52, s52, s53
  s_mul_i32 s43, s41, 143360
  s_mul_i32 s44, s20, 35840
  s_add_u32 s43, s43, s44
  s_lshl_b32 s44, s42, 10
  s_add_u32 s43, s43, s44
  s_add_u32 s43, s43, 51380224
  s_cmp_lt_u32 s2, 112
  s_cselect_b32 s44, 0, 0x40000000
  v_add_u32 v204, s44, v5
  v_and_b32 v205, 1, v0
  v_mul_u32_u24 v205, 1280, v205
  v_sub_u32 v205, 5120, v205
  v_lshl_add_u32 v205, v15, 4, v205
  s_mul_i32 s45, s20, 320
  s_add_u32 s45, s45, 16384
  buffer_load_dwordx4 v[160:163], v204, s[16:19], s43 offen
  buffer_load_dwordx4 v[180:183], v205, s[16:19], s45 offen offset:0
  s_add_u32 s43, s43, 7168
  buffer_load_dwordx4 v[164:167], v204, s[16:19], s43 offen
  buffer_load_dwordx4 v[184:187], v205, s[16:19], s45 offen offset:64
  s_add_u32 s43, s43, 7168
  buffer_load_dwordx4 v[168:171], v204, s[16:19], s43 offen
  buffer_load_dwordx4 v[188:191], v205, s[16:19], s45 offen offset:128
  s_add_u32 s43, s43, 7168
  buffer_load_dwordx4 v[172:175], v204, s[16:19], s43 offen
  buffer_load_dwordx4 v[192:195], v205, s[16:19], s45 offen offset:192
  s_add_u32 s43, s43, 7168
  buffer_load_dwordx4 v[176:179], v204, s[16:19], s43 offen
  buffer_load_dwordx4 v[196:199], v205, s[16:19], s45 offen offset:256
  s_lshr_b32 s46, s42, 1
  s_lshl_b32 s46, s46, 7
  s_and_b32 s47, s42, 1
  s_lshl_b32 s47, s47, 4
  s_add_u32 s46, s46, s47
  s_cmp_lt_u32 s42, 6
  s_cselect_b32 s47, 5, 4
  s_mul_i32 s41, s41, 448
  s_add_u32 s46, s46, s41
  s_mul_i32 s41, s20, 14336
  s_add_u32 s46, s46, s41
  s_add_u32 s46, s46, 32768
  v_lshlrev_b32 v206, s47, v15
  v_mul_u32_u24 v207, 7168, v16
  v_add3_u32 v206, v206, v207, s44
  v_cmp_gt_u32 vcc, 2, v16
  v_bfrev_b32 v207, 2
  s_nop 0
  v_cndmask_b32 v206, v207, v206, vcc
  s_lshl_b32 s26, s22, 6
  s_lshl_b32 s27, s20, 4
  s_add_u32 s26, s26, s27
  s_mul_i32 s27, s21, 160
  s_mul_i32 s36, s26, 1280
  s_add_u32 s36, s36, s27
  s_lshr_b32 s28, s26, 5
  s_mul_i32 s28, s28, 40960
  s_mul_i32 s29, s21, 5120
  s_add_u32 s28, s28, s29
  s_and_b32 s29, s26, 16
  s_lshl_b32 s29, s29, 4
  s_add_u32 s28, s28, s29
  s_add_u32 s37, s28, 7340032
  s_add_u32 s38, s28, 10485760
  s_mul_i32 s39, s21, 320
  v_mul_u32_u24 v18, 1280, v16
  v_lshl_add_u32 v17, v15, 4, v18
  v_lshl_add_u32 v18, v15, 3, v18
  v_lshlrev_b32 v19, 9, v15
  v_lshl_add_u32 v19, v16, 4, v19
  v_lshrrev_b32 v20, 1, v15
  v_lshlrev_b32 v20, 9, v20
  v_lshl_add_u32 v20, v16, 4, v20
  v_and_b32 v23, 1, v15
  v_lshl_add_u32 v20, v23, 3, v20
  v_add_u32 v20, 4096, v20
  v_lshlrev_b32 v21, 5, v15
  v_lshlrev_b32 v22, 4, v15
  s_waitcnt vmcnt(35)
  v_mfma_f32_16x16x32_bf16 v[80:83], a[16:19], a[0:3], 0
  s_add_u32 s34, s23, 15360
  s_add_u32 s35, s24, 6144
  buffer_load_dwordx4 a[124:127], v5, s[16:19], s34 offen offset:0
  s_waitcnt vmcnt(34)
  v_mfma_f32_16x16x32_bf16 v[100:103], a[16:19], a[4:7], 0
  buffer_load_dwordx4 a[108:111], v1, s[16:19], s35 offen
  s_waitcnt vmcnt(33)
  v_mfma_f32_16x16x32_bf16 v[120:123], a[16:19], a[8:11], 0
  buffer_load_dwordx4 a[128:131], v5, s[16:19], s34 offen offset:1024
  s_waitcnt vmcnt(32)
  v_mfma_f32_16x16x32_bf16 v[140:143], a[16:19], a[12:15], 0
  buffer_load_dwordx4 a[112:115], v2, s[16:19], s35 offen
  v_mfma_f32_16x16x32_bf16 v[84:87], a[20:23], a[0:3], 0
  buffer_load_dwordx4 a[132:135], v5, s[16:19], s34 offen offset:2048
  v_mfma_f32_16x16x32_bf16 v[104:107], a[20:23], a[4:7], 0
  buffer_load_dwordx4 a[116:119], v3, s[16:19], s35 offen
  v_mfma_f32_16x16x32_bf16 v[124:127], a[20:23], a[8:11], 0
  buffer_load_dwordx4 a[136:139], v5, s[16:19], s34 offen offset:3072
  v_mfma_f32_16x16x32_bf16 v[144:147], a[20:23], a[12:15], 0
  buffer_load_dwordx4 a[120:123], v4, s[16:19], s35 offen
  v_mfma_f32_16x16x32_bf16 v[88:91], a[24:27], a[0:3], 0
  buffer_load_dwordx4 a[140:143], v6, s[16:19], s34 offen offset:0
  v_mfma_f32_16x16x32_bf16 v[108:111], a[24:27], a[4:7], 0
  s_add_u32 s32, s23, 20480
  s_add_u32 s33, s24, 8192
  buffer_load_dwordx4 a[160:163], v5, s[16:19], s32 offen offset:0
  v_mfma_f32_16x16x32_bf16 v[128:131], a[24:27], a[8:11], 0
  buffer_load_dwordx4 a[144:147], v1, s[16:19], s33 offen
  v_mfma_f32_16x16x32_bf16 v[148:151], a[24:27], a[12:15], 0
  buffer_load_dwordx4 a[164:167], v5, s[16:19], s32 offen offset:1024
  v_mfma_f32_16x16x32_bf16 v[92:95], a[28:31], a[0:3], 0
  buffer_load_dwordx4 a[148:151], v2, s[16:19], s33 offen
  v_mfma_f32_16x16x32_bf16 v[112:115], a[28:31], a[4:7], 0
  buffer_load_dwordx4 a[168:171], v5, s[16:19], s32 offen offset:2048
  v_mfma_f32_16x16x32_bf16 v[132:135], a[28:31], a[8:11], 0
  buffer_load_dwordx4 a[152:155], v3, s[16:19], s33 offen
  v_mfma_f32_16x16x32_bf16 v[152:155], a[28:31], a[12:15], 0
  buffer_load_dwordx4 a[172:175], v5, s[16:19], s32 offen offset:3072
  s_waitcnt vmcnt(44)
  v_mfma_f32_16x16x32_bf16 v[96:99], a[32:35], a[0:3], 0
  buffer_load_dwordx4 a[156:159], v4, s[16:19], s33 offen
  v_mfma_f32_16x16x32_bf16 v[116:119], a[32:35], a[4:7], 0
  buffer_load_dwordx4 a[176:179], v6, s[16:19], s32 offen offset:0
  v_mfma_f32_16x16x32_bf16 v[136:139], a[32:35], a[8:11], 0
  s_add_u32 s34, s23, 25600
  s_add_u32 s35, s24, 10240
  buffer_load_dwordx4 a[196:199], v5, s[16:19], s34 offen offset:0
  v_mfma_f32_16x16x32_bf16 v[156:159], a[32:35], a[12:15], 0
  buffer_load_dwordx4 a[180:183], v1, s[16:19], s35 offen
  s_waitcnt vmcnt(46)
  v_mfma_f32_16x16x32_bf16 v[80:83], a[52:55], a[36:39], v[80:83]
  buffer_load_dwordx4 a[200:203], v5, s[16:19], s34 offen offset:1024
  s_waitcnt vmcnt(45)
  v_mfma_f32_16x16x32_bf16 v[100:103], a[52:55], a[40:43], v[100:103]
  buffer_load_dwordx4 a[184:187], v2, s[16:19], s35 offen
  s_waitcnt vmcnt(44)
  v_mfma_f32_16x16x32_bf16 v[120:123], a[52:55], a[44:47], v[120:123]
  buffer_load_dwordx4 a[204:207], v5, s[16:19], s34 offen offset:2048
  s_waitcnt vmcnt(43)
  v_mfma_f32_16x16x32_bf16 v[140:143], a[52:55], a[48:51], v[140:143]
  buffer_load_dwordx4 a[188:191], v3, s[16:19], s35 offen
  v_mfma_f32_16x16x32_bf16 v[84:87], a[56:59], a[36:39], v[84:87]
  buffer_load_dwordx4 a[208:211], v5, s[16:19], s34 offen offset:3072
  v_mfma_f32_16x16x32_bf16 v[104:107], a[56:59], a[40:43], v[104:107]
  buffer_load_dwordx4 a[192:195], v4, s[16:19], s35 offen
  v_mfma_f32_16x16x32_bf16 v[124:127], a[56:59], a[44:47], v[124:127]
  buffer_load_dwordx4 a[212:215], v6, s[16:19], s34 offen offset:0
  v_mfma_f32_16x16x32_bf16 v[144:147], a[56:59], a[48:51], v[144:147]
  s_add_u32 s32, s23, 30720
  s_add_u32 s33, s24, 12288
  buffer_load_dwordx4 a[232:235], v5, s[16:19], s32 offen offset:0
  v_mfma_f32_16x16x32_bf16 v[88:91], a[60:63], a[36:39], v[88:91]
  buffer_load_dwordx4 a[216:219], v1, s[16:19], s33 offen
  v_mfma_f32_16x16x32_bf16 v[108:111], a[60:63], a[40:43], v[108:111]
  buffer_load_dwordx4 a[236:239], v5, s[16:19], s32 offen offset:1024
  v_mfma_f32_16x16x32_bf16 v[128:131], a[60:63], a[44:47], v[128:131]
  buffer_load_dwordx4 a[220:223], v2, s[16:19], s33 offen
  v_mfma_f32_16x16x32_bf16 v[148:151], a[60:63], a[48:51], v[148:151]
  buffer_load_dwordx4 a[240:243], v5, s[16:19], s32 offen offset:2048
  v_mfma_f32_16x16x32_bf16 v[92:95], a[64:67], a[36:39], v[92:95]
  buffer_load_dwordx4 a[224:227], v3, s[16:19], s33 offen
  v_mfma_f32_16x16x32_bf16 v[112:115], a[64:67], a[40:43], v[112:115]
  buffer_load_dwordx4 a[244:247], v5, s[16:19], s32 offen offset:3072
  v_mfma_f32_16x16x32_bf16 v[132:135], a[64:67], a[44:47], v[132:135]
  buffer_load_dwordx4 a[228:231], v4, s[16:19], s33 offen
  v_mfma_f32_16x16x32_bf16 v[152:155], a[64:67], a[48:51], v[152:155]
  buffer_load_dwordx4 a[248:251], v6, s[16:19], s32 offen offset:0
  s_waitcnt vmcnt(55)
  v_mfma_f32_16x16x32_bf16 v[96:99], a[68:71], a[36:39], v[96:99]
  v_mfma_f32_16x16x32_bf16 v[116:119], a[68:71], a[40:43], v[116:119]
  s_add_u32 s34, s23, 35840
  s_add_u32 s35, s24, 14336
  buffer_load_dwordx4 a[16:19], v5, s[16:19], s34 offen offset:0
  v_mfma_f32_16x16x32_bf16 v[136:139], a[68:71], a[44:47], v[136:139]
  v_mfma_f32_16x16x32_bf16 v[156:159], a[68:71], a[48:51], v[156:159]
  buffer_load_dwordx4 a[0:3], v1, s[16:19], s35 offen
  s_waitcnt vmcnt(55)
  v_mfma_f32_16x16x32_bf16 v[80:83], a[88:91], a[72:75], v[80:83]
  buffer_load_dwordx4 a[20:23], v5, s[16:19], s34 offen offset:1024
  s_waitcnt vmcnt(54)
  v_mfma_f32_16x16x32_bf16 v[100:103], a[88:91], a[76:79], v[100:103]
  buffer_load_dwordx4 a[4:7], v2, s[16:19], s35 offen
  s_waitcnt vmcnt(53)
  v_mfma_f32_16x16x32_bf16 v[120:123], a[88:91], a[80:83], v[120:123]
  buffer_load_dwordx4 a[24:27], v5, s[16:19], s34 offen offset:2048
  s_waitcnt vmcnt(52)
  v_mfma_f32_16x16x32_bf16 v[140:143], a[88:91], a[84:87], v[140:143]
  buffer_load_dwordx4 a[8:11], v3, s[16:19], s35 offen
  v_mfma_f32_16x16x32_bf16 v[84:87], a[92:95], a[72:75], v[84:87]
  buffer_load_dwordx4 a[28:31], v5, s[16:19], s34 offen offset:3072
  v_mfma_f32_16x16x32_bf16 v[104:107], a[92:95], a[76:79], v[104:107]
  buffer_load_dwordx4 a[12:15], v4, s[16:19], s35 offen
  v_mfma_f32_16x16x32_bf16 v[124:127], a[92:95], a[80:83], v[124:127]
  buffer_load_dwordx4 a[32:35], v6, s[16:19], s34 offen offset:0
  v_mfma_f32_16x16x32_bf16 v[144:147], a[92:95], a[84:87], v[144:147]
  s_add_u32 s32, s23, 40960
  s_add_u32 s33, s24, 16384
  buffer_load_dwordx4 a[52:55], v5, s[16:19], s32 offen offset:0
  v_mfma_f32_16x16x32_bf16 v[88:91], a[96:99], a[72:75], v[88:91]
  v_mfma_f32_16x16x32_bf16 v[108:111], a[96:99], a[76:79], v[108:111]
  buffer_load_dwordx4 a[36:39], v1, s[16:19], s33 offen
  v_mfma_f32_16x16x32_bf16 v[128:131], a[96:99], a[80:83], v[128:131]
  v_mfma_f32_16x16x32_bf16 v[148:151], a[96:99], a[84:87], v[148:151]
  buffer_load_dwordx4 a[56:59], v5, s[16:19], s32 offen offset:1024
  v_mfma_f32_16x16x32_bf16 v[92:95], a[100:103], a[72:75], v[92:95]
  v_mfma_f32_16x16x32_bf16 v[112:115], a[100:103], a[76:79], v[112:115]
  buffer_load_dwordx4 a[40:43], v2, s[16:19], s33 offen
  v_mfma_f32_16x16x32_bf16 v[132:135], a[100:103], a[80:83], v[132:135]
  v_mfma_f32_16x16x32_bf16 v[152:155], a[100:103], a[84:87], v[152:155]
  buffer_load_dwordx4 a[60:63], v5, s[16:19], s32 offen offset:2048
  s_waitcnt vmcnt(60)
  v_mfma_f32_16x16x32_bf16 v[96:99], a[104:107], a[72:75], v[96:99]
  v_mfma_f32_16x16x32_bf16 v[116:119], a[104:107], a[76:79], v[116:119]
  buffer_load_dwordx4 a[44:47], v3, s[16:19], s33 offen
  v_mfma_f32_16x16x32_bf16 v[136:139], a[104:107], a[80:83], v[136:139]
  v_mfma_f32_16x16x32_bf16 v[156:159], a[104:107], a[84:87], v[156:159]
  buffer_load_dwordx4 a[64:67], v5, s[16:19], s32 offen offset:3072
  s_waitcnt vmcnt(50)
  v_mfma_f32_16x16x32_bf16 v[80:83], a[124:127], a[108:111], v[80:83]
  buffer_load_dwordx4 a[48:51], v4, s[16:19], s33 offen
  s_waitcnt vmcnt(49)
  v_mfma_f32_16x16x32_bf16 v[100:103], a[124:127], a[112:115], v[100:103]
  buffer_load_dwordx4 a[68:71], v6, s[16:19], s32 offen offset:0
  s_waitcnt vmcnt(48)
  v_mfma_f32_16x16x32_bf16 v[120:123], a[124:127], a[116:119], v[120:123]
  s_waitcnt vmcnt(46)
  v_mfma_f32_16x16x32_bf16 v[140:143], a[124:127], a[120:123], v[140:143]
  s_add_u32 s34, s23, 46080
  s_add_u32 s35, s24, 18432
  buffer_load_dwordx4 a[88:91], v5, s[16:19], s34 offen offset:0
  v_mfma_f32_16x16x32_bf16 v[84:87], a[128:131], a[108:111], v[84:87]
  v_mfma_f32_16x16x32_bf16 v[104:107], a[128:131], a[112:115], v[104:107]
  buffer_load_dwordx4 a[72:75], v1, s[16:19], s35 offen
  v_mfma_f32_16x16x32_bf16 v[124:127], a[128:131], a[116:119], v[124:127]
  v_mfma_f32_16x16x32_bf16 v[144:147], a[128:131], a[120:123], v[144:147]
  buffer_load_dwordx4 a[92:95], v5, s[16:19], s34 offen offset:1024
  v_mfma_f32_16x16x32_bf16 v[88:91], a[132:135], a[108:111], v[88:91]
  v_mfma_f32_16x16x32_bf16 v[108:111], a[132:135], a[112:115], v[108:111]
  buffer_load_dwordx4 a[76:79], v2, s[16:19], s35 offen
  v_mfma_f32_16x16x32_bf16 v[128:131], a[132:135], a[116:119], v[128:131]
  v_mfma_f32_16x16x32_bf16 v[148:151], a[132:135], a[120:123], v[148:151]
  buffer_load_dwordx4 a[96:99], v5, s[16:19], s34 offen offset:2048
  v_mfma_f32_16x16x32_bf16 v[92:95], a[136:139], a[108:111], v[92:95]
  v_mfma_f32_16x16x32_bf16 v[112:115], a[136:139], a[112:115], v[112:115]
  buffer_load_dwordx4 a[80:83], v3, s[16:19], s35 offen
  v_mfma_f32_16x16x32_bf16 v[132:135], a[136:139], a[116:119], v[132:135]
  v_mfma_f32_16x16x32_bf16 v[152:155], a[136:139], a[120:123], v[152:155]
  buffer_load_dwordx4 a[100:103], v5, s[16:19], s34 offen offset:3072
  s_waitcnt vmcnt(52)
  v_mfma_f32_16x16x32_bf16 v[96:99], a[140:143], a[108:111], v[96:99]
  v_mfma_f32_16x16x32_bf16 v[116:119], a[140:143], a[112:115], v[116:119]
  buffer_load_dwordx4 a[84:87], v4, s[16:19], s35 offen
  v_mfma_f32_16x16x32_bf16 v[136:139], a[140:143], a[116:119], v[136:139]
  v_mfma_f32_16x16x32_bf16 v[156:159], a[140:143], a[120:123], v[156:159]
  buffer_load_dwordx4 a[104:107], v6, s[16:19], s34 offen offset:0
  s_waitcnt vmcnt(52)
  v_mfma_f32_16x16x32_bf16 v[80:83], a[160:163], a[144:147], v[80:83]
  s_waitcnt vmcnt(50)
  v_mfma_f32_16x16x32_bf16 v[100:103], a[160:163], a[148:151], v[100:103]
  s_add_u32 s32, s23, 51200
  s_add_u32 s33, s24, 20480
  buffer_load_dwordx4 a[124:127], v5, s[16:19], s32 offen offset:0
  s_waitcnt vmcnt(49)
  v_mfma_f32_16x16x32_bf16 v[120:123], a[160:163], a[152:155], v[120:123]
  s_waitcnt vmcnt(47)
  v_mfma_f32_16x16x32_bf16 v[140:143], a[160:163], a[156:159], v[140:143]
  buffer_load_dwordx4 a[108:111], v1, s[16:19], s33 offen
  v_mfma_f32_16x16x32_bf16 v[84:87], a[164:167], a[144:147], v[84:87]
  v_mfma_f32_16x16x32_bf16 v[104:107], a[164:167], a[148:151], v[104:107]
  buffer_load_dwordx4 a[128:131], v5, s[16:19], s32 offen offset:1024
  v_mfma_f32_16x16x32_bf16 v[124:127], a[164:167], a[152:155], v[124:127]
  v_mfma_f32_16x16x32_bf16 v[144:147], a[164:167], a[156:159], v[144:147]
  buffer_load_dwordx4 a[112:115], v2, s[16:19], s33 offen
  v_mfma_f32_16x16x32_bf16 v[88:91], a[168:171], a[144:147], v[88:91]
  v_mfma_f32_16x16x32_bf16 v[108:111], a[168:171], a[148:151], v[108:111]
  buffer_load_dwordx4 a[132:135], v5, s[16:19], s32 offen offset:2048
  v_mfma_f32_16x16x32_bf16 v[128:131], a[168:171], a[152:155], v[128:131]
  v_mfma_f32_16x16x32_bf16 v[148:151], a[168:171], a[156:159], v[148:151]
  buffer_load_dwordx4 a[116:119], v3, s[16:19], s33 offen
  v_mfma_f32_16x16x32_bf16 v[92:95], a[172:175], a[144:147], v[92:95]
  v_mfma_f32_16x16x32_bf16 v[112:115], a[172:175], a[148:151], v[112:115]
  buffer_load_dwordx4 a[136:139], v5, s[16:19], s32 offen offset:3072
  v_mfma_f32_16x16x32_bf16 v[132:135], a[172:175], a[152:155], v[132:135]
  v_mfma_f32_16x16x32_bf16 v[152:155], a[172:175], a[156:159], v[152:155]
  buffer_load_dwordx4 a[120:123], v4, s[16:19], s33 offen
  s_waitcnt vmcnt(53)
  v_mfma_f32_16x16x32_bf16 v[96:99], a[176:179], a[144:147], v[96:99]
  v_mfma_f32_16x16x32_bf16 v[116:119], a[176:179], a[148:151], v[116:119]
  buffer_load_dwordx4 a[140:143], v6, s[16:19], s32 offen offset:0
  v_mfma_f32_16x16x32_bf16 v[136:139], a[176:179], a[152:155], v[136:139]
  v_mfma_f32_16x16x32_bf16 v[156:159], a[176:179], a[156:159], v[156:159]
  s_waitcnt vmcnt(52)
  v_mfma_f32_16x16x32_bf16 v[80:83], a[196:199], a[180:183], v[80:83]
  s_waitcnt vmcnt(50)
  v_mfma_f32_16x16x32_bf16 v[100:103], a[196:199], a[184:187], v[100:103]
  s_add_u32 s34, s23, 56320
  s_add_u32 s35, s24, 22528
  buffer_load_dwordx4 a[160:163], v5, s[16:19], s34 offen offset:0
  s_waitcnt vmcnt(49)
  v_mfma_f32_16x16x32_bf16 v[120:123], a[196:199], a[188:191], v[120:123]
  s_waitcnt vmcnt(47)
  v_mfma_f32_16x16x32_bf16 v[140:143], a[196:199], a[192:195], v[140:143]
  buffer_load_dwordx4 a[144:147], v1, s[16:19], s35 offen
  v_mfma_f32_16x16x32_bf16 v[84:87], a[200:203], a[180:183], v[84:87]
  v_mfma_f32_16x16x32_bf16 v[104:107], a[200:203], a[184:187], v[104:107]
  buffer_load_dwordx4 a[164:167], v5, s[16:19], s34 offen offset:1024
  v_mfma_f32_16x16x32_bf16 v[124:127], a[200:203], a[188:191], v[124:127]
  v_mfma_f32_16x16x32_bf16 v[144:147], a[200:203], a[192:195], v[144:147]
  buffer_load_dwordx4 a[148:151], v2, s[16:19], s35 offen
  v_mfma_f32_16x16x32_bf16 v[88:91], a[204:207], a[180:183], v[88:91]
  v_mfma_f32_16x16x32_bf16 v[108:111], a[204:207], a[184:187], v[108:111]
  buffer_load_dwordx4 a[168:171], v5, s[16:19], s34 offen offset:2048
  v_mfma_f32_16x16x32_bf16 v[128:131], a[204:207], a[188:191], v[128:131]
  v_mfma_f32_16x16x32_bf16 v[148:151], a[204:207], a[192:195], v[148:151]
  buffer_load_dwordx4 a[152:155], v3, s[16:19], s35 offen
  v_mfma_f32_16x16x32_bf16 v[92:95], a[208:211], a[180:183], v[92:95]
  v_mfma_f32_16x16x32_bf16 v[112:115], a[208:211], a[184:187], v[112:115]
  buffer_load_dwordx4 a[172:175], v5, s[16:19], s34 offen offset:3072
  v_mfma_f32_16x16x32_bf16 v[132:135], a[208:211], a[188:191], v[132:135]
  v_mfma_f32_16x16x32_bf16 v[152:155], a[208:211], a[192:195], v[152:155]
  buffer_load_dwordx4 a[156:159], v4, s[16:19], s35 offen
  s_waitcnt vmcnt(53)
  v_mfma_f32_16x16x32_bf16 v[96:99], a[212:215], a[180:183], v[96:99]
  v_mfma_f32_16x16x32_bf16 v[116:119], a[212:215], a[184:187], v[116:119]
  buffer_load_dwordx4 a[176:179], v6, s[16:19], s34 offen offset:0
  v_mfma_f32_16x16x32_bf16 v[136:139], a[212:215], a[188:191], v[136:139]
  v_mfma_f32_16x16x32_bf16 v[156:159], a[212:215], a[192:195], v[156:159]
  s_waitcnt vmcnt(52)
  v_mfma_f32_16x16x32_bf16 v[80:83], a[232:235], a[216:219], v[80:83]
  s_waitcnt vmcnt(50)
  v_mfma_f32_16x16x32_bf16 v[100:103], a[232:235], a[220:223], v[100:103]
  s_add_u32 s32, s23, 61440
  s_add_u32 s33, s24, 24576
  buffer_load_dwordx4 a[196:199], v5, s[16:19], s32 offen offset:0
  s_waitcnt vmcnt(49)
  v_mfma_f32_16x16x32_bf16 v[120:123], a[232:235], a[224:227], v[120:123]
  s_waitcnt vmcnt(47)
  v_mfma_f32_16x16x32_bf16 v[140:143], a[232:235], a[228:231], v[140:143]
  buffer_load_dwordx4 a[180:183], v1, s[16:19], s33 offen
  v_mfma_f32_16x16x32_bf16 v[84:87], a[236:239], a[216:219], v[84:87]
  v_mfma_f32_16x16x32_bf16 v[104:107], a[236:239], a[220:223], v[104:107]
  buffer_load_dwordx4 a[200:203], v5, s[16:19], s32 offen offset:1024
  v_mfma_f32_16x16x32_bf16 v[124:127], a[236:239], a[224:227], v[124:127]
  v_mfma_f32_16x16x32_bf16 v[144:147], a[236:239], a[228:231], v[144:147]
  buffer_load_dwordx4 a[184:187], v2, s[16:19], s33 offen
  v_mfma_f32_16x16x32_bf16 v[88:91], a[240:243], a[216:219], v[88:91]
  v_mfma_f32_16x16x32_bf16 v[108:111], a[240:243], a[220:223], v[108:111]
  buffer_load_dwordx4 a[204:207], v5, s[16:19], s32 offen offset:2048
  v_mfma_f32_16x16x32_bf16 v[128:131], a[240:243], a[224:227], v[128:131]
  v_mfma_f32_16x16x32_bf16 v[148:151], a[240:243], a[228:231], v[148:151]
  buffer_load_dwordx4 a[188:191], v3, s[16:19], s33 offen
  v_mfma_f32_16x16x32_bf16 v[92:95], a[244:247], a[216:219], v[92:95]
  v_mfma_f32_16x16x32_bf16 v[112:115], a[244:247], a[220:223], v[112:115]
  buffer_load_dwordx4 a[208:211], v5, s[16:19], s32 offen offset:3072
  v_mfma_f32_16x16x32_bf16 v[132:135], a[244:247], a[224:227], v[132:135]
  v_mfma_f32_16x16x32_bf16 v[152:155], a[244:247], a[228:231], v[152:155]
  buffer_load_dwordx4 a[192:195], v4, s[16:19], s33 offen
  s_waitcnt vmcnt(53)
  v_mfma_f32_16x16x32_bf16 v[96:99], a[248:251], a[216:219], v[96:99]
  v_mfma_f32_16x16x32_bf16 v[116:119], a[248:251], a[220:223], v[116:119]
  buffer_load_dwordx4 a[212:215], v6, s[16:19], s32 offen offset:0
  v_mfma_f32_16x16x32_bf16 v[136:139], a[248:251], a[224:227], v[136:139]
  v_mfma_f32_16x16x32_bf16 v[156:159], a[248:251], a[228:231], v[156:159]
  s_waitcnt vmcnt(52)
  v_mfma_f32_16x16x32_bf16 v[80:83], a[16:19], a[0:3], v[80:83]
  s_waitcnt vmcnt(50)
  v_mfma_f32_16x16x32_bf16 v[100:103], a[16:19], a[4:7], v[100:103]
  s_add_u32 s34, s23, 66560
  s_add_u32 s35, s24, 26624
  buffer_load_dwordx4 a[232:235], v5, s[16:19], s34 offen offset:0
  s_waitcnt vmcnt(49)
  v_mfma_f32_16x16x32_bf16 v[120:123], a[16:19], a[8:11], v[120:123]
  s_waitcnt vmcnt(47)
  v_mfma_f32_16x16x32_bf16 v[140:143], a[16:19], a[12:15], v[140:143]
  buffer_load_dwordx4 a[216:219], v1, s[16:19], s35 offen
  v_mfma_f32_16x16x32_bf16 v[84:87], a[20:23], a[0:3], v[84:87]
  v_mfma_f32_16x16x32_bf16 v[104:107], a[20:23], a[4:7], v[104:107]
  buffer_load_dwordx4 a[236:239], v5, s[16:19], s34 offen offset:1024
  v_mfma_f32_16x16x32_bf16 v[124:127], a[20:23], a[8:11], v[124:127]
  v_mfma_f32_16x16x32_bf16 v[144:147], a[20:23], a[12:15], v[144:147]
  buffer_load_dwordx4 a[220:223], v2, s[16:19], s35 offen
  v_mfma_f32_16x16x32_bf16 v[88:91], a[24:27], a[0:3], v[88:91]
  v_mfma_f32_16x16x32_bf16 v[108:111], a[24:27], a[4:7], v[108:111]
  buffer_load_dwordx4 a[240:243], v5, s[16:19], s34 offen offset:2048
  v_mfma_f32_16x16x32_bf16 v[128:131], a[24:27], a[8:11], v[128:131]
  v_mfma_f32_16x16x32_bf16 v[148:151], a[24:27], a[12:15], v[148:151]
  buffer_load_dwordx4 a[224:227], v3, s[16:19], s35 offen
  v_mfma_f32_16x16x32_bf16 v[92:95], a[28:31], a[0:3], v[92:95]
  v_mfma_f32_16x16x32_bf16 v[112:115], a[28:31], a[4:7], v[112:115]
  buffer_load_dwordx4 a[244:247], v5, s[16:19], s34 offen offset:3072
  v_mfma_f32_16x16x32_bf16 v[132:135], a[28:31], a[8:11], v[132:135]
  v_mfma_f32_16x16x32_bf16 v[152:155], a[28:31], a[12:15], v[152:155]
  buffer_load_dwordx4 a[228:231], v4, s[16:19], s35 offen
  s_waitcnt vmcnt(53)
  v_mfma_f32_16x16x32_bf16 v[96:99], a[32:35], a[0:3], v[96:99]
  v_mfma_f32_16x16x32_bf16 v[116:119], a[32:35], a[4:7], v[116:119]
  buffer_load_dwordx4 a[248:251], v6, s[16:19], s34 offen offset:0
  v_mfma_f32_16x16x32_bf16 v[136:139], a[32:35], a[8:11], v[136:139]
  v_mfma_f32_16x16x32_bf16 v[156:159], a[32:35], a[12:15], v[156:159]
  s_waitcnt vmcnt(52)
  v_mfma_f32_16x16x32_bf16 v[80:83], a[52:55], a[36:39], v[80:83]
  s_waitcnt vmcnt(50)
  v_mfma_f32_16x16x32_bf16 v[100:103], a[52:55], a[40:43], v[100:103]
  s_add_u32 s32, s23, 71680
  s_add_u32 s33, s24, 28672
  buffer_load_dwordx4 a[16:19], v5, s[16:19], s32 offen offset:0
  s_waitcnt vmcnt(49)
  v_mfma_f32_16x16x32_bf16 v[120:123], a[52:55], a[44:47], v[120:123]
  s_waitcnt vmcnt(47)
  v_mfma_f32_16x16x32_bf16 v[140:143], a[52:55], a[48:51], v[140:143]
  buffer_load_dwordx4 a[0:3], v1, s[16:19], s33 offen
  v_mfma_f32_16x16x32_bf16 v[84:87], a[56:59], a[36:39], v[84:87]
  v_mfma_f32_16x16x32_bf16 v[104:107], a[56:59], a[40:43], v[104:107]
  buffer_load_dwordx4 a[20:23], v5, s[16:19], s32 offen offset:1024
  v_mfma_f32_16x16x32_bf16 v[124:127], a[56:59], a[44:47], v[124:127]
  v_mfma_f32_16x16x32_bf16 v[144:147], a[56:59], a[48:51], v[144:147]
  buffer_load_dwordx4 a[4:7], v2, s[16:19], s33 offen
  v_mfma_f32_16x16x32_bf16 v[88:91], a[60:63], a[36:39], v[88:91]
  v_mfma_f32_16x16x32_bf16 v[108:111], a[60:63], a[40:43], v[108:111]
  buffer_load_dwordx4 a[24:27], v5, s[16:19], s32 offen offset:2048
  v_mfma_f32_16x16x32_bf16 v[128:131], a[60:63], a[44:47], v[128:131]
  v_mfma_f32_16x16x32_bf16 v[148:151], a[60:63], a[48:51], v[148:151]
  buffer_load_dwordx4 a[8:11], v3, s[16:19], s33 offen
  v_mfma_f32_16x16x32_bf16 v[92:95], a[64:67], a[36:39], v[92:95]
  v_mfma_f32_16x16x32_bf16 v[112:115], a[64:67], a[40:43], v[112:115]
  buffer_load_dwordx4 a[28:31], v5, s[16:19], s32 offen offset:3072
  v_mfma_f32_16x16x32_bf16 v[132:135], a[64:67], a[44:47], v[132:135]
  v_mfma_f32_16x16x32_bf16 v[152:155], a[64:67], a[48:51], v[152:155]
  buffer_load_dwordx4 a[12:15], v4, s[16:19], s33 offen
  s_waitcnt vmcnt(53)
  v_mfma_f32_16x16x32_bf16 v[96:99], a[68:71], a[36:39], v[96:99]
  v_mfma_f32_16x16x32_bf16 v[116:119], a[68:71], a[40:43], v[116:119]
  buffer_load_dwordx4 a[32:35], v6, s[16:19], s32 offen offset:0
  v_mfma_f32_16x16x32_bf16 v[136:139], a[68:71], a[44:47], v[136:139]
  v_mfma_f32_16x16x32_bf16 v[156:159], a[68:71], a[48:51], v[156:159]
  v_mfma_f32_16x16x32_bf16 v[200:203], v[160:163], v[180:183], 0
  v_mfma_f32_16x16x32_bf16 v[200:203], v[164:167], v[184:187], v[200:203]
  v_mfma_f32_16x16x32_bf16 v[200:203], v[168:171], v[188:191], v[200:203]
  v_mfma_f32_16x16x32_bf16 v[200:203], v[172:175], v[192:195], v[200:203]
  v_mfma_f32_16x16x32_bf16 v[200:203], v[176:179], v[196:199], v[200:203]
  s_waitcnt vmcnt(52)
  v_mfma_f32_16x16x32_bf16 v[80:83], a[88:91], a[72:75], v[80:83]
  s_waitcnt vmcnt(50)
  v_mfma_f32_16x16x32_bf16 v[100:103], a[88:91], a[76:79], v[100:103]
  s_add_u32 s34, s23, 76800
  s_add_u32 s35, s24, 30720
  buffer_load_dwordx4 a[52:55], v5, s[16:19], s34 offen offset:0
  s_waitcnt vmcnt(49)
  v_mfma_f32_16x16x32_bf16 v[120:123], a[88:91], a[80:83], v[120:123]
  s_waitcnt vmcnt(47)
  v_mfma_f32_16x16x32_bf16 v[140:143], a[88:91], a[84:87], v[140:143]
  buffer_load_dwordx4 a[36:39], v1, s[16:19], s35 offen
  v_mfma_f32_16x16x32_bf16 v[84:87], a[92:95], a[72:75], v[84:87]
  v_mfma_f32_16x16x32_bf16 v[104:107], a[92:95], a[76:79], v[104:107]
  buffer_load_dwordx4 a[56:59], v5, s[16:19], s34 offen offset:1024
  v_mfma_f32_16x16x32_bf16 v[124:127], a[92:95], a[80:83], v[124:127]
  v_mfma_f32_16x16x32_bf16 v[144:147], a[92:95], a[84:87], v[144:147]
  buffer_load_dwordx4 a[40:43], v2, s[16:19], s35 offen
  v_mfma_f32_16x16x32_bf16 v[88:91], a[96:99], a[72:75], v[88:91]
  v_mfma_f32_16x16x32_bf16 v[108:111], a[96:99], a[76:79], v[108:111]
  buffer_load_dwordx4 a[60:63], v5, s[16:19], s34 offen offset:2048
  v_mfma_f32_16x16x32_bf16 v[128:131], a[96:99], a[80:83], v[128:131]
  v_mfma_f32_16x16x32_bf16 v[148:151], a[96:99], a[84:87], v[148:151]
  buffer_load_dwordx4 a[44:47], v3, s[16:19], s35 offen
  v_mfma_f32_16x16x32_bf16 v[92:95], a[100:103], a[72:75], v[92:95]
  v_mfma_f32_16x16x32_bf16 v[112:115], a[100:103], a[76:79], v[112:115]
  buffer_load_dwordx4 a[64:67], v5, s[16:19], s34 offen offset:3072
  v_mfma_f32_16x16x32_bf16 v[132:135], a[100:103], a[80:83], v[132:135]
  v_mfma_f32_16x16x32_bf16 v[152:155], a[100:103], a[84:87], v[152:155]
  buffer_load_dwordx4 a[48:51], v4, s[16:19], s35 offen
  s_waitcnt vmcnt(53)
  v_mfma_f32_16x16x32_bf16 v[96:99], a[104:107], a[72:75], v[96:99]
  v_mfma_f32_16x16x32_bf16 v[116:119], a[104:107], a[76:79], v[116:119]
  buffer_load_dwordx4 a[68:71], v6, s[16:19], s34 offen offset:0
  v_mfma_f32_16x16x32_bf16 v[136:139], a[104:107], a[80:83], v[136:139]
  v_mfma_f32_16x16x32_bf16 v[156:159], a[104:107], a[84:87], v[156:159]
  buffer_store_dwordx4 v[200:203], v206, s[16:19], s46 offen sc1
  s_waitcnt vmcnt(53)
  v_mfma_f32_16x16x32_bf16 v[80:83], a[124:127], a[108:111], v[80:83]
  s_waitcnt vmcnt(51)
  v_mfma_f32_16x16x32_bf16 v[100:103], a[124:127], a[112:115], v[100:103]
  s_add_u32 s32, s23, 81920
  s_add_u32 s33, s24, 32768
  buffer_load_dwordx4 a[88:91], v5, s[16:19], s32 offen offset:0
  s_waitcnt vmcnt(50)
  v_mfma_f32_16x16x32_bf16 v[120:123], a[124:127], a[116:119], v[120:123]
  s_waitcnt vmcnt(48)
  v_mfma_f32_16x16x32_bf16 v[140:143], a[124:127], a[120:123], v[140:143]
  buffer_load_dwordx4 a[72:75], v1, s[16:19], s33 offen
  v_mfma_f32_16x16x32_bf16 v[84:87], a[128:131], a[108:111], v[84:87]
  v_mfma_f32_16x16x32_bf16 v[104:107], a[128:131], a[112:115], v[104:107]
  buffer_load_dwordx4 a[92:95], v5, s[16:19], s32 offen offset:1024
  v_mfma_f32_16x16x32_bf16 v[124:127], a[128:131], a[116:119], v[124:127]
  v_mfma_f32_16x16x32_bf16 v[144:147], a[128:131], a[120:123], v[144:147]
  buffer_load_dwordx4 a[76:79], v2, s[16:19], s33 offen
  v_mfma_f32_16x16x32_bf16 v[88:91], a[132:135], a[108:111], v[88:91]
  v_mfma_f32_16x16x32_bf16 v[108:111], a[132:135], a[112:115], v[108:111]
  buffer_load_dwordx4 a[96:99], v5, s[16:19], s32 offen offset:2048
  v_mfma_f32_16x16x32_bf16 v[128:131], a[132:135], a[116:119], v[128:131]
  v_mfma_f32_16x16x32_bf16 v[148:151], a[132:135], a[120:123], v[148:151]
  buffer_load_dwordx4 a[80:83], v3, s[16:19], s33 offen
  v_mfma_f32_16x16x32_bf16 v[92:95], a[136:139], a[108:111], v[92:95]
  v_mfma_f32_16x16x32_bf16 v[112:115], a[136:139], a[112:115], v[112:115]
  buffer_load_dwordx4 a[100:103], v5, s[16:19], s32 offen offset:3072
  v_mfma_f32_16x16x32_bf16 v[132:135], a[136:139], a[116:119], v[132:135]
  v_mfma_f32_16x16x32_bf16 v[152:155], a[136:139], a[120:123], v[152:155]
  buffer_load_dwordx4 a[84:87], v4, s[16:19], s33 offen
  s_waitcnt vmcnt(54)
  v_mfma_f32_16x16x32_bf16 v[96:99], a[140:143], a[108:111], v[96:99]
  v_mfma_f32_16x16x32_bf16 v[116:119], a[140:143], a[112:115], v[116:119]
  buffer_load_dwordx4 a[104:107], v6, s[16:19], s32 offen offset:0
  v_mfma_f32_16x16x32_bf16 v[136:139], a[140:143], a[116:119], v[136:139]
  v_mfma_f32_16x16x32_bf16 v[156:159], a[140:143], a[120:123], v[156:159]
  s_waitcnt vmcnt(53)
  v_mfma_f32_16x16x32_bf16 v[80:83], a[160:163], a[144:147], v[80:83]
  s_waitcnt vmcnt(51)
  v_mfma_f32_16x16x32_bf16 v[100:103], a[160:163], a[148:151], v[100:103]
  s_add_u32 s34, s23, 87040
  s_add_u32 s35, s24, 34816
  buffer_load_dwordx4 a[124:127], v5, s[16:19], s34 offen offset:0
  s_waitcnt vmcnt(50)
  v_mfma_f32_16x16x32_bf16 v[120:123], a[160:163], a[152:155], v[120:123]
  s_waitcnt vmcnt(48)
  v_mfma_f32_16x16x32_bf16 v[140:143], a[160:163], a[156:159], v[140:143]
  buffer_load_dwordx4 a[108:111], v1, s[16:19], s35 offen
  v_mfma_f32_16x16x32_bf16 v[84:87], a[164:167], a[144:147], v[84:87]
  v_mfma_f32_16x16x32_bf16 v[104:107], a[164:167], a[148:151], v[104:107]
  buffer_load_dwordx4 a[128:131], v5, s[16:19], s34 offen offset:1024
  v_mfma_f32_16x16x32_bf16 v[124:127], a[164:167], a[152:155], v[124:127]
  v_mfma_f32_16x16x32_bf16 v[144:147], a[164:167], a[156:159], v[144:147]
  buffer_load_dwordx4 a[112:115], v2, s[16:19], s35 offen
  v_mfma_f32_16x16x32_bf16 v[88:91], a[168:171], a[144:147], v[88:91]
  v_mfma_f32_16x16x32_bf16 v[108:111], a[168:171], a[148:151], v[108:111]
  buffer_load_dwordx4 a[132:135], v5, s[16:19], s34 offen offset:2048
  v_mfma_f32_16x16x32_bf16 v[128:131], a[168:171], a[152:155], v[128:131]
  v_mfma_f32_16x16x32_bf16 v[148:151], a[168:171], a[156:159], v[148:151]
  buffer_load_dwordx4 a[116:119], v3, s[16:19], s35 offen
  v_mfma_f32_16x16x32_bf16 v[92:95], a[172:175], a[144:147], v[92:95]
  v_mfma_f32_16x16x32_bf16 v[112:115], a[172:175], a[148:151], v[112:115]
  buffer_load_dwordx4 a[136:139], v5, s[16:19], s34 offen offset:3072
  v_mfma_f32_16x16x32_bf16 v[132:135], a[172:175], a[152:155], v[132:135]
  v_mfma_f32_16x16x32_bf16 v[152:155], a[172:175], a[156:159], v[152:155]
  buffer_load_dwordx4 a[120:123], v4, s[16:19], s35 offen
  s_waitcnt vmcnt(54)
  v_mfma_f32_16x16x32_bf16 v[96:99], a[176:179], a[144:147], v[96:99]
  v_mfma_f32_16x16x32_bf16 v[116:119], a[176:179], a[148:151], v[116:119]
  buffer_load_dwordx4 a[140:143], v6, s[16:19], s34 offen offset:0
  v_mfma_f32_16x16x32_bf16 v[136:139], a[176:179], a[152:155], v[136:139]
  v_mfma_f32_16x16x32_bf16 v[156:159], a[176:179], a[156:159], v[156:159]
  s_waitcnt vmcnt(53)
  v_mfma_f32_16x16x32_bf16 v[80:83], a[196:199], a[180:183], v[80:83]
  s_waitcnt vmcnt(51)
  v_mfma_f32_16x16x32_bf16 v[100:103], a[196:199], a[184:187], v[100:103]
  s_add_u32 s32, s23, 92160
  s_add_u32 s33, s24, 36864
  buffer_load_dwordx4 a[160:163], v5, s[16:19], s32 offen offset:0
  s_waitcnt vmcnt(50)
  v_mfma_f32_16x16x32_bf16 v[120:123], a[196:199], a[188:191], v[120:123]
  s_waitcnt vmcnt(48)
  v_mfma_f32_16x16x32_bf16 v[140:143], a[196:199], a[192:195], v[140:143]
  buffer_load_dwordx4 a[144:147], v1, s[16:19], s33 offen
  v_mfma_f32_16x16x32_bf16 v[84:87], a[200:203], a[180:183], v[84:87]
  v_mfma_f32_16x16x32_bf16 v[104:107], a[200:203], a[184:187], v[104:107]
  buffer_load_dwordx4 a[164:167], v5, s[16:19], s32 offen offset:1024
  v_mfma_f32_16x16x32_bf16 v[124:127], a[200:203], a[188:191], v[124:127]
  v_mfma_f32_16x16x32_bf16 v[144:147], a[200:203], a[192:195], v[144:147]
  buffer_load_dwordx4 a[148:151], v2, s[16:19], s33 offen
  v_mfma_f32_16x16x32_bf16 v[88:91], a[204:207], a[180:183], v[88:91]
  v_mfma_f32_16x16x32_bf16 v[108:111], a[204:207], a[184:187], v[108:111]
  buffer_load_dwordx4 a[168:171], v5, s[16:19], s32 offen offset:2048
  v_mfma_f32_16x16x32_bf16 v[128:131], a[204:207], a[188:191], v[128:131]
  v_mfma_f32_16x16x32_bf16 v[148:151], a[204:207], a[192:195], v[148:151]
  buffer_load_dwordx4 a[152:155], v3, s[16:19], s33 offen
  v_mfma_f32_16x16x32_bf16 v[92:95], a[208:211], a[180:183], v[92:95]
  v_mfma_f32_16x16x32_bf16 v[112:115], a[208:211], a[184:187], v[112:115]
  buffer_load_dwordx4 a[172:175], v5, s[16:19], s32 offen offset:3072
  v_mfma_f32_16x16x32_bf16 v[132:135], a[208:211], a[188:191], v[132:135]
  v_mfma_f32_16x16x32_bf16 v[152:155], a[208:211], a[192:195], v[152:155]
  buffer_load_dwordx4 a[156:159], v4, s[16:19], s33 offen
  s_waitcnt vmcnt(54)
  v_mfma_f32_16x16x32_bf16 v[96:99], a[212:215], a[180:183], v[96:99]
  v_mfma_f32_16x16x32_bf16 v[116:119], a[212:215], a[184:187], v[116:119]
  buffer_load_dwordx4 a[176:179], v6, s[16:19], s32 offen offset:0
  v_mfma_f32_16x16x32_bf16 v[136:139], a[212:215], a[188:191], v[136:139]
  v_mfma_f32_16x16x32_bf16 v[156:159], a[212:215], a[192:195], v[156:159]
  s_waitcnt vmcnt(53)
  v_mfma_f32_16x16x32_bf16 v[80:83], a[232:235], a[216:219], v[80:83]
  s_waitcnt vmcnt(51)
  v_mfma_f32_16x16x32_bf16 v[100:103], a[232:235], a[220:223], v[100:103]
  s_add_u32 s34, s23, 97280
  s_add_u32 s35, s24, 38912
  buffer_load_dwordx4 a[196:199], v5, s[16:19], s34 offen offset:0
  s_waitcnt vmcnt(50)
  v_mfma_f32_16x16x32_bf16 v[120:123], a[232:235], a[224:227], v[120:123]
  s_waitcnt vmcnt(48)
  v_mfma_f32_16x16x32_bf16 v[140:143], a[232:235], a[228:231], v[140:143]
  buffer_load_dwordx4 a[180:183], v1, s[16:19], s35 offen
  v_mfma_f32_16x16x32_bf16 v[84:87], a[236:239], a[216:219], v[84:87]
  v_mfma_f32_16x16x32_bf16 v[104:107], a[236:239], a[220:223], v[104:107]
  buffer_load_dwordx4 a[200:203], v5, s[16:19], s34 offen offset:1024
  v_mfma_f32_16x16x32_bf16 v[124:127], a[236:239], a[224:227], v[124:127]
  v_mfma_f32_16x16x32_bf16 v[144:147], a[236:239], a[228:231], v[144:147]
  buffer_load_dwordx4 a[184:187], v2, s[16:19], s35 offen
  v_mfma_f32_16x16x32_bf16 v[88:91], a[240:243], a[216:219], v[88:91]
  v_mfma_f32_16x16x32_bf16 v[108:111], a[240:243], a[220:223], v[108:111]
  buffer_load_dwordx4 a[204:207], v5, s[16:19], s34 offen offset:2048
  v_mfma_f32_16x16x32_bf16 v[128:131], a[240:243], a[224:227], v[128:131]
  v_mfma_f32_16x16x32_bf16 v[148:151], a[240:243], a[228:231], v[148:151]
  buffer_load_dwordx4 a[188:191], v3, s[16:19], s35 offen
  v_mfma_f32_16x16x32_bf16 v[92:95], a[244:247], a[216:219], v[92:95]
  v_mfma_f32_16x16x32_bf16 v[112:115], a[244:247], a[220:223], v[112:115]
  buffer_load_dwordx4 a[208:211], v5, s[16:19], s34 offen offset:3072
  v_mfma_f32_16x16x32_bf16 v[132:135], a[244:247], a[224:227], v[132:135]
  v_mfma_f32_16x16x32_bf16 v[152:155], a[244:247], a[228:231], v[152:155]
  buffer_load_dwordx4 a[192:195], v4, s[16:19], s35 offen
  s_waitcnt vmcnt(54)
  v_mfma_f32_16x16x32_bf16 v[96:99], a[248:251], a[216:219], v[96:99]
  v_mfma_f32_16x16x32_bf16 v[116:119], a[248:251], a[220:223], v[116:119]
  buffer_load_dwordx4 a[212:215], v6, s[16:19], s34 offen offset:0
  v_mfma_f32_16x16x32_bf16 v[136:139], a[248:251], a[224:227], v[136:139]
  v_mfma_f32_16x16x32_bf16 v[156:159], a[248:251], a[228:231], v[156:159]
  s_waitcnt vmcnt(53)
  v_mfma_f32_16x16x32_bf16 v[80:83], a[16:19], a[0:3], v[80:83]
  s_waitcnt vmcnt(51)
  v_mfma_f32_16x16x32_bf16 v[100:103], a[16:19], a[4:7], v[100:103]
  s_add_u32 s32, s23, 102400
  s_add_u32 s33, s24, 40960
  buffer_load_dwordx4 a[232:235], v5, s[16:19], s32 offen offset:0
  s_waitcnt vmcnt(50)
  v_mfma_f32_16x16x32_bf16 v[120:123], a[16:19], a[8:11], v[120:123]
  s_waitcnt vmcnt(48)
  v_mfma_f32_16x16x32_bf16 v[140:143], a[16:19], a[12:15], v[140:143]
  buffer_load_dwordx4 a[216:219], v1, s[16:19], s33 offen
  v_mfma_f32_16x16x32_bf16 v[84:87], a[20:23], a[0:3], v[84:87]
  v_mfma_f32_16x16x32_bf16 v[104:107], a[20:23], a[4:7], v[104:107]
  buffer_load_dwordx4 a[236:239], v5, s[16:19], s32 offen offset:1024
  v_mfma_f32_16x16x32_bf16 v[124:127], a[20:23], a[8:11], v[124:127]
  v_mfma_f32_16x16x32_bf16 v[144:147], a[20:23], a[12:15], v[144:147]
  buffer_load_dwordx4 a[220:223], v2, s[16:19], s33 offen
  v_mfma_f32_16x16x32_bf16 v[88:91], a[24:27], a[0:3], v[88:91]
  v_mfma_f32_16x16x32_bf16 v[108:111], a[24:27], a[4:7], v[108:111]
  buffer_load_dwordx4 a[240:243], v5, s[16:19], s32 offen offset:2048
  v_mfma_f32_16x16x32_bf16 v[128:131], a[24:27], a[8:11], v[128:131]
  v_mfma_f32_16x16x32_bf16 v[148:151], a[24:27], a[12:15], v[148:151]
  buffer_load_dwordx4 a[224:227], v3, s[16:19], s33 offen
  v_mfma_f32_16x16x32_bf16 v[92:95], a[28:31], a[0:3], v[92:95]
  v_mfma_f32_16x16x32_bf16 v[112:115], a[28:31], a[4:7], v[112:115]
  buffer_load_dwordx4 a[244:247], v5, s[16:19], s32 offen offset:3072
  v_mfma_f32_16x16x32_bf16 v[132:135], a[28:31], a[8:11], v[132:135]
  v_mfma_f32_16x16x32_bf16 v[152:155], a[28:31], a[12:15], v[152:155]
  buffer_load_dwordx4 a[228:231], v4, s[16:19], s33 offen
  s_waitcnt vmcnt(54)
  v_mfma_f32_16x16x32_bf16 v[96:99], a[32:35], a[0:3], v[96:99]
  v_mfma_f32_16x16x32_bf16 v[116:119], a[32:35], a[4:7], v[116:119]
  buffer_load_dwordx4 a[248:251], v6, s[16:19], s32 offen offset:0
  v_mfma_f32_16x16x32_bf16 v[136:139], a[32:35], a[8:11], v[136:139]
  v_mfma_f32_16x16x32_bf16 v[156:159], a[32:35], a[12:15], v[156:159]
  s_waitcnt vmcnt(53)
  v_mfma_f32_16x16x32_bf16 v[80:83], a[52:55], a[36:39], v[80:83]
  s_waitcnt vmcnt(51)
  v_mfma_f32_16x16x32_bf16 v[100:103], a[52:55], a[40:43], v[100:103]
  s_add_u32 s34, s23, 107520
  s_add_u32 s35, s24, 43008
  buffer_load_dwordx4 a[16:19], v5, s[16:19], s34 offen offset:0
  s_waitcnt vmcnt(50)
  v_mfma_f32_16x16x32_bf16 v[120:123], a[52:55], a[44:47], v[120:123]
  s_waitcnt vmcnt(48)
  v_mfma_f32_16x16x32_bf16 v[140:143], a[52:55], a[48:51], v[140:143]
  buffer_load_dwordx4 a[0:3], v1, s[16:19], s35 offen
  v_mfma_f32_16x16x32_bf16 v[84:87], a[56:59], a[36:39], v[84:87]
  v_mfma_f32_16x16x32_bf16 v[104:107], a[56:59], a[40:43], v[104:107]
  buffer_load_dwordx4 a[20:23], v5, s[16:19], s34 offen offset:1024
  v_mfma_f32_16x16x32_bf16 v[124:127], a[56:59], a[44:47], v[124:127]
  v_mfma_f32_16x16x32_bf16 v[144:147], a[56:59], a[48:51], v[144:147]
  buffer_load_dwordx4 a[4:7], v2, s[16:19], s35 offen
  v_mfma_f32_16x16x32_bf16 v[88:91], a[60:63], a[36:39], v[88:91]
  v_mfma_f32_16x16x32_bf16 v[108:111], a[60:63], a[40:43], v[108:111]
  buffer_load_dwordx4 a[24:27], v5, s[16:19], s34 offen offset:2048
  v_mfma_f32_16x16x32_bf16 v[128:131], a[60:63], a[44:47], v[128:131]
  v_mfma_f32_16x16x32_bf16 v[148:151], a[60:63], a[48:51], v[148:151]
  buffer_load_dwordx4 a[8:11], v3, s[16:19], s35 offen
  v_mfma_f32_16x16x32_bf16 v[92:95], a[64:67], a[36:39], v[92:95]
  v_mfma_f32_16x16x32_bf16 v[112:115], a[64:67], a[40:43], v[112:115]
  buffer_load_dwordx4 a[28:31], v5, s[16:19], s34 offen offset:3072
  v_mfma_f32_16x16x32_bf16 v[132:135], a[64:67], a[44:47], v[132:135]
  v_mfma_f32_16x16x32_bf16 v[152:155], a[64:67], a[48:51], v[152:155]
  buffer_load_dwordx4 a[12:15], v4, s[16:19], s35 offen
  s_waitcnt vmcnt(54)
  v_mfma_f32_16x16x32_bf16 v[96:99], a[68:71], a[36:39], v[96:99]
  v_mfma_f32_16x16x32_bf16 v[116:119], a[68:71], a[40:43], v[116:119]
  buffer_load_dwordx4 a[32:35], v6, s[16:19], s34 offen offset:0
  v_mfma_f32_16x16x32_bf16 v[136:139], a[68:71], a[44:47], v[136:139]
  v_mfma_f32_16x16x32_bf16 v[156:159], a[68:71], a[48:51], v[156:159]
  s_waitcnt vmcnt(52)
  v_mfma_f32_16x16x32_bf16 v[80:83], a[88:91], a[72:75], v[80:83]
  s_waitcnt vmcnt(50)
  v_mfma_f32_16x16x32_bf16 v[100:103], a[88:91], a[76:79], v[100:103]
  s_add_u32 s32, s23, 112640
  s_add_u32 s33, s24, 45056
  buffer_load_dwordx4 a[52:55], v5, s[16:19], s32 offen offset:0
  s_waitcnt vmcnt(49)
  v_mfma_f32_16x16x32_bf16 v[120:123], a[88:91], a[80:83], v[120:123]
  s_waitcnt vmcnt(47)
  v_mfma_f32_16x16x32_bf16 v[140:143], a[88:91], a[84:87], v[140:143]
  buffer_load_dwordx4 a[36:39], v1, s[16:19], s33 offen
  v_mfma_f32_16x16x32_bf16 v[84:87], a[92:95], a[72:75], v[84:87]
  v_mfma_f32_16x16x32_bf16 v[104:107], a[92:95], a[76:79], v[104:107]
  buffer_load_dwordx4 a[56:59], v5, s[16:19], s32 offen offset:1024
  v_mfma_f32_16x16x32_bf16 v[124:127], a[92:95], a[80:83], v[124:127]
  v_mfma_f32_16x16x32_bf16 v[144:147], a[92:95], a[84:87], v[144:147]
  buffer_load_dwordx4 a[40:43], v2, s[16:19], s33 offen
  v_mfma_f32_16x16x32_bf16 v[88:91], a[96:99], a[72:75], v[88:91]
  v_mfma_f32_16x16x32_bf16 v[108:111], a[96:99], a[76:79], v[108:111]
  buffer_load_dwordx4 a[60:63], v5, s[16:19], s32 offen offset:2048
  v_mfma_f32_16x16x32_bf16 v[128:131], a[96:99], a[80:83], v[128:131]
  v_mfma_f32_16x16x32_bf16 v[148:151], a[96:99], a[84:87], v[148:151]
  buffer_load_dwordx4 a[44:47], v3, s[16:19], s33 offen
  v_mfma_f32_16x16x32_bf16 v[92:95], a[100:103], a[72:75], v[92:95]
  v_mfma_f32_16x16x32_bf16 v[112:115], a[100:103], a[76:79], v[112:115]
  buffer_load_dwordx4 a[64:67], v5, s[16:19], s32 offen offset:3072
  v_mfma_f32_16x16x32_bf16 v[132:135], a[100:103], a[80:83], v[132:135]
  v_mfma_f32_16x16x32_bf16 v[152:155], a[100:103], a[84:87], v[152:155]
  buffer_load_dwordx4 a[48:51], v4, s[16:19], s33 offen
  s_waitcnt vmcnt(53)
  v_mfma_f32_16x16x32_bf16 v[96:99], a[104:107], a[72:75], v[96:99]
  v_mfma_f32_16x16x32_bf16 v[116:119], a[104:107], a[76:79], v[116:119]
  buffer_load_dwordx4 a[68:71], v6, s[16:19], s32 offen offset:0
  v_mfma_f32_16x16x32_bf16 v[136:139], a[104:107], a[80:83], v[136:139]
  v_mfma_f32_16x16x32_bf16 v[156:159], a[104:107], a[84:87], v[156:159]
  s_waitcnt vmcnt(52)
  v_mfma_f32_16x16x32_bf16 v[80:83], a[124:127], a[108:111], v[80:83]
  s_waitcnt vmcnt(50)
  v_mfma_f32_16x16x32_bf16 v[100:103], a[124:127], a[112:115], v[100:103]
  s_add_u32 s34, s23, 117760
  s_add_u32 s35, s24, 47104
  buffer_load_dwordx4 a[88:91], v5, s[16:19], s34 offen offset:0
  s_waitcnt vmcnt(49)
  v_mfma_f32_16x16x32_bf16 v[120:123], a[124:127], a[116:119], v[120:123]
  s_waitcnt vmcnt(47)
  v_mfma_f32_16x16x32_bf16 v[140:143], a[124:127], a[120:123], v[140:143]
  buffer_load_dwordx4 a[72:75], v1, s[16:19], s35 offen
  v_mfma_f32_16x16x32_bf16 v[84:87], a[128:131], a[108:111], v[84:87]
  v_mfma_f32_16x16x32_bf16 v[104:107], a[128:131], a[112:115], v[104:107]
  buffer_load_dwordx4 a[92:95], v5, s[16:19], s34 offen offset:1024
  v_mfma_f32_16x16x32_bf16 v[124:127], a[128:131], a[116:119], v[124:127]
  v_mfma_f32_16x16x32_bf16 v[144:147], a[128:131], a[120:123], v[144:147]
  buffer_load_dwordx4 a[76:79], v2, s[16:19], s35 offen
  v_mfma_f32_16x16x32_bf16 v[88:91], a[132:135], a[108:111], v[88:91]
  v_mfma_f32_16x16x32_bf16 v[108:111], a[132:135], a[112:115], v[108:111]
  buffer_load_dwordx4 a[96:99], v5, s[16:19], s34 offen offset:2048
  v_mfma_f32_16x16x32_bf16 v[128:131], a[132:135], a[116:119], v[128:131]
  v_mfma_f32_16x16x32_bf16 v[148:151], a[132:135], a[120:123], v[148:151]
  buffer_load_dwordx4 a[80:83], v3, s[16:19], s35 offen
  v_mfma_f32_16x16x32_bf16 v[92:95], a[136:139], a[108:111], v[92:95]
  v_mfma_f32_16x16x32_bf16 v[112:115], a[136:139], a[112:115], v[112:115]
  buffer_load_dwordx4 a[100:103], v5, s[16:19], s34 offen offset:3072
  v_mfma_f32_16x16x32_bf16 v[132:135], a[136:139], a[116:119], v[132:135]
  v_mfma_f32_16x16x32_bf16 v[152:155], a[136:139], a[120:123], v[152:155]
  buffer_load_dwordx4 a[84:87], v4, s[16:19], s35 offen
  s_waitcnt vmcnt(53)
  v_mfma_f32_16x16x32_bf16 v[96:99], a[140:143], a[108:111], v[96:99]
  v_mfma_f32_16x16x32_bf16 v[116:119], a[140:143], a[112:115], v[116:119]
  buffer_load_dwordx4 a[104:107], v6, s[16:19], s34 offen offset:0
  v_mfma_f32_16x16x32_bf16 v[136:139], a[140:143], a[116:119], v[136:139]
  v_mfma_f32_16x16x32_bf16 v[156:159], a[140:143], a[120:123], v[156:159]
  s_waitcnt vmcnt(52)
  v_mfma_f32_16x16x32_bf16 v[80:83], a[160:163], a[144:147], v[80:83]
  s_waitcnt vmcnt(50)
  v_mfma_f32_16x16x32_bf16 v[100:103], a[160:163], a[148:151], v[100:103]
  s_add_u32 s32, s23, 122880
  s_add_u32 s33, s24, 49152
  buffer_load_dwordx4 a[124:127], v5, s[16:19], s32 offen offset:0
  s_waitcnt vmcnt(49)
  v_mfma_f32_16x16x32_bf16 v[120:123], a[160:163], a[152:155], v[120:123]
  s_waitcnt vmcnt(47)
  v_mfma_f32_16x16x32_bf16 v[140:143], a[160:163], a[156:159], v[140:143]
  buffer_load_dwordx4 a[108:111], v1, s[16:19], s33 offen
  v_mfma_f32_16x16x32_bf16 v[84:87], a[164:167], a[144:147], v[84:87]
  v_mfma_f32_16x16x32_bf16 v[104:107], a[164:167], a[148:151], v[104:107]
  buffer_load_dwordx4 a[128:131], v5, s[16:19], s32 offen offset:1024
  v_mfma_f32_16x16x32_bf16 v[124:127], a[164:167], a[152:155], v[124:127]
  v_mfma_f32_16x16x32_bf16 v[144:147], a[164:167], a[156:159], v[144:147]
  buffer_load_dwordx4 a[112:115], v2, s[16:19], s33 offen
  v_mfma_f32_16x16x32_bf16 v[88:91], a[168:171], a[144:147], v[88:91]
  v_mfma_f32_16x16x32_bf16 v[108:111], a[168:171], a[148:151], v[108:111]
  buffer_load_dwordx4 a[132:135], v5, s[16:19], s32 offen offset:2048
  v_mfma_f32_16x16x32_bf16 v[128:131], a[168:171], a[152:155], v[128:131]
  v_mfma_f32_16x16x32_bf16 v[148:151], a[168:171], a[156:159], v[148:151]
  buffer_load_dwordx4 a[116:119], v3, s[16:19], s33 offen
  v_mfma_f32_16x16x32_bf16 v[92:95], a[172:175], a[144:147], v[92:95]
  v_mfma_f32_16x16x32_bf16 v[112:115], a[172:175], a[148:151], v[112:115]
  buffer_load_dwordx4 a[136:139], v5, s[16:19], s32 offen offset:3072
  v_mfma_f32_16x16x32_bf16 v[132:135], a[172:175], a[152:155], v[132:135]
  v_mfma_f32_16x16x32_bf16 v[152:155], a[172:175], a[156:159], v[152:155]
  buffer_load_dwordx4 a[120:123], v4, s[16:19], s33 offen
  s_waitcnt vmcnt(53)
  v_mfma_f32_16x16x32_bf16 v[96:99], a[176:179], a[144:147], v[96:99]
  v_mfma_f32_16x16x32_bf16 v[116:119], a[176:179], a[148:151], v[116:119]
  buffer_load_dwordx4 a[140:143], v6, s[16:19], s32 offen offset:0
  v_mfma_f32_16x16x32_bf16 v[136:139], a[176:179], a[152:155], v[136:139]
  v_mfma_f32_16x16x32_bf16 v[156:159], a[176:179], a[156:159], v[156:159]
  s_waitcnt vmcnt(52)
  v_mfma_f32_16x16x32_bf16 v[80:83], a[196:199], a[180:183], v[80:83]
  s_waitcnt vmcnt(50)
  v_mfma_f32_16x16x32_bf16 v[100:103], a[196:199], a[184:187], v[100:103]
  s_add_u32 s34, s23, 128000
  s_add_u32 s35, s24, 51200
  buffer_load_dwordx4 a[160:163], v5, s[16:19], s34 offen offset:0
  s_waitcnt vmcnt(49)
  v_mfma_f32_16x16x32_bf16 v[120:123], a[196:199], a[188:191], v[120:123]
  s_waitcnt vmcnt(47)
  v_mfma_f32_16x16x32_bf16 v[140:143], a[196:199], a[192:195], v[140:143]
  buffer_load_dwordx4 a[144:147], v1, s[16:19], s35 offen
  v_mfma_f32_16x16x32_bf16 v[84:87], a[200:203], a[180:183], v[84:87]
  v_mfma_f32_16x16x32_bf16 v[104:107], a[200:203], a[184:187], v[104:107]
  buffer_load_dwordx4 a[164:167], v5, s[16:19], s34 offen offset:1024
  v_mfma_f32_16x16x32_bf16 v[124:127], a[200:203], a[188:191], v[124:127]
  v_mfma_f32_16x16x32_bf16 v[144:147], a[200:203], a[192:195], v[144:147]
  buffer_load_dwordx4 a[148:151], v2, s[16:19], s35 offen
  v_mfma_f32_16x16x32_bf16 v[88:91], a[204:207], a[180:183], v[88:91]
  v_mfma_f32_16x16x32_bf16 v[108:111], a[204:207], a[184:187], v[108:111]
  buffer_load_dwordx4 a[168:171], v5, s[16:19], s34 offen offset:2048
  v_mfma_f32_16x16x32_bf16 v[128:131], a[204:207], a[188:191], v[128:131]
  v_mfma_f32_16x16x32_bf16 v[148:151], a[204:207], a[192:195], v[148:151]
  buffer_load_dwordx4 a[152:155], v3, s[16:19], s35 offen
  v_mfma_f32_16x16x32_bf16 v[92:95], a[208:211], a[180:183], v[92:95]
  v_mfma_f32_16x16x32_bf16 v[112:115], a[208:211], a[184:187], v[112:115]
  buffer_load_dwordx4 a[172:175], v5, s[16:19], s34 offen offset:3072
  v_mfma_f32_16x16x32_bf16 v[132:135], a[208:211], a[188:191], v[132:135]
  v_mfma_f32_16x16x32_bf16 v[152:155], a[208:211], a[192:195], v[152:155]
  buffer_load_dwordx4 a[156:159], v4, s[16:19], s35 offen
  s_waitcnt vmcnt(53)
  v_mfma_f32_16x16x32_bf16 v[96:99], a[212:215], a[180:183], v[96:99]
  v_mfma_f32_16x16x32_bf16 v[116:119], a[212:215], a[184:187], v[116:119]
  buffer_load_dwordx4 a[176:179], v6, s[16:19], s34 offen offset:0
  v_mfma_f32_16x16x32_bf16 v[136:139], a[212:215], a[188:191], v[136:139]
  v_mfma_f32_16x16x32_bf16 v[156:159], a[212:215], a[192:195], v[156:159]
  s_waitcnt vmcnt(52)
  v_mfma_f32_16x16x32_bf16 v[80:83], a[232:235], a[216:219], v[80:83]
  s_waitcnt vmcnt(50)
  v_mfma_f32_16x16x32_bf16 v[100:103], a[232:235], a[220:223], v[100:103]
  s_add_u32 s32, s23, 133120
  s_add_u32 s33, s24, 53248
  buffer_load_dwordx4 a[196:199], v5, s[16:19], s32 offen offset:0
  s_waitcnt vmcnt(49)
  v_mfma_f32_16x16x32_bf16 v[120:123], a[232:235], a[224:227], v[120:123]
  s_waitcnt vmcnt(47)
  v_mfma_f32_16x16x32_bf16 v[140:143], a[232:235], a[228:231], v[140:143]
  buffer_load_dwordx4 a[180:183], v1, s[16:19], s33 offen
  v_mfma_f32_16x16x32_bf16 v[84:87], a[236:239], a[216:219], v[84:87]
  v_mfma_f32_16x16x32_bf16 v[104:107], a[236:239], a[220:223], v[104:107]
  buffer_load_dwordx4 a[200:203], v5, s[16:19], s32 offen offset:1024
  v_mfma_f32_16x16x32_bf16 v[124:127], a[236:239], a[224:227], v[124:127]
  v_mfma_f32_16x16x32_bf16 v[144:147], a[236:239], a[228:231], v[144:147]
  buffer_load_dwordx4 a[184:187], v2, s[16:19], s33 offen
  v_mfma_f32_16x16x32_bf16 v[88:91], a[240:243], a[216:219], v[88:91]
  v_mfma_f32_16x16x32_bf16 v[108:111], a[240:243], a[220:223], v[108:111]
  buffer_load_dwordx4 a[204:207], v5, s[16:19], s32 offen offset:2048
  v_mfma_f32_16x16x32_bf16 v[128:131], a[240:243], a[224:227], v[128:131]
  v_mfma_f32_16x16x32_bf16 v[148:151], a[240:243], a[228:231], v[148:151]
  buffer_load_dwordx4 a[188:191], v3, s[16:19], s33 offen
  v_mfma_f32_16x16x32_bf16 v[92:95], a[244:247], a[216:219], v[92:95]
  v_mfma_f32_16x16x32_bf16 v[112:115], a[244:247], a[220:223], v[112:115]
  buffer_load_dwordx4 a[208:211], v5, s[16:19], s32 offen offset:3072
  v_mfma_f32_16x16x32_bf16 v[132:135], a[244:247], a[224:227], v[132:135]
  v_mfma_f32_16x16x32_bf16 v[152:155], a[244:247], a[228:231], v[152:155]
  buffer_load_dwordx4 a[192:195], v4, s[16:19], s33 offen
  s_waitcnt vmcnt(53)
  v_mfma_f32_16x16x32_bf16 v[96:99], a[248:251], a[216:219], v[96:99]
  v_mfma_f32_16x16x32_bf16 v[116:119], a[248:251], a[220:223], v[116:119]
  buffer_load_dwordx4 a[212:215], v6, s[16:19], s32 offen offset:0
  v_mfma_f32_16x16x32_bf16 v[136:139], a[248:251], a[224:227], v[136:139]
  v_mfma_f32_16x16x32_bf16 v[156:159], a[248:251], a[228:231], v[156:159]
  s_waitcnt vmcnt(52)
  v_mfma_f32_16x16x32_bf16 v[80:83], a[16:19], a[0:3], v[80:83]
  s_waitcnt vmcnt(50)
  v_mfma_f32_16x16x32_bf16 v[100:103], a[16:19], a[4:7], v[100:103]
  s_add_u32 s34, s23, 138240
  s_add_u32 s35, s24, 55296
  buffer_load_dwordx4 a[232:235], v5, s[16:19], s34 offen offset:0
  s_waitcnt vmcnt(49)
  v_mfma_f32_16x16x32_bf16 v[120:123], a[16:19], a[8:11], v[120:123]
  s_waitcnt vmcnt(47)
  v_mfma_f32_16x16x32_bf16 v[140:143], a[16:19], a[12:15], v[140:143]
  buffer_load_dwordx4 a[216:219], v1, s[16:19], s35 offen
  v_mfma_f32_16x16x32_bf16 v[84:87], a[20:23], a[0:3], v[84:87]
  v_mfma_f32_16x16x32_bf16 v[104:107], a[20:23], a[4:7], v[104:107]
  buffer_load_dwordx4 a[236:239], v5, s[16:19], s34 offen offset:1024
  v_mfma_f32_16x16x32_bf16 v[124:127], a[20:23], a[8:11], v[124:127]
  v_mfma_f32_16x16x32_bf16 v[144:147], a[20:23], a[12:15], v[144:147]
  buffer_load_dwordx4 a[220:223], v2, s[16:19], s35 offen
  v_mfma_f32_16x16x32_bf16 v[88:91], a[24:27], a[0:3], v[88:91]
  v_mfma_f32_16x16x32_bf16 v[108:111], a[24:27], a[4:7], v[108:111]
  buffer_load_dwordx4 a[240:243], v5, s[16:19], s34 offen offset:2048
  v_mfma_f32_16x16x32_bf16 v[128:131], a[24:27], a[8:11], v[128:131]
  v_mfma_f32_16x16x32_bf16 v[148:151], a[24:27], a[12:15], v[148:151]
  buffer_load_dwordx4 a[224:227], v3, s[16:19], s35 offen
  v_mfma_f32_16x16x32_bf16 v[92:95], a[28:31], a[0:3], v[92:95]
  v_mfma_f32_16x16x32_bf16 v[112:115], a[28:31], a[4:7], v[112:115]
  buffer_load_dwordx4 a[244:247], v5, s[16:19], s34 offen offset:3072
  v_mfma_f32_16x16x32_bf16 v[132:135], a[28:31], a[8:11], v[132:135]
  v_mfma_f32_16x16x32_bf16 v[152:155], a[28:31], a[12:15], v[152:155]
  buffer_load_dwordx4 a[228:231], v4, s[16:19], s35 offen
  s_waitcnt vmcnt(53)
  v_mfma_f32_16x16x32_bf16 v[96:99], a[32:35], a[0:3], v[96:99]
  v_mfma_f32_16x16x32_bf16 v[116:119], a[32:35], a[4:7], v[116:119]
  buffer_load_dwordx4 a[248:251], v6, s[16:19], s34 offen offset:0
  v_mfma_f32_16x16x32_bf16 v[136:139], a[32:35], a[8:11], v[136:139]
  v_mfma_f32_16x16x32_bf16 v[156:159], a[32:35], a[12:15], v[156:159]
  s_waitcnt vmcnt(52)
  v_mfma_f32_16x16x32_bf16 v[80:83], a[52:55], a[36:39], v[80:83]
  s_waitcnt vmcnt(50)
  v_mfma_f32_16x16x32_bf16 v[100:103], a[52:55], a[40:43], v[100:103]
  s_add_u32 s32, s23, 143360
  s_add_u32 s33, s24, 57344
  buffer_load_dwordx4 a[16:19], v5, s[16:19], s32 offen offset:0
  s_waitcnt vmcnt(49)
  v_mfma_f32_16x16x32_bf16 v[120:123], a[52:55], a[44:47], v[120:123]
  s_waitcnt vmcnt(47)
  v_mfma_f32_16x16x32_bf16 v[140:143], a[52:55], a[48:51], v[140:143]
  buffer_load_dwordx4 a[0:3], v1, s[16:19], s33 offen
  v_mfma_f32_16x16x32_bf16 v[84:87], a[56:59], a[36:39], v[84:87]
  v_mfma_f32_16x16x32_bf16 v[104:107], a[56:59], a[40:43], v[104:107]
  buffer_load_dwordx4 a[20:23], v5, s[16:19], s32 offen offset:1024
  v_mfma_f32_16x16x32_bf16 v[124:127], a[56:59], a[44:47], v[124:127]
  v_mfma_f32_16x16x32_bf16 v[144:147], a[56:59], a[48:51], v[144:147]
  buffer_load_dwordx4 a[4:7], v2, s[16:19], s33 offen
  v_mfma_f32_16x16x32_bf16 v[88:91], a[60:63], a[36:39], v[88:91]
  v_mfma_f32_16x16x32_bf16 v[108:111], a[60:63], a[40:43], v[108:111]
  buffer_load_dwordx4 a[24:27], v5, s[16:19], s32 offen offset:2048
  v_mfma_f32_16x16x32_bf16 v[128:131], a[60:63], a[44:47], v[128:131]
  v_mfma_f32_16x16x32_bf16 v[148:151], a[60:63], a[48:51], v[148:151]
  buffer_load_dwordx4 a[8:11], v3, s[16:19], s33 offen
  v_mfma_f32_16x16x32_bf16 v[92:95], a[64:67], a[36:39], v[92:95]
  v_mfma_f32_16x16x32_bf16 v[112:115], a[64:67], a[40:43], v[112:115]
  buffer_load_dwordx4 a[28:31], v5, s[16:19], s32 offen offset:3072
  v_mfma_f32_16x16x32_bf16 v[132:135], a[64:67], a[44:47], v[132:135]
  v_mfma_f32_16x16x32_bf16 v[152:155], a[64:67], a[48:51], v[152:155]
  buffer_load_dwordx4 a[12:15], v4, s[16:19], s33 offen
  s_waitcnt vmcnt(53)
  v_mfma_f32_16x16x32_bf16 v[96:99], a[68:71], a[36:39], v[96:99]
  v_mfma_f32_16x16x32_bf16 v[116:119], a[68:71], a[40:43], v[116:119]
  buffer_load_dwordx4 a[32:35], v6, s[16:19], s32 offen offset:0
  v_mfma_f32_16x16x32_bf16 v[136:139], a[68:71], a[44:47], v[136:139]
  v_mfma_f32_16x16x32_bf16 v[156:159], a[68:71], a[48:51], v[156:159]
  s_waitcnt vmcnt(52)
  v_mfma_f32_16x16x32_bf16 v[80:83], a[88:91], a[72:75], v[80:83]
  s_waitcnt vmcnt(50)
  v_mfma_f32_16x16x32_bf16 v[100:103], a[88:91], a[76:79], v[100:103]
  s_add_u32 s34, s23, 148480
  s_add_u32 s35, s24, 59392
  buffer_load_dwordx4 a[52:55], v5, s[16:19], s34 offen offset:0
  s_waitcnt vmcnt(49)
  v_mfma_f32_16x16x32_bf16 v[120:123], a[88:91], a[80:83], v[120:123]
  s_waitcnt vmcnt(47)
  v_mfma_f32_16x16x32_bf16 v[140:143], a[88:91], a[84:87], v[140:143]
  buffer_load_dwordx4 a[36:39], v1, s[16:19], s35 offen
  v_mfma_f32_16x16x32_bf16 v[84:87], a[92:95], a[72:75], v[84:87]
  v_mfma_f32_16x16x32_bf16 v[104:107], a[92:95], a[76:79], v[104:107]
  buffer_load_dwordx4 a[56:59], v5, s[16:19], s34 offen offset:1024
  v_mfma_f32_16x16x32_bf16 v[124:127], a[92:95], a[80:83], v[124:127]
  v_mfma_f32_16x16x32_bf16 v[144:147], a[92:95], a[84:87], v[144:147]
  buffer_load_dwordx4 a[40:43], v2, s[16:19], s35 offen
  v_mfma_f32_16x16x32_bf16 v[88:91], a[96:99], a[72:75], v[88:91]
  v_mfma_f32_16x16x32_bf16 v[108:111], a[96:99], a[76:79], v[108:111]
  buffer_load_dwordx4 a[60:63], v5, s[16:19], s34 offen offset:2048
  v_mfma_f32_16x16x32_bf16 v[128:131], a[96:99], a[80:83], v[128:131]
  v_mfma_f32_16x16x32_bf16 v[148:151], a[96:99], a[84:87], v[148:151]
  buffer_load_dwordx4 a[44:47], v3, s[16:19], s35 offen
  v_mfma_f32_16x16x32_bf16 v[92:95], a[100:103], a[72:75], v[92:95]
  v_mfma_f32_16x16x32_bf16 v[112:115], a[100:103], a[76:79], v[112:115]
  buffer_load_dwordx4 a[64:67], v5, s[16:19], s34 offen offset:3072
  v_mfma_f32_16x16x32_bf16 v[132:135], a[100:103], a[80:83], v[132:135]
  v_mfma_f32_16x16x32_bf16 v[152:155], a[100:103], a[84:87], v[152:155]
  buffer_load_dwordx4 a[48:51], v4, s[16:19], s35 offen
  s_waitcnt vmcnt(53)
  v_mfma_f32_16x16x32_bf16 v[96:99], a[104:107], a[72:75], v[96:99]
  v_mfma_f32_16x16x32_bf16 v[116:119], a[104:107], a[76:79], v[116:119]
  buffer_load_dwordx4 a[68:71], v6, s[16:19], s34 offen offset:0
  v_mfma_f32_16x16x32_bf16 v[136:139], a[104:107], a[80:83], v[136:139]
  v_mfma_f32_16x16x32_bf16 v[156:159], a[104:107], a[84:87], v[156:159]
  s_waitcnt vmcnt(52)
  v_mfma_f32_16x16x32_bf16 v[80:83], a[124:127], a[108:111], v[80:83]
  s_waitcnt vmcnt(50)
  v_mfma_f32_16x16x32_bf16 v[100:103], a[124:127], a[112:115], v[100:103]
  s_add_u32 s32, s23, 153600
  s_add_u32 s33, s24, 61440
  buffer_load_dwordx4 a[88:91], v5, s[16:19], s32 offen offset:0
  s_waitcnt vmcnt(49)
  v_mfma_f32_16x16x32_bf16 v[120:123], a[124:127], a[116:119], v[120:123]
  s_waitcnt vmcnt(47)
  v_mfma_f32_16x16x32_bf16 v[140:143], a[124:127], a[120:123], v[140:143]
  buffer_load_dwordx4 a[72:75], v1, s[16:19], s33 offen
  v_mfma_f32_16x16x32_bf16 v[84:87], a[128:131], a[108:111], v[84:87]
  v_mfma_f32_16x16x32_bf16 v[104:107], a[128:131], a[112:115], v[104:107]
  buffer_load_dwordx4 a[92:95], v5, s[16:19], s32 offen offset:1024
  v_mfma_f32_16x16x32_bf16 v[124:127], a[128:131], a[116:119], v[124:127]
  v_mfma_f32_16x16x32_bf16 v[144:147], a[128:131], a[120:123], v[144:147]
  buffer_load_dwordx4 a[76:79], v2, s[16:19], s33 offen
  v_mfma_f32_16x16x32_bf16 v[88:91], a[132:135], a[108:111], v[88:91]
  v_mfma_f32_16x16x32_bf16 v[108:111], a[132:135], a[112:115], v[108:111]
  buffer_load_dwordx4 a[96:99], v5, s[16:19], s32 offen offset:2048
  v_mfma_f32_16x16x32_bf16 v[128:131], a[132:135], a[116:119], v[128:131]
  v_mfma_f32_16x16x32_bf16 v[148:151], a[132:135], a[120:123], v[148:151]
  buffer_load_dwordx4 a[80:83], v3, s[16:19], s33 offen
  v_mfma_f32_16x16x32_bf16 v[92:95], a[136:139], a[108:111], v[92:95]
  v_mfma_f32_16x16x32_bf16 v[112:115], a[136:139], a[112:115], v[112:115]
  buffer_load_dwordx4 a[100:103], v5, s[16:19], s32 offen offset:3072
  v_mfma_f32_16x16x32_bf16 v[132:135], a[136:139], a[116:119], v[132:135]
  v_mfma_f32_16x16x32_bf16 v[152:155], a[136:139], a[120:123], v[152:155]
  buffer_load_dwordx4 a[84:87], v4, s[16:19], s33 offen
  s_waitcnt vmcnt(53)
  v_mfma_f32_16x16x32_bf16 v[96:99], a[140:143], a[108:111], v[96:99]
  v_mfma_f32_16x16x32_bf16 v[116:119], a[140:143], a[112:115], v[116:119]
  buffer_load_dwordx4 a[104:107], v6, s[16:19], s32 offen offset:0
  v_mfma_f32_16x16x32_bf16 v[136:139], a[140:143], a[116:119], v[136:139]
  v_mfma_f32_16x16x32_bf16 v[156:159], a[140:143], a[120:123], v[156:159]
  s_waitcnt vmcnt(52)
  v_mfma_f32_16x16x32_bf16 v[80:83], a[160:163], a[144:147], v[80:83]
  s_waitcnt vmcnt(50)
  v_mfma_f32_16x16x32_bf16 v[100:103], a[160:163], a[148:151], v[100:103]
  s_add_u32 s34, s23, 158720
  s_add_u32 s35, s24, 63488
  buffer_load_dwordx4 a[124:127], v5, s[16:19], s34 offen offset:0
  s_waitcnt vmcnt(49)
  v_mfma_f32_16x16x32_bf16 v[120:123], a[160:163], a[152:155], v[120:123]
  s_waitcnt vmcnt(47)
  v_mfma_f32_16x16x32_bf16 v[140:143], a[160:163], a[156:159], v[140:143]
  buffer_load_dwordx4 a[108:111], v1, s[16:19], s35 offen
  v_mfma_f32_16x16x32_bf16 v[84:87], a[164:167], a[144:147], v[84:87]
  v_mfma_f32_16x16x32_bf16 v[104:107], a[164:167], a[148:151], v[104:107]
  buffer_load_dwordx4 a[128:131], v5, s[16:19], s34 offen offset:1024
  v_mfma_f32_16x16x32_bf16 v[124:127], a[164:167], a[152:155], v[124:127]
  v_mfma_f32_16x16x32_bf16 v[144:147], a[164:167], a[156:159], v[144:147]
  buffer_load_dwordx4 a[112:115], v2, s[16:19], s35 offen
  v_mfma_f32_16x16x32_bf16 v[88:91], a[168:171], a[144:147], v[88:91]
  v_mfma_f32_16x16x32_bf16 v[108:111], a[168:171], a[148:151], v[108:111]
  buffer_load_dwordx4 a[132:135], v5, s[16:19], s34 offen offset:2048
  v_mfma_f32_16x16x32_bf16 v[128:131], a[168:171], a[152:155], v[128:131]
  v_mfma_f32_16x16x32_bf16 v[148:151], a[168:171], a[156:159], v[148:151]
  buffer_load_dwordx4 a[116:119], v3, s[16:19], s35 offen
  v_mfma_f32_16x16x32_bf16 v[92:95], a[172:175], a[144:147], v[92:95]
  v_mfma_f32_16x16x32_bf16 v[112:115], a[172:175], a[148:151], v[112:115]
  buffer_load_dwordx4 a[136:139], v5, s[16:19], s34 offen offset:3072
  v_mfma_f32_16x16x32_bf16 v[132:135], a[172:175], a[152:155], v[132:135]
  v_mfma_f32_16x16x32_bf16 v[152:155], a[172:175], a[156:159], v[152:155]
  buffer_load_dwordx4 a[120:123], v4, s[16:19], s35 offen
  s_waitcnt vmcnt(53)
  v_mfma_f32_16x16x32_bf16 v[96:99], a[176:179], a[144:147], v[96:99]
  v_mfma_f32_16x16x32_bf16 v[116:119], a[176:179], a[148:151], v[116:119]
  buffer_load_dwordx4 a[140:143], v6, s[16:19], s34 offen offset:0
  v_mfma_f32_16x16x32_bf16 v[136:139], a[176:179], a[152:155], v[136:139]
  v_mfma_f32_16x16x32_bf16 v[156:159], a[176:179], a[156:159], v[156:159]
  buffer_load_dwordx4 v[24:27], v17, s[4:7], s36 offen
  buffer_load_dwordx4 v[28:31], v17, s[4:7], s36 offen offset:64
  buffer_load_dwordx2 v[32:33], v18, s[4:7], s36 offen offset:128
  s_add_u32 s40, s39, 5120
  buffer_load_dwordx4 v[36:39], v21, s[16:19], s40 offen offset:0
  buffer_load_dwordx4 v[40:43], v21, s[16:19], s40 offen offset:16
  buffer_load_dwordx4 v[44:47], v21, s[16:19], s40 offen offset:128
  buffer_load_dwordx4 v[48:51], v21, s[16:19], s40 offen offset:144
  buffer_load_dwordx4 v[52:55], v22, s[16:19], s40 offen offset:256
  s_add_u32 s40, s39, 10240
  buffer_load_dwordx4 v[56:59], v21, s[16:19], s40 offen offset:0
  buffer_load_dwordx4 v[60:63], v21, s[16:19], s40 offen offset:16
  buffer_load_dwordx4 v[64:67], v21, s[16:19], s40 offen offset:128
  buffer_load_dwordx4 v[68:71], v21, s[16:19], s40 offen offset:144
  buffer_load_dwordx4 v[72:75], v22, s[16:19], s40 offen offset:256
  s_waitcnt vmcnt(63)
  v_mfma_f32_16x16x32_bf16 v[80:83], a[196:199], a[180:183], v[80:83]
  v_mfma_f32_16x16x32_bf16 v[100:103], a[196:199], a[184:187], v[100:103]
  s_add_u32 s54, s52, 0
  s_add_u32 m0, s53, 0
  s_nop 0
  buffer_load_dwordx4 v5, s[16:19], s54 offen offset:0 lds
  s_waitcnt vmcnt(62)
  v_mfma_f32_16x16x32_bf16 v[120:123], a[196:199], a[188:191], v[120:123]
  s_waitcnt vmcnt(60)
  v_mfma_f32_16x16x32_bf16 v[140:143], a[196:199], a[192:195], v[140:143]
  v_mfma_f32_16x16x32_bf16 v[84:87], a[200:203], a[180:183], v[84:87]
  v_mfma_f32_16x16x32_bf16 v[104:107], a[200:203], a[184:187], v[104:107]
  buffer_load_dwordx4 v5, s[16:19], s54 offen offset:1024 lds
  v_mfma_f32_16x16x32_bf16 v[124:127], a[200:203], a[188:191], v[124:127]
  v_mfma_f32_16x16x32_bf16 v[144:147], a[200:203], a[192:195], v[144:147]
  v_mfma_f32_16x16x32_bf16 v[88:91], a[204:207], a[180:183], v[88:91]
  v_mfma_f32_16x16x32_bf16 v[108:111], a[204:207], a[184:187], v[108:111]
  buffer_load_dwordx4 v5, s[16:19], s54 offen offset:2048 lds
  v_mfma_f32_16x16x32_bf16 v[128:131], a[204:207], a[188:191], v[128:131]
  v_mfma_f32_16x16x32_bf16 v[148:151], a[204:207], a[192:195], v[148:151]
  v_mfma_f32_16x16x32_bf16 v[92:95], a[208:211], a[180:183], v[92:95]
  v_mfma_f32_16x16x32_bf16 v[112:115], a[208:211], a[184:187], v[112:115]
  buffer_load_dwordx4 v5, s[16:19], s54 offen offset:3072 lds
  v_mfma_f32_16x16x32_bf16 v[132:135], a[208:211], a[188:191], v[132:135]
  v_mfma_f32_16x16x32_bf16 v[152:155], a[208:211], a[192:195], v[152:155]
  s_waitcnt vmcnt(62)
  v_mfma_f32_16x16x32_bf16 v[96:99], a[212:215], a[180:183], v[96:99]
  v_mfma_f32_16x16x32_bf16 v[116:119], a[212:215], a[184:187], v[116:119]
  s_add_u32 s54, s52, 4096
  s_add_u32 m0, s53, 4096
  s_nop 0
  buffer_load_dwordx4 v5, s[16:19], s54 offen offset:0 lds
  v_mfma_f32_16x16x32_bf16 v[136:139], a[212:215], a[188:191], v[136:139]
  v_mfma_f32_16x16x32_bf16 v[156:159], a[212:215], a[192:195], v[156:159]
  s_waitcnt vmcnt(61)
  v_mfma_f32_16x16x32_bf16 v[80:83], a[232:235], a[216:219], v[80:83]
  s_waitcnt vmcnt(59)
  v_mfma_f32_16x16x32_bf16 v[100:103], a[232:235], a[220:223], v[100:103]
  buffer_load_dwordx4 v5, s[16:19], s54 offen offset:1024 lds
  s_waitcnt vmcnt(58)
  v_mfma_f32_16x16x32_bf16 v[120:123], a[232:235], a[224:227], v[120:123]
  s_waitcnt vmcnt(56)
  v_mfma_f32_16x16x32_bf16 v[140:143], a[232:235], a[228:231], v[140:143]
  v_mfma_f32_16x16x32_bf16 v[84:87], a[236:239], a[216:219], v[84:87]
  v_mfma_f32_16x16x32_bf16 v[104:107], a[236:239], a[220:223], v[104:107]
  buffer_load_dwordx4 v5, s[16:19], s54 offen offset:2048 lds
  v_mfma_f32_16x16x32_bf16 v[124:127], a[236:239], a[224:227], v[124:127]
  v_mfma_f32_16x16x32_bf16 v[144:147], a[236:239], a[228:231], v[144:147]
  v_mfma_f32_16x16x32_bf16 v[88:91], a[240:243], a[216:219], v[88:91]
  v_mfma_f32_16x16x32_bf16 v[108:111], a[240:243], a[220:223], v[108:111]
  s_add_u32 s54, s52, 28672
  s_add_u32 m0, s53, 28672
  s_nop 0
  buffer_load_dwordx4 v5, s[16:19], s54 offen offset:0 lds
  v_mfma_f32_16x16x32_bf16 v[128:131], a[240:243], a[224:227], v[128:131]
  v_mfma_f32_16x16x32_bf16 v[148:151], a[240:243], a[228:231], v[148:151]
  v_mfma_f32_16x16x32_bf16 v[92:95], a[244:247], a[216:219], v[92:95]
  v_mfma_f32_16x16x32_bf16 v[112:115], a[244:247], a[220:223], v[112:115]
  buffer_load_dwordx4 v5, s[16:19], s54 offen offset:1024 lds
  v_mfma_f32_16x16x32_bf16 v[132:135], a[244:247], a[224:227], v[132:135]
  v_mfma_f32_16x16x32_bf16 v[152:155], a[244:247], a[228:231], v[152:155]
  s_waitcnt vmcnt(58)
  v_mfma_f32_16x16x32_bf16 v[96:99], a[248:251], a[216:219], v[96:99]
  v_mfma_f32_16x16x32_bf16 v[116:119], a[248:251], a[220:223], v[116:119]
  buffer_load_dwordx4 v5, s[16:19], s54 offen offset:2048 lds
  v_mfma_f32_16x16x32_bf16 v[136:139], a[248:251], a[224:227], v[136:139]
  v_mfma_f32_16x16x32_bf16 v[156:159], a[248:251], a[228:231], v[156:159]
  s_waitcnt vmcnt(57)
  v_mfma_f32_16x16x32_bf16 v[80:83], a[16:19], a[0:3], v[80:83]
  s_waitcnt vmcnt(55)
  v_mfma_f32_16x16x32_bf16 v[100:103], a[16:19], a[4:7], v[100:103]
  buffer_load_dwordx4 v5, s[16:19], s54 offen offset:3072 lds
  s_waitcnt vmcnt(54)
  v_mfma_f32_16x16x32_bf16 v[120:123], a[16:19], a[8:11], v[120:123]
  s_waitcnt vmcnt(52)
  v_mfma_f32_16x16x32_bf16 v[140:143], a[16:19], a[12:15], v[140:143]
  v_mfma_f32_16x16x32_bf16 v[84:87], a[20:23], a[0:3], v[84:87]
  v_mfma_f32_16x16x32_bf16 v[104:107], a[20:23], a[4:7], v[104:107]
  s_add_u32 s54, s52, 32768
  s_add_u32 m0, s53, 32768
  s_nop 0
  buffer_load_dwordx4 v5, s[16:19], s54 offen offset:0 lds
  v_mfma_f32_16x16x32_bf16 v[124:127], a[20:23], a[8:11], v[124:127]
  v_mfma_f32_16x16x32_bf16 v[144:147], a[20:23], a[12:15], v[144:147]
  v_mfma_f32_16x16x32_bf16 v[88:91], a[24:27], a[0:3], v[88:91]
  v_mfma_f32_16x16x32_bf16 v[108:111], a[24:27], a[4:7], v[108:111]
  buffer_load_dwordx4 v5, s[16:19], s54 offen offset:1024 lds
  v_mfma_f32_16x16x32_bf16 v[128:131], a[24:27], a[8:11], v[128:131]
  v_mfma_f32_16x16x32_bf16 v[148:151], a[24:27], a[12:15], v[148:151]
  v_mfma_f32_16x16x32_bf16 v[92:95], a[28:31], a[0:3], v[92:95]
  v_mfma_f32_16x16x32_bf16 v[112:115], a[28:31], a[4:7], v[112:115]
  buffer_load_dwordx4 v5, s[16:19], s54 offen offset:2048 lds
  v_mfma_f32_16x16x32_bf16 v[132:135], a[28:31], a[8:11], v[132:135]
  v_mfma_f32_16x16x32_bf16 v[152:155], a[28:31], a[12:15], v[152:155]
  s_waitcnt vmcnt(54)
  v_mfma_f32_16x16x32_bf16 v[96:99], a[32:35], a[0:3], v[96:99]
  v_mfma_f32_16x16x32_bf16 v[116:119], a[32:35], a[4:7], v[116:119]
  s_add_u32 s54, s52, 57344
  s_add_u32 m0, s53, 57344
  s_nop 0
  buffer_load_dwordx4 v5, s[16:19], s54 offen offset:0 lds
  v_mfma_f32_16x16x32_bf16 v[136:139], a[32:35], a[8:11], v[136:139]
  v_mfma_f32_16x16x32_bf16 v[156:159], a[32:35], a[12:15], v[156:159]
  s_waitcnt vmcnt(53)
  v_mfma_f32_16x16x32_bf16 v[80:83], a[52:55], a[36:39], v[80:83]
  s_waitcnt vmcnt(51)
  v_mfma_f32_16x16x32_bf16 v[100:103], a[52:55], a[40:43], v[100:103]
  buffer_load_dwordx4 v5, s[16:19], s54 offen offset:1024 lds
  s_waitcnt vmcnt(50)
  v_mfma_f32_16x16x32_bf16 v[120:123], a[52:55], a[44:47], v[120:123]
  s_waitcnt vmcnt(48)
  v_mfma_f32_16x16x32_bf16 v[140:143], a[52:55], a[48:51], v[140:143]
  v_mfma_f32_16x16x32_bf16 v[84:87], a[56:59], a[36:39], v[84:87]
  v_mfma_f32_16x16x32_bf16 v[104:107], a[56:59], a[40:43], v[104:107]
  buffer_load_dwordx4 v5, s[16:19], s54 offen offset:2048 lds
  v_mfma_f32_16x16x32_bf16 v[124:127], a[56:59], a[44:47], v[124:127]
  v_mfma_f32_16x16x32_bf16 v[144:147], a[56:59], a[48:51], v[144:147]
  v_mfma_f32_16x16x32_bf16 v[88:91], a[60:63], a[36:39], v[88:91]
  v_mfma_f32_16x16x32_bf16 v[108:111], a[60:63], a[40:43], v[108:111]
  buffer_load_dwordx4 v5, s[16:19], s54 offen offset:3072 lds
  v_mfma_f32_16x16x32_bf16 v[128:131], a[60:63], a[44:47], v[128:131]
  v_mfma_f32_16x16x32_bf16 v[148:151], a[60:63], a[48:51], v[148:151]
  v_mfma_f32_16x16x32_bf16 v[92:95], a[64:67], a[36:39], v[92:95]
  v_mfma_f32_16x16x32_bf16 v[112:115], a[64:67], a[40:43], v[112:115]
  s_add_u32 s54, s52, 61440
  s_add_u32 m0, s53, 61440
  s_nop 0
  buffer_load_dwordx4 v5, s[16:19], s54 offen offset:0 lds
  v_mfma_f32_16x16x32_bf16 v[132:135], a[64:67], a[44:47], v[132:135]
  v_mfma_f32_16x16x32_bf16 v[152:155], a[64:67], a[48:51], v[152:155]
  s_waitcnt vmcnt(50)
  v_mfma_f32_16x16x32_bf16 v[96:99], a[68:71], a[36:39], v[96:99]
  v_mfma_f32_16x16x32_bf16 v[116:119], a[68:71], a[40:43], v[116:119]
  buffer_load_dwordx4 v5, s[16:19], s54 offen offset:1024 lds
  v_mfma_f32_16x16x32_bf16 v[136:139], a[68:71], a[44:47], v[136:139]
  v_mfma_f32_16x16x32_bf16 v[156:159], a[68:71], a[48:51], v[156:159]
  s_waitcnt vmcnt(49)
  v_mfma_f32_16x16x32_bf16 v[80:83], a[88:91], a[72:75], v[80:83]
  s_waitcnt vmcnt(47)
  v_mfma_f32_16x16x32_bf16 v[100:103], a[88:91], a[76:79], v[100:103]
  buffer_load_dwordx4 v5, s[16:19], s54 offen offset:2048 lds
  s_waitcnt vmcnt(46)
  v_mfma_f32_16x16x32_bf16 v[120:123], a[88:91], a[80:83], v[120:123]
  s_waitcnt vmcnt(44)
  v_mfma_f32_16x16x32_bf16 v[140:143], a[88:91], a[84:87], v[140:143]
  v_mfma_f32_16x16x32_bf16 v[84:87], a[92:95], a[72:75], v[84:87]
  v_mfma_f32_16x16x32_bf16 v[104:107], a[92:95], a[76:79], v[104:107]
  v_mfma_f32_16x16x32_bf16 v[124:127], a[92:95], a[80:83], v[124:127]
  v_mfma_f32_16x16x32_bf16 v[144:147], a[92:95], a[84:87], v[144:147]
  v_mfma_f32_16x16x32_bf16 v[88:91], a[96:99], a[72:75], v[88:91]
  v_mfma_f32_16x16x32_bf16 v[108:111], a[96:99], a[76:79], v[108:111]
  v_mfma_f32_16x16x32_bf16 v[128:131], a[96:99], a[80:83], v[128:131]
  v_mfma_f32_16x16x32_bf16 v[148:151], a[96:99], a[84:87], v[148:151]
  v_mfma_f32_16x16x32_bf16 v[92:95], a[100:103], a[72:75], v[92:95]
  v_mfma_f32_16x16x32_bf16 v[112:115], a[100:103], a[76:79], v[112:115]
  v_mfma_f32_16x16x32_bf16 v[132:135], a[100:103], a[80:83], v[132:135]
  v_mfma_f32_16x16x32_bf16 v[152:155], a[100:103], a[84:87], v[152:155]
  s_waitcnt vmcnt(43)
  v_mfma_f32_16x16x32_bf16 v[96:99], a[104:107], a[72:75], v[96:99]
  v_mfma_f32_16x16x32_bf16 v[116:119], a[104:107], a[76:79], v[116:119]
  v_mfma_f32_16x16x32_bf16 v[136:139], a[104:107], a[80:83], v[136:139]
  v_mfma_f32_16x16x32_bf16 v[156:159], a[104:107], a[84:87], v[156:159]
  s_waitcnt vmcnt(39)
  v_mfma_f32_16x16x32_bf16 v[100:103], a[124:127], a[112:115], v[100:103]
  v_mfma_f32_16x16x32_bf16 v[104:107], a[128:131], a[112:115], v[104:107]
  s_waitcnt vmcnt(38)
  v_mfma_f32_16x16x32_bf16 v[108:111], a[132:135], a[112:115], v[108:111]
  s_waitcnt vmcnt(36)
  v_mfma_f32_16x16x32_bf16 v[112:115], a[136:139], a[112:115], v[112:115]
  s_waitcnt vmcnt(34)
  v_mfma_f32_16x16x32_bf16 v[116:119], a[140:143], a[112:115], v[116:119]
  v_mfma_f32_16x16x32_bf16 v[120:123], a[124:127], a[116:119], v[120:123]
  v_mfma_f32_16x16x32_bf16 v[124:127], a[128:131], a[116:119], v[124:127]
  v_mfma_f32_16x16x32_bf16 v[128:131], a[132:135], a[116:119], v[128:131]
  ds_write_b128 v7, v[100:103] offset:0
  v_mfma_f32_16x16x32_bf16 v[132:135], a[136:139], a[116:119], v[132:135]
  ds_write_b128 v7, v[104:107] offset:1024
  v_mfma_f32_16x16x32_bf16 v[136:139], a[140:143], a[116:119], v[136:139]
  ds_write_b128 v7, v[108:111] offset:2048
  v_mfma_f32_16x16x32_bf16 v[140:143], a[124:127], a[120:123], v[140:143]
  ds_write_b128 v7, v[112:115] offset:3072
  v_mfma_f32_16x16x32_bf16 v[144:147], a[128:131], a[120:123], v[144:147]
  ds_write_b128 v7, v[116:119] offset:4096
  v_mfma_f32_16x16x32_bf16 v[148:151], a[132:135], a[120:123], v[148:151]
  ds_write_b128 v8, v[120:123] offset:0
  v_mfma_f32_16x16x32_bf16 v[152:155], a[136:139], a[120:123], v[152:155]
  ds_write_b128 v8, v[124:127] offset:1024
  v_mfma_f32_16x16x32_bf16 v[156:159], a[140:143], a[120:123], v[156:159]
  ds_write_b128 v8, v[128:131] offset:2048
  v_mfma_f32_16x16x32_bf16 v[80:83], a[124:127], a[108:111], v[80:83]
  ds_write_b128 v8, v[132:135] offset:3072
  v_mfma_f32_16x16x32_bf16 v[84:87], a[128:131], a[108:111], v[84:87]
  ds_write_b128 v8, v[136:139] offset:4096
  v_mfma_f32_16x16x32_bf16 v[88:91], a[132:135], a[108:111], v[88:91]
  ds_write_b128 v9, v[140:143] offset:0
  v_mfma_f32_16x16x32_bf16 v[92:95], a[136:139], a[108:111], v[92:95]
  ds_write_b128 v9, v[144:147] offset:1024
  v_mfma_f32_16x16x32_bf16 v[96:99], a[140:143], a[108:111], v[96:99]
  ds_write_b128 v9, v[148:151] offset:2048
  ds_write_b128 v9, v[152:155] offset:3072
  ds_write_b128 v9, v[156:159] offset:4096
  s_waitcnt lgkmcnt(0)
  s_barrier
  ds_read_b128 v[160:163], v10 offset:0
  ds_read_b128 v[164:167], v10 offset:1024
  ds_read_b128 v[168:171], v10 offset:2048
  ds_read_b128 v[172:175], v10 offset:3072
  ds_read_b128 v[176:179], v10 offset:4096
  ds_read_b128 v[180:183], v10 offset:5120
  ds_read_b128 v[184:187], v10 offset:6144
  ds_read_b128 v[188:191], v10 offset:7168
  ds_read_b128 v[192:195], v10 offset:8192
  ds_read_b128 v[196:199], v10 offset:9216
  ds_read_b128 v[200:203], v10 offset:10240
  ds_read_b128 v[204:207], v10 offset:11264
  ds_read_b128 v[208:211], v10 offset:12288
  ds_read_b128 v[212:215], v10 offset:13312
  ds_read_b128 v[216:219], v10 offset:14336
  s_waitcnt lgkmcnt(14)
  v_add_f32 v80, v80, v160
  v_add_f32 v81, v81, v161
  v_add_f32 v82, v82, v162
  v_add_f32 v83, v83, v163
  s_waitcnt lgkmcnt(13)
  v_add_f32 v84, v84, v164
  v_add_f32 v85, v85, v165
  v_add_f32 v86, v86, v166
  v_add_f32 v87, v87, v167
  s_waitcnt lgkmcnt(12)
  v_add_f32 v88, v88, v168
  v_add_f32 v89, v89, v169
  v_add_f32 v90, v90, v170
  v_add_f32 v91, v91, v171
  s_waitcnt lgkmcnt(11)
  v_add_f32 v92, v92, v172
  v_add_f32 v93, v93, v173
  v_add_f32 v94, v94, v174
  v_add_f32 v95, v95, v175
  s_waitcnt lgkmcnt(10)
  v_add_f32 v96, v96, v176
  v_add_f32 v97, v97, v177
  v_add_f32 v98, v98, v178
  v_add_f32 v99, v99, v179
  s_waitcnt lgkmcnt(9)
  v_add_f32 v80, v80, v180
  v_add_f32 v81, v81, v181
  v_add_f32 v82, v82, v182
  v_add_f32 v83, v83, v183
  s_waitcnt lgkmcnt(8)
  v_add_f32 v84, v84, v184
  v_add_f32 v85, v85, v185
  v_add_f32 v86, v86, v186
  v_add_f32 v87, v87, v187
  s_waitcnt lgkmcnt(7)
  v_add_f32 v88, v88, v188
  v_add_f32 v89, v89, v189
  v_add_f32 v90, v90, v190
  v_add_f32 v91, v91, v191
  s_waitcnt lgkmcnt(6)
  v_add_f32 v92, v92, v192
  v_add_f32 v93, v93, v193
  v_add_f32 v94, v94, v194
  v_add_f32 v95, v95, v195
  s_waitcnt lgkmcnt(5)
  v_add_f32 v96, v96, v196
  v_add_f32 v97, v97, v197
  v_add_f32 v98, v98, v198
  v_add_f32 v99, v99, v199
  s_waitcnt lgkmcnt(4)
  v_add_f32 v80, v80, v200
  v_add_f32 v81, v81, v201
  v_add_f32 v82, v82, v202
  v_add_f32 v83, v83, v203
  s_waitcnt lgkmcnt(3)
  v_add_f32 v84, v84, v204
  v_add_f32 v85, v85, v205
  v_add_f32 v86, v86, v206
  v_add_f32 v87, v87, v207
  s_waitcnt lgkmcnt(2)
  v_add_f32 v88, v88, v208
  v_add_f32 v89, v89, v209
  v_add_f32 v90, v90, v210
  v_add_f32 v91, v91, v211
  s_waitcnt lgkmcnt(1)
  v_add_f32 v92, v92, v212
  v_add_f32 v93, v93, v213
  v_add_f32 v94, v94, v214
  v_add_f32 v95, v95, v215
  s_waitcnt lgkmcnt(0)
  v_add_f32 v96, v96, v216
  v_add_f32 v97, v97, v217
  v_add_f32 v98, v98, v218
  v_add_f32 v99, v99, v219
  v_cvt_pk_bf16_f32 v100, v80, v81
  v_lshlrev_b32 v80, 16, v100
  v_and_b32 v81, s30, v100
  s_waitcnt vmcnt(30)
  v_mul_f32 v80, v80, v36
  v_mul_f32 v81, v81, v37
  v_cvt_pk_bf16_f32 v100, v80, v81
  v_lshlrev_b32 v80, 16, v100
  v_and_b32 v81, s30, v100
  v_lshlrev_b32 v120, 16, v24
  v_and_b32 v121, s30, v24
  v_add_f32 v80, v80, v120
  v_add_f32 v81, v81, v121
  v_cvt_pk_bf16_f32 v248, v80, v81
  v_lshlrev_b32 v80, 16, v248
  v_and_b32 v81, s30, v248
  v_add_f32 v150, v80, v81
  v_mul_f32 v151, v80, v80
  v_fmac_f32 v151, v81, v81
  s_waitcnt vmcnt(25)
  v_mul_f32 v80, v80, v56
  v_mul_f32 v81, v81, v57
  v_cvt_pk_bf16_f32 v140, v80, v81
  v_cvt_pk_bf16_f32 v100, v82, v83
  v_lshlrev_b32 v82, 16, v100
  v_and_b32 v83, s30, v100
  v_mul_f32 v82, v82, v38
  v_mul_f32 v83, v83, v39
  v_cvt_pk_bf16_f32 v100, v82, v83
  v_lshlrev_b32 v82, 16, v100
  v_and_b32 v83, s30, v100
  v_lshlrev_b32 v120, 16, v25
  v_and_b32 v121, s30, v25
  v_add_f32 v82, v82, v120
  v_add_f32 v83, v83, v121
  v_cvt_pk_bf16_f32 v249, v82, v83
  v_lshlrev_b32 v82, 16, v249
  v_and_b32 v83, s30, v249
  v_add_f32 v150, v150, v82
  v_fmac_f32 v151, v82, v82
  v_add_f32 v150, v150, v83
  v_fmac_f32 v151, v83, v83
  v_mul_f32 v82, v82, v58
  v_mul_f32 v83, v83, v59
  v_cvt_pk_bf16_f32 v141, v82, v83
  v_cvt_pk_bf16_f32 v100, v84, v85
  v_lshlrev_b32 v84, 16, v100
  v_and_b32 v85, s30, v100
  v_mul_f32 v84, v84, v40
  v_mul_f32 v85, v85, v41
  v_cvt_pk_bf16_f32 v100, v84, v85
  v_lshlrev_b32 v84, 16, v100
  v_and_b32 v85, s30, v100
  v_lshlrev_b32 v120, 16, v26
  v_and_b32 v121, s30, v26
  v_add_f32 v84, v84, v120
  v_add_f32 v85, v85, v121
  v_cvt_pk_bf16_f32 v250, v84, v85
  v_lshlrev_b32 v84, 16, v250
  v_and_b32 v85, s30, v250
  v_add_f32 v150, v150, v84
  v_fmac_f32 v151, v84, v84
  v_add_f32 v150, v150, v85
  v_fmac_f32 v151, v85, v85
  s_waitcnt vmcnt(24)
  v_mul_f32 v84, v84, v60
  v_mul_f32 v85, v85, v61
  v_cvt_pk_bf16_f32 v142, v84, v85
  v_cvt_pk_bf16_f32 v100, v86, v87
  v_lshlrev_b32 v86, 16, v100
  v_and_b32 v87, s30, v100
  v_mul_f32 v86, v86, v42
  v_mul_f32 v87, v87, v43
  v_cvt_pk_bf16_f32 v100, v86, v87
  v_lshlrev_b32 v86, 16, v100
  v_and_b32 v87, s30, v100
  v_lshlrev_b32 v120, 16, v27
  v_and_b32 v121, s30, v27
  v_add_f32 v86, v86, v120
  v_add_f32 v87, v87, v121
  v_cvt_pk_bf16_f32 v251, v86, v87
  v_lshlrev_b32 v86, 16, v251
  v_and_b32 v87, s30, v251
  v_add_f32 v150, v150, v86
  v_fmac_f32 v151, v86, v86
  v_add_f32 v150, v150, v87
  v_fmac_f32 v151, v87, v87
  v_mul_f32 v86, v86, v62
  v_mul_f32 v87, v87, v63
  v_cvt_pk_bf16_f32 v143, v86, v87
  v_cvt_pk_bf16_f32 v100, v88, v89
  v_lshlrev_b32 v88, 16, v100
  v_and_b32 v89, s30, v100
  v_mul_f32 v88, v88, v44
  v_mul_f32 v89, v89, v45
  v_cvt_pk_bf16_f32 v100, v88, v89
  v_lshlrev_b32 v88, 16, v100
  v_and_b32 v89, s30, v100
  v_lshlrev_b32 v120, 16, v28
  v_and_b32 v121, s30, v28
  v_add_f32 v88, v88, v120
  v_add_f32 v89, v89, v121
  v_cvt_pk_bf16_f32 v252, v88, v89
  v_lshlrev_b32 v88, 16, v252
  v_and_b32 v89, s30, v252
  v_add_f32 v150, v150, v88
  v_fmac_f32 v151, v88, v88
  v_add_f32 v150, v150, v89
  v_fmac_f32 v151, v89, v89
  s_waitcnt vmcnt(23)
  v_mul_f32 v88, v88, v64
  v_mul_f32 v89, v89, v65
  v_cvt_pk_bf16_f32 v144, v88, v89
  v_cvt_pk_bf16_f32 v100, v90, v91
  v_lshlrev_b32 v90, 16, v100
  v_and_b32 v91, s30, v100
  v_mul_f32 v90, v90, v46
  v_mul_f32 v91, v91, v47
  v_cvt_pk_bf16_f32 v100, v90, v91
  v_lshlrev_b32 v90, 16, v100
  v_and_b32 v91, s30, v100
  v_lshlrev_b32 v120, 16, v29
  v_and_b32 v121, s30, v29
  v_add_f32 v90, v90, v120
  v_add_f32 v91, v91, v121
  v_cvt_pk_bf16_f32 v253, v90, v91
  v_lshlrev_b32 v90, 16, v253
  v_and_b32 v91, s30, v253
  v_add_f32 v150, v150, v90
  v_fmac_f32 v151, v90, v90
  v_add_f32 v150, v150, v91
  v_fmac_f32 v151, v91, v91
  v_mul_f32 v90, v90, v66
  v_mul_f32 v91, v91, v67
  v_cvt_pk_bf16_f32 v145, v90, v91
  v_cvt_pk_bf16_f32 v100, v92, v93
  v_lshlrev_b32 v92, 16, v100
  v_and_b32 v93, s30, v100
  v_mul_f32 v92, v92, v48
  v_mul_f32 v93, v93, v49
  v_cvt_pk_bf16_f32 v100, v92, v93
  v_lshlrev_b32 v92, 16, v100
  v_and_b32 v93, s30, v100
  v_lshlrev_b32 v120, 16, v30
  v_and_b32 v121, s30, v30
  v_add_f32 v92, v92, v120
  v_add_f32 v93, v93, v121
  v_cvt_pk_bf16_f32 v254, v92, v93
  v_lshlrev_b32 v92, 16, v254
  v_and_b32 v93, s30, v254
  v_add_f32 v150, v150, v92
  v_fmac_f32 v151, v92, v92
  v_add_f32 v150, v150, v93
  v_fmac_f32 v151, v93, v93
  s_waitcnt vmcnt(22)
  v_mul_f32 v92, v92, v68
  v_mul_f32 v93, v93, v69
  v_cvt_pk_bf16_f32 v146, v92, v93
  v_cvt_pk_bf16_f32 v100, v94, v95
  v_lshlrev_b32 v94, 16, v100
  v_and_b32 v95, s30, v100
  v_mul_f32 v94, v94, v50
  v_mul_f32 v95, v95, v51
  v_cvt_pk_bf16_f32 v100, v94, v95
  v_lshlrev_b32 v94, 16, v100
  v_and_b32 v95, s30, v100
  v_lshlrev_b32 v120, 16, v31
  v_and_b32 v121, s30, v31
  v_add_f32 v94, v94, v120
  v_add_f32 v95, v95, v121
  v_cvt_pk_bf16_f32 v255, v94, v95
  v_lshlrev_b32 v94, 16, v255
  v_and_b32 v95, s30, v255
  v_add_f32 v150, v150, v94
  v_fmac_f32 v151, v94, v94
  v_add_f32 v150, v150, v95
  v_fmac_f32 v151, v95, v95
  v_mul_f32 v94, v94, v70
  v_mul_f32 v95, v95, v71
  v_cvt_pk_bf16_f32 v147, v94, v95
  v_cvt_pk_bf16_f32 v100, v96, v97
  v_lshlrev_b32 v96, 16, v100
  v_and_b32 v97, s30, v100
  v_mul_f32 v96, v96, v52
  v_mul_f32 v97, v97, v53
  v_cvt_pk_bf16_f32 v100, v96, v97
  v_lshlrev_b32 v96, 16, v100
  v_and_b32 v97, s30, v100
  v_lshlrev_b32 v120, 16, v32
  v_and_b32 v121, s30, v32
  v_add_f32 v96, v96, v120
  v_add_f32 v97, v97, v121
  v_cvt_pk_bf16_f32 v29, v96, v97
  v_lshlrev_b32 v96, 16, v29
  v_and_b32 v97, s30, v29
  v_add_f32 v150, v150, v96
  v_fmac_f32 v151, v96, v96
  v_add_f32 v150, v150, v97
  v_fmac_f32 v151, v97, v97
  s_waitcnt vmcnt(21)
  v_mul_f32 v96, v96, v72
  v_mul_f32 v97, v97, v73
  v_cvt_pk_bf16_f32 v148, v96, v97
  v_cvt_pk_bf16_f32 v100, v98, v99
  v_lshlrev_b32 v98, 16, v100
  v_and_b32 v99, s30, v100
  v_mul_f32 v98, v98, v54
  v_mul_f32 v99, v99, v55
  v_cvt_pk_bf16_f32 v100, v98, v99
  v_lshlrev_b32 v98, 16, v100
  v_and_b32 v99, s30, v100
  v_lshlrev_b32 v120, 16, v33
  v_and_b32 v121, s30, v33
  v_add_f32 v98, v98, v120
  v_add_f32 v99, v99, v121
  v_cvt_pk_bf16_f32 v31, v98, v99
  v_lshlrev_b32 v98, 16, v31
  v_and_b32 v99, s30, v31
  v_add_f32 v150, v150, v98
  v_fmac_f32 v151, v98, v98
  v_add_f32 v150, v150, v99
  v_fmac_f32 v151, v99, v99
  v_mul_f32 v98, v98, v74
  v_mul_f32 v99, v99, v75
  v_cvt_pk_bf16_f32 v149, v98, v99
  buffer_store_dwordx4 v[140:143], v19, s[16:19], s38 offen sc1
  buffer_store_dwordx4 v[144:147], v19, s[16:19], s38 offen offset:2048 sc1
  buffer_store_dwordx2 v[148:149], v20, s[16:19], s38 offen sc1
  v_mov_b32 v120, v150
  s_nop 1
  v_permlane16_swap_b32 v150, v120
  v_add_f32 v150, v150, v120
  v_mov_b32 v121, v151
  s_nop 1
  v_permlane16_swap_b32 v151, v121
  v_add_f32 v151, v151, v121
  v_mov_b32 v120, v150
  s_nop 1
  v_permlane32_swap_b32 v150, v120
  v_add_f32 v150, v150, v120
  v_mov_b32 v121, v151
  s_nop 1
  v_permlane32_swap_b32 v151, v121
  v_add_f32 v151, v151, v121
  v_lshlrev_b32 v120, 3, v16
  s_lshl_b32 s26, s22, 9
  s_lshl_b32 s27, s20, 7
  s_add_u32 s26, s26, s27
  s_lshl_b32 s27, s21, 14
  s_add_u32 s26, s26, s27
  s_add_u32 s26, s26, 393216
  buffer_store_dwordx2 v[150:151], v120, s[16:19], s26 offen sc1
  s_waitcnt vmcnt(0)
  s_barrier
  v_mov_b32 v244, 1
  s_mov_b32 s59, 56623104
  buffer_store_dword v244, v240, s[16:19], s59 offen sc1
  s_mov_b32 s30, 0xffff0000
  v_readfirstlane_b32 s20, v0
  s_nop 0
  s_lshr_b32 s20, s20, 6
  s_and_b32 s22, s2, 7
  s_lshl_b32 s22, s22, 1
  s_bfe_u32 s26, s2, 0x10003
  s_add_u32 s22, s22, s26
  s_lshr_b32 s21, s2, 4
  s_mul_i32 s23, s21, 143360
  s_add_u32 s23, s23, 51380224
  s_mul_i32 s25, s20, 7168
  s_add_u32 s23, s23, s25
  s_lshl_b32 s26, s22, 2
  s_add_u32 s26, s26, s20
  s_mul_i32 s24, s26, 40960
  s_add_u32 s24, s24, 10485760
  v_and_b32 v4, 63, v0
  v_lshrrev_b32 v5, 4, v4
  v_and_b32 v6, 15, v0
  v_lshlrev_b32 v1, 4, v4
  v_lshlrev_b32 v2, 9, v5
  v_lshl_add_u32 v2, v6, 4, v2
  v_lshlrev_b32 v10, 4, v5
  v_lshlrev_b32 v11, 3, v5
  s_mul_i32 s29, s21, 224
  v_add_u32 v10, s29, v10
  v_add_u32 v11, s29, v11
  buffer_load_dwordx4 v[148:151], v10, s[8:11], 0 offen offset:0
  buffer_load_dwordx4 v[152:155], v10, s[8:11], 0 offen offset:64
  buffer_load_dwordx4 v[156:159], v10, s[8:11], 0 offen offset:128
  buffer_load_dwordx2 v[160:161], v11, s[8:11], 0 offen offset:192
  s_mul_i32 s53, s20, 13
  s_cmp_ge_u32 s20, 1
  s_addc_u32 s53, s53, 0
  s_lshr_b32 s52, s2, 5
  s_mul_i32 s52, s52, 54
  s_add_u32 s52, s52, s53
  s_mul_i32 s52, s52, 5120
  s_add_u32 s52, s52, 48234496
  s_cmp_ge_u32 s20, 2
  s_cselect_b32 s53, 0x40000000, 0
  v_add_u32 v30, s53, v1
  s_lshl_b32 s35, s22, 12
  s_lshl_b32 s36, s21, 2
  s_add_u32 s35, s35, s36
  s_add_u32 s35, s35, 128
  v_lshlrev_b32 v3, 8, v6
  v_add_u32 v3, s35, v3
  v_cmp_lt_u32 vcc, 15, v0
  v_bfrev_b32 v7, 2
  s_nop 0
  v_cndmask_b32 v3, v3, v7, vcc
  v_add_u32 v12, 0x10000, v1
  v_add_u32 v13, 0x20000, v1
  v_lshlrev_b32 v26, 5, v5
  v_add_u32 v26, 143360, v26
  v_lshlrev_b32 v27, 4, v5
  v_add_u32 v27, 143360, v27
  v_lshrrev_b32 v28, 1, v5
  v_lshlrev_b32 v28, 9, v28
  v_lshl_add_u32 v28, v6, 4, v28
  v_and_b32 v19, 1, v5
  v_lshl_add_u32 v28, v19, 3, v28
  s_mul_i32 s32, s26, 114688
  s_mul_i32 s33, s21, 7168
  s_add_u32 s32, s32, s33
  s_add_u32 s32, s32, 33554432
  s_add_u32 s33, s32, 4096
  s_add_u32 s34, s32, 6144
  s_cmp_ge_u32 s20, 2
  s_cselect_b32 s57, 8, 0
  s_lshl_b32 s57, 0xff, s57
  s_lshl_b32 s58, s22, 4
  s_add_u32 s58, s58, s21
  s_lshl_b32 s58, s58, 8
  s_add_u32 s58, s58, 56623104
  v_and_b32 v242, 31, v0
  v_lshlrev_b32 v242, 2, v242
  s_mov_b32 s60, 200000
  s_add_u32 s27, s23, 86016
  s_add_u32 m0, s25, 86016
  s_nop 0
  buffer_load_dwordx4 v1, s[16:19], s27 offen offset:0 lds
  buffer_load_dwordx4 v1, s[16:19], s27 offen offset:1024 lds
  buffer_load_dwordx4 v1, s[16:19], s27 offen offset:2048 lds
  buffer_load_dwordx4 v1, s[16:19], s27 offen offset:3072 lds
  s_add_u32 s27, s23, 90112
  s_add_u32 m0, s25, 90112
  s_nop 0
  buffer_load_dwordx4 v1, s[16:19], s27 offen offset:0 lds
  buffer_load_dwordx4 v1, s[16:19], s27 offen offset:1024 lds
  buffer_load_dwordx4 v1, s[16:19], s27 offen offset:2048 lds
  s_add_u32 s27, s23, 114688
  s_add_u32 m0, s25, 114688
  s_nop 0
  buffer_load_dwordx4 v1, s[16:19], s27 offen offset:0 lds
  buffer_load_dwordx4 v1, s[16:19], s27 offen offset:1024 lds
  buffer_load_dwordx4 v1, s[16:19], s27 offen offset:2048 lds
  buffer_load_dwordx4 v1, s[16:19], s27 offen offset:3072 lds
  s_add_u32 s27, s23, 118784
  s_add_u32 m0, s25, 118784
  s_nop 0
  buffer_load_dwordx4 v1, s[16:19], s27 offen offset:0 lds
  buffer_load_dwordx4 v1, s[16:19], s27 offen offset:1024 lds
  buffer_load_dwordx4 v1, s[16:19], s27 offen offset:2048 lds
KF_PA_L:
  buffer_load_dword v243, v242, s[16:19], s58 offen sc1
  s_waitcnt vmcnt(0)
  v_cmp_ne_u32 vcc, 0, v243
  s_nop 0
  s_mov_b32 s61, vcc_lo
  s_and_b32 s59, s61, s57
  s_cmp_eq_u32 s59, s57
  s_cbranch_scc1 KF_PA_A
  s_sub_u32 s60, s60, 1
  s_cbranch_scc1 KF_PA_A
  s_sleep 1
  s_branch KF_PA_L
KF_PA_A:
  s_add_u32 s28, s24, 0
  buffer_load_dwordx4 a[0:3], v2, s[16:19], s28 offen offset:0
  buffer_load_dwordx4 a[4:7], v2, s[16:19], s28 offen offset:256
  buffer_load_dwordx4 a[8:11], v2, s[16:19], s28 offen offset:2048
  buffer_load_dwordx4 a[12:15], v2, s[16:19], s28 offen offset:2304
  s_add_u32 s28, s24, 4096
  buffer_load_dwordx4 a[16:19], v2, s[16:19], s28 offen offset:0
  buffer_load_dwordx4 a[20:23], v2, s[16:19], s28 offen offset:256
  buffer_load_dwordx4 a[24:27], v2, s[16:19], s28 offen offset:2048
  buffer_load_dwordx4 a[28:31], v2, s[16:19], s28 offen offset:2304
  s_add_u32 s28, s24, 8192
  buffer_load_dwordx4 a[32:35], v2, s[16:19], s28 offen offset:0
  buffer_load_dwordx4 a[36:39], v2, s[16:19], s28 offen offset:256
  buffer_load_dwordx4 a[40:43], v2, s[16:19], s28 offen offset:2048
  buffer_load_dwordx4 a[44:47], v2, s[16:19], s28 offen offset:2304
  s_add_u32 s28, s24, 12288
  buffer_load_dwordx4 a[48:51], v2, s[16:19], s28 offen offset:0
  buffer_load_dwordx4 a[52:55], v2, s[16:19], s28 offen offset:256
  buffer_load_dwordx4 a[56:59], v2, s[16:19], s28 offen offset:2048
  buffer_load_dwordx4 a[60:63], v2, s[16:19], s28 offen offset:2304
  ds_read_b128 v[88:91], v1 offset:0
  ds_read_b128 v[92:95], v1 offset:1024
  ds_read_b128 v[96:99], v1 offset:2048
  ds_read_b128 v[100:103], v1 offset:3072
  s_waitcnt vmcnt(15) lgkmcnt(3)
  v_mfma_f32_16x16x32_bf16 v[32:35], v[88:91], a[0:3], 0
  ds_read_b128 v[104:107], v1 offset:4096
  s_waitcnt vmcnt(14)
  v_mfma_f32_16x16x32_bf16 v[60:63], v[88:91], a[4:7], 0
  s_waitcnt lgkmcnt(3)
  v_mfma_f32_16x16x32_bf16 v[36:39], v[92:95], a[0:3], 0
  ds_read_b128 v[108:111], v1 offset:5120
  s_add_u32 s28, s24, 16384
  buffer_load_dwordx4 a[64:67], v2, s[16:19], s28 offen offset:0
  v_mfma_f32_16x16x32_bf16 v[64:67], v[92:95], a[4:7], 0
  s_waitcnt lgkmcnt(3)
  v_mfma_f32_16x16x32_bf16 v[40:43], v[96:99], a[0:3], 0
  ds_read_b128 v[112:115], v1 offset:6144
  v_mfma_f32_16x16x32_bf16 v[68:71], v[96:99], a[4:7], 0
  buffer_load_dwordx4 a[68:71], v2, s[16:19], s28 offen offset:256
  s_waitcnt lgkmcnt(3)
  v_mfma_f32_16x16x32_bf16 v[44:47], v[100:103], a[0:3], 0
  ds_read_b128 v[116:119], v1 offset:7168
  v_mfma_f32_16x16x32_bf16 v[72:75], v[100:103], a[4:7], 0
  s_waitcnt lgkmcnt(3)
  v_mfma_f32_16x16x32_bf16 v[48:51], v[104:107], a[0:3], 0
  ds_read_b128 v[88:91], v1 offset:8192
  buffer_load_dwordx4 a[72:75], v2, s[16:19], s28 offen offset:2048
  v_mfma_f32_16x16x32_bf16 v[76:79], v[104:107], a[4:7], 0
  s_waitcnt lgkmcnt(3)
  v_mfma_f32_16x16x32_bf16 v[52:55], v[108:111], a[0:3], 0
  ds_read_b128 v[92:95], v1 offset:9216
  v_mfma_f32_16x16x32_bf16 v[80:83], v[108:111], a[4:7], 0
  buffer_load_dwordx4 a[76:79], v2, s[16:19], s28 offen offset:2304
  s_waitcnt lgkmcnt(3)
  v_mfma_f32_16x16x32_bf16 v[56:59], v[112:115], a[0:3], 0
  ds_read_b128 v[96:99], v1 offset:10240
  v_mfma_f32_16x16x32_bf16 v[84:87], v[112:115], a[4:7], 0
  s_waitcnt vmcnt(17) lgkmcnt(3)
  v_mfma_f32_16x16x32_bf16 v[32:35], v[116:119], a[8:11], v[32:35]
  ds_read_b128 v[100:103], v1 offset:11264
  s_add_u32 s28, s24, 20480
  buffer_load_dwordx4 a[80:83], v2, s[16:19], s28 offen offset:0
  s_waitcnt vmcnt(17)
  v_mfma_f32_16x16x32_bf16 v[60:63], v[116:119], a[12:15], v[60:63]
  s_waitcnt lgkmcnt(3)
  v_mfma_f32_16x16x32_bf16 v[36:39], v[88:91], a[8:11], v[36:39]
  ds_read_b128 v[104:107], v1 offset:12288
  v_mfma_f32_16x16x32_bf16 v[64:67], v[88:91], a[12:15], v[64:67]
  buffer_load_dwordx4 a[84:87], v2, s[16:19], s28 offen offset:256
  s_waitcnt lgkmcnt(3)
  v_mfma_f32_16x16x32_bf16 v[40:43], v[92:95], a[8:11], v[40:43]
  ds_read_b128 v[108:111], v1 offset:13312
  v_mfma_f32_16x16x32_bf16 v[68:71], v[92:95], a[12:15], v[68:71]
  s_waitcnt lgkmcnt(3)
  v_mfma_f32_16x16x32_bf16 v[44:47], v[96:99], a[8:11], v[44:47]
  ds_read_b128 v[112:115], v1 offset:14336
  buffer_load_dwordx4 a[88:91], v2, s[16:19], s28 offen offset:2048
  v_mfma_f32_16x16x32_bf16 v[72:75], v[96:99], a[12:15], v[72:75]
  s_waitcnt lgkmcnt(3)
  v_mfma_f32_16x16x32_bf16 v[48:51], v[100:103], a[8:11], v[48:51]
  ds_read_b128 v[116:119], v1 offset:15360
  v_mfma_f32_16x16x32_bf16 v[76:79], v[100:103], a[12:15], v[76:79]
  buffer_load_dwordx4 a[92:95], v2, s[16:19], s28 offen offset:2304
  s_waitcnt lgkmcnt(3)
  v_mfma_f32_16x16x32_bf16 v[52:55], v[104:107], a[8:11], v[52:55]
  ds_read_b128 v[88:91], v1 offset:16384
  v_mfma_f32_16x16x32_bf16 v[80:83], v[104:107], a[12:15], v[80:83]
  s_waitcnt lgkmcnt(3)
  v_mfma_f32_16x16x32_bf16 v[56:59], v[108:111], a[8:11], v[56:59]
  ds_read_b128 v[92:95], v1 offset:17408
  s_add_u32 s28, s24, 24576
  buffer_load_dwordx4 a[96:99], v2, s[16:19], s28 offen offset:0
  v_mfma_f32_16x16x32_bf16 v[84:87], v[108:111], a[12:15], v[84:87]
  s_waitcnt vmcnt(20) lgkmcnt(3)
  v_mfma_f32_16x16x32_bf16 v[32:35], v[112:115], a[16:19], v[32:35]
  ds_read_b128 v[96:99], v1 offset:18432
  s_waitcnt vmcnt(19)
  v_mfma_f32_16x16x32_bf16 v[60:63], v[112:115], a[20:23], v[60:63]
  buffer_load_dwordx4 a[100:103], v2, s[16:19], s28 offen offset:256
  s_waitcnt lgkmcnt(3)
  v_mfma_f32_16x16x32_bf16 v[36:39], v[116:119], a[16:19], v[36:39]
  ds_read_b128 v[100:103], v1 offset:19456
  v_mfma_f32_16x16x32_bf16 v[64:67], v[116:119], a[20:23], v[64:67]
  s_waitcnt lgkmcnt(3)
  v_mfma_f32_16x16x32_bf16 v[40:43], v[88:91], a[16:19], v[40:43]
  ds_read_b128 v[104:107], v1 offset:20480
  buffer_load_dwordx4 a[104:107], v2, s[16:19], s28 offen offset:2048
  v_mfma_f32_16x16x32_bf16 v[68:71], v[88:91], a[20:23], v[68:71]
  s_waitcnt lgkmcnt(3)
  v_mfma_f32_16x16x32_bf16 v[44:47], v[92:95], a[16:19], v[44:47]
  ds_read_b128 v[108:111], v1 offset:21504
  v_mfma_f32_16x16x32_bf16 v[72:75], v[92:95], a[20:23], v[72:75]
  buffer_load_dwordx4 a[108:111], v2, s[16:19], s28 offen offset:2304
  s_waitcnt lgkmcnt(3)
  v_mfma_f32_16x16x32_bf16 v[48:51], v[96:99], a[16:19], v[48:51]
  ds_read_b128 v[112:115], v1 offset:22528
  v_mfma_f32_16x16x32_bf16 v[76:79], v[96:99], a[20:23], v[76:79]
  s_waitcnt lgkmcnt(3)
  v_mfma_f32_16x16x32_bf16 v[52:55], v[100:103], a[16:19], v[52:55]
  ds_read_b128 v[116:119], v1 offset:23552
  s_add_u32 s28, s24, 28672
  buffer_load_dwordx4 a[112:115], v2, s[16:19], s28 offen offset:0
  v_mfma_f32_16x16x32_bf16 v[80:83], v[100:103], a[20:23], v[80:83]
  s_waitcnt lgkmcnt(3)
  v_mfma_f32_16x16x32_bf16 v[56:59], v[104:107], a[16:19], v[56:59]
  ds_read_b128 v[88:91], v1 offset:24576
  v_mfma_f32_16x16x32_bf16 v[84:87], v[104:107], a[20:23], v[84:87]
  buffer_load_dwordx4 a[116:119], v2, s[16:19], s28 offen offset:256
  s_waitcnt vmcnt(23) lgkmcnt(3)
  v_mfma_f32_16x16x32_bf16 v[32:35], v[108:111], a[24:27], v[32:35]
  ds_read_b128 v[92:95], v1 offset:25600
  s_waitcnt vmcnt(22)
  v_mfma_f32_16x16x32_bf16 v[60:63], v[108:111], a[28:31], v[60:63]
  s_waitcnt lgkmcnt(3)
  v_mfma_f32_16x16x32_bf16 v[36:39], v[112:115], a[24:27], v[36:39]
  ds_read_b128 v[96:99], v1 offset:26624
  buffer_load_dwordx4 a[120:123], v2, s[16:19], s28 offen offset:2048
  v_mfma_f32_16x16x32_bf16 v[64:67], v[112:115], a[28:31], v[64:67]
  s_waitcnt lgkmcnt(3)
  v_mfma_f32_16x16x32_bf16 v[40:43], v[116:119], a[24:27], v[40:43]
  ds_read_b128 v[100:103], v1 offset:27648
  v_mfma_f32_16x16x32_bf16 v[68:71], v[116:119], a[28:31], v[68:71]
  buffer_load_dwordx4 a[124:127], v2, s[16:19], s28 offen offset:2304
  s_waitcnt lgkmcnt(3)
  v_mfma_f32_16x16x32_bf16 v[44:47], v[88:91], a[24:27], v[44:47]
  ds_read_b128 v[104:107], v1 offset:28672
  v_mfma_f32_16x16x32_bf16 v[72:75], v[88:91], a[28:31], v[72:75]
  s_waitcnt lgkmcnt(3)
  v_mfma_f32_16x16x32_bf16 v[48:51], v[92:95], a[24:27], v[48:51]
  ds_read_b128 v[108:111], v1 offset:29696
  v_cmp_lt_u32 vcc, 111, v0
  v_mov_b32 v8, 6720
  s_nop 0
  v_cndmask_b32 v7, 0, v8, vcc
  v_lshl_add_u32 v7, v0, 2, v7
  v_cmp_lt_u32 vcc, 223, v0
  v_mov_b32 v8, 0x40000000
  s_nop 0
  v_cndmask_b32 v7, v7, v8, vcc
  s_mul_i32 s29, s21, 448
  s_add_u32 s29, s29, 32768
  s_and_b32 s59, s61, 0x7f0000
  s_cmp_eq_u32 s59, 0x7f0000
  s_cbranch_scc1 KF_PT_A
  s_mov_b32 s60, 200000
KF_PT_L:
  buffer_load_dword v243, v242, s[16:19], s58 offen sc1
  s_waitcnt vmcnt(0)
  v_cmp_ne_u32 vcc, 0, v243
  s_nop 0
  s_mov_b32 s61, vcc_lo
  s_and_b32 s59, s61, 8323072
  s_cmp_eq_u32 s59, 8323072
  s_cbranch_scc1 KF_PT_A
  s_sub_u32 s60, s60, 1
  s_cbranch_scc1 KF_PT_A
  s_sleep 1
  s_branch KF_PT_L
KF_PT_A:
  buffer_load_dword v120, v7, s[16:19], s29 offen sc1
  v_mfma_f32_16x16x32_bf16 v[76:79], v[92:95], a[28:31], v[76:79]
  s_waitcnt lgkmcnt(3)
  v_mfma_f32_16x16x32_bf16 v[52:55], v[96:99], a[24:27], v[52:55]
  ds_read_b128 v[112:115], v1 offset:30720
  v_mfma_f32_16x16x32_bf16 v[80:83], v[96:99], a[28:31], v[80:83]
  s_add_u32 s29, s29, 14336
  buffer_load_dword v121, v7, s[16:19], s29 offen sc1
  s_waitcnt lgkmcnt(3)
  v_mfma_f32_16x16x32_bf16 v[56:59], v[100:103], a[24:27], v[56:59]
  ds_read_b128 v[116:119], v1 offset:31744
  v_mfma_f32_16x16x32_bf16 v[84:87], v[100:103], a[28:31], v[84:87]
  s_waitcnt vmcnt(25) lgkmcnt(3)
  v_mfma_f32_16x16x32_bf16 v[32:35], v[104:107], a[32:35], v[32:35]
  ds_read_b128 v[88:91], v1 offset:32768
  s_add_u32 s29, s29, 14336
  buffer_load_dword v122, v7, s[16:19], s29 offen sc1
  s_waitcnt vmcnt(25)
  v_mfma_f32_16x16x32_bf16 v[60:63], v[104:107], a[36:39], v[60:63]
  s_waitcnt lgkmcnt(3)
  v_mfma_f32_16x16x32_bf16 v[36:39], v[108:111], a[32:35], v[36:39]
  ds_read_b128 v[92:95], v1 offset:33792
  v_mfma_f32_16x16x32_bf16 v[64:67], v[108:111], a[36:39], v[64:67]
  s_add_u32 s29, s29, 14336
  buffer_load_dword v123, v7, s[16:19], s29 offen sc1
  s_waitcnt lgkmcnt(3)
  v_mfma_f32_16x16x32_bf16 v[40:43], v[112:115], a[32:35], v[40:43]
  ds_read_b128 v[96:99], v1 offset:34816
  v_mfma_f32_16x16x32_bf16 v[68:71], v[112:115], a[36:39], v[68:71]
  s_waitcnt lgkmcnt(3)
  v_mfma_f32_16x16x32_bf16 v[44:47], v[116:119], a[32:35], v[44:47]
  ds_read_b128 v[100:103], v1 offset:35840
  v_lshlrev_b32 v9, 15, v5
  v_lshl_add_u32 v9, v6, 3, v9
  s_lshl_b32 s29, s26, 8
  s_add_u32 s29, s29, 393216
  s_add_u32 s31, s29, 16384
  buffer_load_dwordx2 v[140:141], v9, s[16:19], s29 offen offset:0
  v_mfma_f32_16x16x32_bf16 v[72:75], v[116:119], a[36:39], v[72:75]
  s_waitcnt lgkmcnt(3)
  v_mfma_f32_16x16x32_bf16 v[48:51], v[88:91], a[32:35], v[48:51]
  ds_read_b128 v[104:107], v1 offset:36864
  v_mfma_f32_16x16x32_bf16 v[76:79], v[88:91], a[36:39], v[76:79]
  buffer_load_dwordx2 v[142:143], v9, s[16:19], s31 offen offset:0
  s_waitcnt lgkmcnt(3)
  v_mfma_f32_16x16x32_bf16 v[52:55], v[92:95], a[32:35], v[52:55]
  ds_read_b128 v[108:111], v1 offset:37888
  v_mfma_f32_16x16x32_bf16 v[80:83], v[92:95], a[36:39], v[80:83]
  s_waitcnt lgkmcnt(3)
  v_mfma_f32_16x16x32_bf16 v[56:59], v[96:99], a[32:35], v[56:59]
  ds_read_b128 v[112:115], v1 offset:38912
  buffer_load_dwordx2 v[144:145], v9, s[16:19], s29 offen offset:128
  v_mfma_f32_16x16x32_bf16 v[84:87], v[96:99], a[36:39], v[84:87]
  s_waitcnt vmcnt(28) lgkmcnt(3)
  v_mfma_f32_16x16x32_bf16 v[32:35], v[100:103], a[40:43], v[32:35]
  ds_read_b128 v[116:119], v1 offset:39936
  s_waitcnt vmcnt(27)
  v_mfma_f32_16x16x32_bf16 v[60:63], v[100:103], a[44:47], v[60:63]
  buffer_load_dwordx2 v[146:147], v9, s[16:19], s31 offen offset:128
  s_waitcnt lgkmcnt(3)
  v_mfma_f32_16x16x32_bf16 v[36:39], v[104:107], a[40:43], v[36:39]
  ds_read_b128 v[88:91], v1 offset:40960
  v_mfma_f32_16x16x32_bf16 v[64:67], v[104:107], a[44:47], v[64:67]
  s_waitcnt lgkmcnt(3)
  v_mfma_f32_16x16x32_bf16 v[40:43], v[108:111], a[40:43], v[40:43]
  ds_read_b128 v[92:95], v1 offset:41984
  s_add_u32 s28, s24, 32768
  buffer_load_dwordx4 a[220:223], v2, s[16:19], s28 offen offset:0
  v_mfma_f32_16x16x32_bf16 v[68:71], v[108:111], a[44:47], v[68:71]
  s_waitcnt lgkmcnt(3)
  v_mfma_f32_16x16x32_bf16 v[44:47], v[112:115], a[40:43], v[44:47]
  ds_read_b128 v[96:99], v1 offset:43008
  v_mfma_f32_16x16x32_bf16 v[72:75], v[112:115], a[44:47], v[72:75]
  buffer_load_dwordx4 a[224:227], v2, s[16:19], s28 offen offset:256
  s_waitcnt lgkmcnt(3)
  v_mfma_f32_16x16x32_bf16 v[48:51], v[116:119], a[40:43], v[48:51]
  ds_read_b128 v[100:103], v1 offset:44032
  v_mfma_f32_16x16x32_bf16 v[76:79], v[116:119], a[44:47], v[76:79]
  s_waitcnt lgkmcnt(3)
  v_mfma_f32_16x16x32_bf16 v[52:55], v[88:91], a[40:43], v[52:55]
  ds_read_b128 v[104:107], v1 offset:45056
  buffer_load_dwordx4 a[228:231], v2, s[16:19], s28 offen offset:2048
  v_mfma_f32_16x16x32_bf16 v[80:83], v[88:91], a[44:47], v[80:83]
  s_waitcnt lgkmcnt(3)
  v_mfma_f32_16x16x32_bf16 v[56:59], v[92:95], a[40:43], v[56:59]
  ds_read_b128 v[108:111], v1 offset:46080
  v_mfma_f32_16x16x32_bf16 v[84:87], v[92:95], a[44:47], v[84:87]
  buffer_load_dwordx4 a[232:235], v2, s[16:19], s28 offen offset:2304
  s_waitcnt vmcnt(31) lgkmcnt(3)
  v_mfma_f32_16x16x32_bf16 v[32:35], v[96:99], a[48:51], v[32:35]
  ds_read_b128 v[112:115], v1 offset:47104
  s_waitcnt vmcnt(30)
  v_mfma_f32_16x16x32_bf16 v[60:63], v[96:99], a[52:55], v[60:63]
  s_waitcnt lgkmcnt(3)
  v_mfma_f32_16x16x32_bf16 v[36:39], v[100:103], a[48:51], v[36:39]
  ds_read_b128 v[116:119], v1 offset:48128
  s_add_u32 s28, s24, 36864
  buffer_load_dwordx4 a[236:239], v2, s[16:19], s28 offen offset:0
  v_mfma_f32_16x16x32_bf16 v[64:67], v[100:103], a[52:55], v[64:67]
  s_waitcnt lgkmcnt(3)
  v_mfma_f32_16x16x32_bf16 v[40:43], v[104:107], a[48:51], v[40:43]
  ds_read_b128 v[88:91], v1 offset:49152
  v_mfma_f32_16x16x32_bf16 v[68:71], v[104:107], a[52:55], v[68:71]
  buffer_load_dwordx4 a[240:243], v2, s[16:19], s28 offen offset:256
  s_waitcnt lgkmcnt(3)
  v_mfma_f32_16x16x32_bf16 v[44:47], v[108:111], a[48:51], v[44:47]
  ds_read_b128 v[92:95], v1 offset:50176
  v_mfma_f32_16x16x32_bf16 v[72:75], v[108:111], a[52:55], v[72:75]
  s_waitcnt lgkmcnt(3)
  v_mfma_f32_16x16x32_bf16 v[48:51], v[112:115], a[48:51], v[48:51]
  ds_read_b128 v[96:99], v1 offset:51200
  buffer_load_dwordx4 a[244:247], v2, s[16:19], s28 offen offset:2048
  v_mfma_f32_16x16x32_bf16 v[76:79], v[112:115], a[52:55], v[76:79]
  s_waitcnt lgkmcnt(3)
  v_mfma_f32_16x16x32_bf16 v[52:55], v[116:119], a[48:51], v[52:55]
  ds_read_b128 v[100:103], v1 offset:52224
  v_mfma_f32_16x16x32_bf16 v[80:83], v[116:119], a[52:55], v[80:83]
  buffer_load_dwordx4 a[248:251], v2, s[16:19], s28 offen offset:2304
  s_waitcnt lgkmcnt(3)
  v_mfma_f32_16x16x32_bf16 v[56:59], v[88:91], a[48:51], v[56:59]
  ds_read_b128 v[104:107], v1 offset:53248
  v_mfma_f32_16x16x32_bf16 v[84:87], v[88:91], a[52:55], v[84:87]
  s_waitcnt vmcnt(33) lgkmcnt(3)
  v_mfma_f32_16x16x32_bf16 v[32:35], v[92:95], a[56:59], v[32:35]
  ds_read_b128 v[108:111], v1 offset:54272
  s_waitcnt vmcnt(32)
  v_mfma_f32_16x16x32_bf16 v[60:63], v[92:95], a[60:63], v[60:63]
  s_waitcnt lgkmcnt(3)
  v_mfma_f32_16x16x32_bf16 v[36:39], v[96:99], a[56:59], v[36:39]
  ds_read_b128 v[112:115], v1 offset:55296
  v_mfma_f32_16x16x32_bf16 v[64:67], v[96:99], a[60:63], v[64:67]
  s_waitcnt lgkmcnt(3)
  v_mfma_f32_16x16x32_bf16 v[40:43], v[100:103], a[56:59], v[40:43]
  ds_read_b128 v[116:119], v1 offset:56320
  v_mfma_f32_16x16x32_bf16 v[68:71], v[100:103], a[60:63], v[68:71]
  s_waitcnt lgkmcnt(3)
  v_mfma_f32_16x16x32_bf16 v[44:47], v[104:107], a[56:59], v[44:47]
  ds_read_b128 v[88:91], v1 offset:57344
  s_waitcnt vmcnt(14)
  v_add_f32 v120, v120, v121
  s_waitcnt vmcnt(13)
  v_add_f32 v120, v120, v122
  s_waitcnt vmcnt(12)
  v_add_f32 v120, v120, v123
  v_mfma_f32_16x16x32_bf16 v[72:75], v[104:107], a[60:63], v[72:75]
  v_lshlrev_b32 v8, 2, v0
  v_add_u32 v8, 143360, v8
  ds_write_b32 v8, v120
  s_waitcnt lgkmcnt(4)
  v_mfma_f32_16x16x32_bf16 v[48:51], v[108:111], a[56:59], v[48:51]
  ds_read_b128 v[92:95], v1 offset:58368
  v_mfma_f32_16x16x32_bf16 v[76:79], v[108:111], a[60:63], v[76:79]
  s_waitcnt lgkmcnt(4)
  v_mfma_f32_16x16x32_bf16 v[52:55], v[112:115], a[56:59], v[52:55]
  ds_read_b128 v[96:99], v1 offset:59392
  v_mfma_f32_16x16x32_bf16 v[80:83], v[112:115], a[60:63], v[80:83]
  s_waitcnt lgkmcnt(4)
  v_mfma_f32_16x16x32_bf16 v[56:59], v[116:119], a[56:59], v[56:59]
  ds_read_b128 v[100:103], v1 offset:60416
  v_mfma_f32_16x16x32_bf16 v[84:87], v[116:119], a[60:63], v[84:87]
  s_waitcnt lgkmcnt(4)
  v_mfma_f32_16x16x32_bf16 v[32:35], v[88:91], a[64:67], v[32:35]
  ds_read_b128 v[104:107], v1 offset:61440
  v_mfma_f32_16x16x32_bf16 v[60:63], v[88:91], a[68:71], v[60:63]
  s_waitcnt lgkmcnt(3)
  v_mfma_f32_16x16x32_bf16 v[36:39], v[92:95], a[64:67], v[36:39]
  ds_read_b128 v[108:111], v1 offset:62464
  v_mfma_f32_16x16x32_bf16 v[64:67], v[92:95], a[68:71], v[64:67]
  s_waitcnt lgkmcnt(3)
  v_mfma_f32_16x16x32_bf16 v[40:43], v[96:99], a[64:67], v[40:43]
  ds_read_b128 v[112:115], v1 offset:63488
  v_mfma_f32_16x16x32_bf16 v[68:71], v[96:99], a[68:71], v[68:71]
  s_waitcnt lgkmcnt(3)
  v_mfma_f32_16x16x32_bf16 v[44:47], v[100:103], a[64:67], v[44:47]
  ds_read_b128 v[116:119], v1 offset:64512
  v_mfma_f32_16x16x32_bf16 v[72:75], v[100:103], a[68:71], v[72:75]
  s_waitcnt lgkmcnt(3)
  v_mfma_f32_16x16x32_bf16 v[48:51], v[104:107], a[64:67], v[48:51]
  ds_read_b128 v[88:91], v12 offset:0
  v_mfma_f32_16x16x32_bf16 v[76:79], v[104:107], a[68:71], v[76:79]
  s_waitcnt lgkmcnt(3)
  v_mfma_f32_16x16x32_bf16 v[52:55], v[108:111], a[64:67], v[52:55]
  ds_read_b128 v[92:95], v12 offset:1024
  v_mfma_f32_16x16x32_bf16 v[80:83], v[108:111], a[68:71], v[80:83]
  s_waitcnt lgkmcnt(3)
  v_mfma_f32_16x16x32_bf16 v[56:59], v[112:115], a[64:67], v[56:59]
  ds_read_b128 v[96:99], v12 offset:2048
  v_mfma_f32_16x16x32_bf16 v[84:87], v[112:115], a[68:71], v[84:87]
  s_waitcnt lgkmcnt(3)
  v_mfma_f32_16x16x32_bf16 v[32:35], v[116:119], a[72:75], v[32:35]
  ds_read_b128 v[100:103], v12 offset:3072
  v_mfma_f32_16x16x32_bf16 v[60:63], v[116:119], a[76:79], v[60:63]
  s_waitcnt lgkmcnt(3)
  v_mfma_f32_16x16x32_bf16 v[36:39], v[88:91], a[72:75], v[36:39]
  ds_read_b128 v[104:107], v12 offset:4096
  v_mfma_f32_16x16x32_bf16 v[64:67], v[88:91], a[76:79], v[64:67]
  s_waitcnt lgkmcnt(3)
  v_mfma_f32_16x16x32_bf16 v[40:43], v[92:95], a[72:75], v[40:43]
  ds_read_b128 v[108:111], v12 offset:5120
  v_mfma_f32_16x16x32_bf16 v[68:71], v[92:95], a[76:79], v[68:71]
  s_waitcnt lgkmcnt(3)
  v_mfma_f32_16x16x32_bf16 v[44:47], v[96:99], a[72:75], v[44:47]
  ds_read_b128 v[112:115], v12 offset:6144
  v_mfma_f32_16x16x32_bf16 v[72:75], v[96:99], a[76:79], v[72:75]
  s_waitcnt lgkmcnt(3)
  v_mfma_f32_16x16x32_bf16 v[48:51], v[100:103], a[72:75], v[48:51]
  ds_read_b128 v[116:119], v12 offset:7168
  v_mfma_f32_16x16x32_bf16 v[76:79], v[100:103], a[76:79], v[76:79]
  s_waitcnt lgkmcnt(3)
  v_mfma_f32_16x16x32_bf16 v[52:55], v[104:107], a[72:75], v[52:55]
  ds_read_b128 v[88:91], v12 offset:8192
  v_mfma_f32_16x16x32_bf16 v[80:83], v[104:107], a[76:79], v[80:83]
  s_waitcnt lgkmcnt(3)
  v_mfma_f32_16x16x32_bf16 v[56:59], v[108:111], a[72:75], v[56:59]
  ds_read_b128 v[92:95], v12 offset:9216
  v_mfma_f32_16x16x32_bf16 v[84:87], v[108:111], a[76:79], v[84:87]
  s_waitcnt lgkmcnt(3)
  v_mfma_f32_16x16x32_bf16 v[32:35], v[112:115], a[80:83], v[32:35]
  ds_read_b128 v[96:99], v12 offset:10240
  v_mfma_f32_16x16x32_bf16 v[60:63], v[112:115], a[84:87], v[60:63]
  s_waitcnt lgkmcnt(3)
  v_mfma_f32_16x16x32_bf16 v[36:39], v[116:119], a[80:83], v[36:39]
  ds_read_b128 v[100:103], v12 offset:11264
  v_mfma_f32_16x16x32_bf16 v[64:67], v[116:119], a[84:87], v[64:67]
  s_waitcnt lgkmcnt(3)
  v_mfma_f32_16x16x32_bf16 v[40:43], v[88:91], a[80:83], v[40:43]
  ds_read_b128 v[104:107], v12 offset:12288
  v_mfma_f32_16x16x32_bf16 v[68:71], v[88:91], a[84:87], v[68:71]
  s_waitcnt lgkmcnt(3)
  v_mfma_f32_16x16x32_bf16 v[44:47], v[92:95], a[80:83], v[44:47]
  ds_read_b128 v[108:111], v12 offset:13312
  v_mfma_f32_16x16x32_bf16 v[72:75], v[92:95], a[84:87], v[72:75]
  s_waitcnt lgkmcnt(3)
  v_mfma_f32_16x16x32_bf16 v[48:51], v[96:99], a[80:83], v[48:51]
  ds_read_b128 v[112:115], v12 offset:14336
  v_mfma_f32_16x16x32_bf16 v[76:79], v[96:99], a[84:87], v[76:79]
  s_waitcnt lgkmcnt(3)
  v_mfma_f32_16x16x32_bf16 v[52:55], v[100:103], a[80:83], v[52:55]
  ds_read_b128 v[116:119], v12 offset:15360
  v_mfma_f32_16x16x32_bf16 v[80:83], v[100:103], a[84:87], v[80:83]
  s_waitcnt lgkmcnt(3)
  v_mfma_f32_16x16x32_bf16 v[56:59], v[104:107], a[80:83], v[56:59]
  ds_read_b128 v[88:91], v12 offset:16384
  v_mfma_f32_16x16x32_bf16 v[84:87], v[104:107], a[84:87], v[84:87]
  s_waitcnt lgkmcnt(3)
  v_mfma_f32_16x16x32_bf16 v[32:35], v[108:111], a[88:91], v[32:35]
  ds_read_b128 v[92:95], v12 offset:17408
  v_mfma_f32_16x16x32_bf16 v[60:63], v[108:111], a[92:95], v[60:63]
  s_waitcnt lgkmcnt(3)
  v_mfma_f32_16x16x32_bf16 v[36:39], v[112:115], a[88:91], v[36:39]
  ds_read_b128 v[96:99], v12 offset:18432
  v_mfma_f32_16x16x32_bf16 v[64:67], v[112:115], a[92:95], v[64:67]
  s_waitcnt lgkmcnt(3)
  v_mfma_f32_16x16x32_bf16 v[40:43], v[116:119], a[88:91], v[40:43]
  ds_read_b128 v[100:103], v12 offset:19456
  v_mfma_f32_16x16x32_bf16 v[68:71], v[116:119], a[92:95], v[68:71]
  s_waitcnt lgkmcnt(3)
  v_mfma_f32_16x16x32_bf16 v[44:47], v[88:91], a[88:91], v[44:47]
  s_barrier
  ds_read_b128 v[104:107], v12 offset:20480
  s_waitcnt vmcnt(10)
  v_add_f32 v140, v140, v142
  v_add_f32 v141, v141, v143
  v_mov_b32 v18, v140
  v_mfma_f32_16x16x32_bf16 v[72:75], v[88:91], a[92:95], v[72:75]
  ds_read_b128 v[164:167], v26 offset:0
  v_permlane16_swap_b32 v140, v18
  v_add_f32 v140, v140, v18
  s_waitcnt lgkmcnt(4)
  v_mfma_f32_16x16x32_bf16 v[48:51], v[92:95], a[88:91], v[48:51]
  ds_read_b128 v[108:111], v12 offset:21504
  v_mov_b32 v19, v141
  ds_read_b128 v[168:171], v26 offset:16
  s_nop 0
  v_permlane16_swap_b32 v141, v19
  v_mfma_f32_16x16x32_bf16 v[76:79], v[92:95], a[92:95], v[76:79]
  v_add_f32 v141, v141, v19
  v_mov_b32 v18, v140
  ds_read_b128 v[172:175], v26 offset:128
  s_waitcnt lgkmcnt(6)
  v_mfma_f32_16x16x32_bf16 v[52:55], v[96:99], a[88:91], v[52:55]
  ds_read_b128 v[112:115], v12 offset:22528
  v_permlane32_swap_b32 v140, v18
  v_add_f32 v140, v140, v18
  v_mov_b32 v19, v141
  v_mfma_f32_16x16x32_bf16 v[80:83], v[96:99], a[92:95], v[80:83]
  ds_read_b128 v[176:179], v26 offset:144
  v_permlane32_swap_b32 v141, v19
  v_add_f32 v141, v141, v19
  s_waitcnt lgkmcnt(7)
  v_mfma_f32_16x16x32_bf16 v[56:59], v[100:103], a[88:91], v[56:59]
  ds_read_b128 v[116:119], v12 offset:23552
  v_mul_f32 v140, 0x3acccccd, v140
  ds_read_b128 v[180:183], v26 offset:256
  v_mul_f32 v141, 0x3acccccd, v141
  v_mfma_f32_16x16x32_bf16 v[84:87], v[100:103], a[92:95], v[84:87]
  v_fma_f32 v141, -v140, v140, v141
  v_max_f32 v141, 0, v141
  ds_read_b128 v[184:187], v26 offset:272
  s_waitcnt lgkmcnt(9)
  v_mfma_f32_16x16x32_bf16 v[32:35], v[104:107], a[96:99], v[32:35]
  ds_read_b128 v[88:91], v12 offset:24576
  v_cvt_pk_bf16_f32 v18, v140, v141
  v_lshlrev_b32 v140, 16, v18
  v_and_b32 v141, s30, v18
  v_mfma_f32_16x16x32_bf16 v[60:63], v[104:107], a[100:103], v[60:63]
  ds_read_b128 v[188:191], v27 offset:384
  v_add_f32 v141, 0x3727c5ac, v141
  v_cvt_pk_bf16_f32 v141, v141, v141
  s_waitcnt lgkmcnt(9)
  v_mfma_f32_16x16x32_bf16 v[36:39], v[108:111], a[96:99], v[36:39]
  ds_read_b128 v[92:95], v12 offset:25600
  v_lshlrev_b32 v141, 16, v141
  ds_read_b128 v[192:195], v26 offset:448
  v_sqrt_f32 v141, v141
  v_mfma_f32_16x16x32_bf16 v[64:67], v[108:111], a[100:103], v[64:67]
  v_cvt_pk_bf16_f32 v141, v141, v141
  v_lshlrev_b32 v141, 16, v141
  ds_read_b128 v[196:199], v26 offset:464
  s_waitcnt lgkmcnt(9)
  v_mfma_f32_16x16x32_bf16 v[40:43], v[112:115], a[96:99], v[40:43]
  ds_read_b128 v[96:99], v12 offset:26624
  v_rcp_f32 v16, v141
  v_sub_f32 v14, 0, v140
  v_mul_f32 v14, v14, v16
  v_mfma_f32_16x16x32_bf16 v[68:71], v[112:115], a[100:103], v[68:71]
  ds_read_b128 v[200:203], v26 offset:576
  s_waitcnt vmcnt(8)
  v_add_f32 v144, v144, v146
  v_add_f32 v145, v145, v147
  s_waitcnt lgkmcnt(9)
  v_mfma_f32_16x16x32_bf16 v[44:47], v[116:119], a[96:99], v[44:47]
  ds_read_b128 v[100:103], v12 offset:27648
  v_mov_b32 v18, v144
  ds_read_b128 v[204:207], v26 offset:592
  s_nop 0
  v_permlane16_swap_b32 v144, v18
  v_mfma_f32_16x16x32_bf16 v[72:75], v[116:119], a[100:103], v[72:75]
  v_add_f32 v144, v144, v18
  v_mov_b32 v19, v145
  ds_read_b128 v[208:211], v26 offset:704
  s_waitcnt lgkmcnt(9)
  v_mfma_f32_16x16x32_bf16 v[48:51], v[88:91], a[96:99], v[48:51]
  ds_read_b128 v[104:107], v12 offset:28672
  v_permlane16_swap_b32 v145, v19
  v_add_f32 v145, v145, v19
  v_mov_b32 v18, v144
  v_mfma_f32_16x16x32_bf16 v[76:79], v[88:91], a[100:103], v[76:79]
  ds_read_b128 v[212:215], v26 offset:720
  v_permlane32_swap_b32 v144, v18
  v_add_f32 v144, v144, v18
  s_waitcnt lgkmcnt(9)
  v_mfma_f32_16x16x32_bf16 v[52:55], v[92:95], a[96:99], v[52:55]
  ds_read_b128 v[108:111], v12 offset:29696
  v_mov_b32 v19, v145
  ds_read_b128 v[216:219], v27 offset:832
  s_nop 0
  v_permlane32_swap_b32 v145, v19
  v_mfma_f32_16x16x32_bf16 v[80:83], v[92:95], a[100:103], v[80:83]
  v_add_f32 v145, v145, v19
  v_mul_f32 v144, 0x3acccccd, v144
  v_mul_f32 v145, 0x3acccccd, v145
  s_waitcnt lgkmcnt(8)
  v_mfma_f32_16x16x32_bf16 v[56:59], v[96:99], a[96:99], v[56:59]
  ds_read_b128 v[112:115], v12 offset:30720
  v_fma_f32 v145, -v144, v144, v145
  v_max_f32 v145, 0, v145
  v_cvt_pk_bf16_f32 v18, v144, v145
  v_mfma_f32_16x16x32_bf16 v[84:87], v[96:99], a[100:103], v[84:87]
  v_lshlrev_b32 v144, 16, v18
  v_and_b32 v145, s30, v18
  v_add_f32 v145, 0x3727c5ac, v145
  s_waitcnt lgkmcnt(7)
  v_mfma_f32_16x16x32_bf16 v[32:35], v[100:103], a[104:107], v[32:35]
  ds_read_b128 v[116:119], v12 offset:31744
  v_cvt_pk_bf16_f32 v145, v145, v145
  v_lshlrev_b32 v145, 16, v145
  v_sqrt_f32 v145, v145
  v_mfma_f32_16x16x32_bf16 v[60:63], v[100:103], a[108:111], v[60:63]
  v_cvt_pk_bf16_f32 v145, v145, v145
  v_lshlrev_b32 v145, 16, v145
  v_rcp_f32 v17, v145
  s_waitcnt lgkmcnt(5)
  v_mfma_f32_16x16x32_bf16 v[36:39], v[104:107], a[104:107], v[36:39]
  ds_read_b128 v[88:91], v12 offset:32768
  v_sub_f32 v15, 0, v144
  v_mul_f32 v15, v15, v17
  v_lshlrev_b32 v220, 16, v148
  v_mfma_f32_16x16x32_bf16 v[64:67], v[104:107], a[108:111], v[64:67]
  v_and_b32 v221, s30, v148
  v_lshlrev_b32 v222, 16, v149
  v_and_b32 v223, s30, v149
  s_waitcnt lgkmcnt(4)
  v_mfma_f32_16x16x32_bf16 v[40:43], v[108:111], a[104:107], v[40:43]
  ds_read_b128 v[92:95], v12 offset:33792
  v_lshlrev_b32 v224, 16, v150
  v_and_b32 v225, s30, v150
  v_lshlrev_b32 v226, 16, v151
  v_mfma_f32_16x16x32_bf16 v[68:71], v[108:111], a[108:111], v[68:71]
  v_and_b32 v227, s30, v151
  v_lshlrev_b32 v228, 16, v152
  v_and_b32 v229, s30, v152
  s_waitcnt lgkmcnt(3)
  v_mfma_f32_16x16x32_bf16 v[44:47], v[112:115], a[104:107], v[44:47]
  ds_read_b128 v[96:99], v12 offset:34816
  v_lshlrev_b32 v230, 16, v153
  v_and_b32 v231, s30, v153
  v_lshlrev_b32 v232, 16, v154
  v_mfma_f32_16x16x32_bf16 v[72:75], v[112:115], a[108:111], v[72:75]
  v_and_b32 v233, s30, v154
  v_lshlrev_b32 v234, 16, v155
  v_and_b32 v235, s30, v155
  s_waitcnt lgkmcnt(3)
  v_mfma_f32_16x16x32_bf16 v[48:51], v[116:119], a[104:107], v[48:51]
  ds_read_b128 v[100:103], v12 offset:35840
  v_lshlrev_b32 v236, 16, v156
  v_and_b32 v237, s30, v156
  v_lshlrev_b32 v238, 16, v157
  v_mfma_f32_16x16x32_bf16 v[76:79], v[116:119], a[108:111], v[76:79]
  v_and_b32 v239, s30, v157
  v_lshlrev_b32 v240, 16, v158
  v_and_b32 v241, s30, v158
  s_waitcnt lgkmcnt(3)
  v_mfma_f32_16x16x32_bf16 v[52:55], v[88:91], a[104:107], v[52:55]
  ds_read_b128 v[104:107], v12 offset:36864
  v_lshlrev_b32 v242, 16, v159
  v_and_b32 v243, s30, v159
  v_lshlrev_b32 v244, 16, v160
  v_mfma_f32_16x16x32_bf16 v[80:83], v[88:91], a[108:111], v[80:83]
  v_and_b32 v245, s30, v160
  v_lshlrev_b32 v246, 16, v161
  v_and_b32 v247, s30, v161
  s_waitcnt lgkmcnt(3)
  v_mfma_f32_16x16x32_bf16 v[56:59], v[92:95], a[104:107], v[56:59]
  ds_read_b128 v[108:111], v12 offset:37888
  v_mov_b32 v24, v17
  v_mov_b32 v25, v17
  v_mov_b32 v17, v16
  v_mfma_f32_16x16x32_bf16 v[84:87], v[92:95], a[108:111], v[84:87]
  v_sub_f32 v14, v14, v15
  v_fmac_f32 v192, v164, v15
  v_fma_f32 v164, v164, v14, v192
  s_waitcnt lgkmcnt(3)
  v_mfma_f32_16x16x32_bf16 v[32:35], v[96:99], a[112:115], v[32:35]
  ds_read_b128 v[112:115], v12 offset:38912
  v_fmac_f32 v193, v165, v15
  v_fma_f32 v165, v165, v14, v193
  v_fmac_f32 v194, v166, v15
  v_mfma_f32_16x16x32_bf16 v[60:63], v[96:99], a[116:119], v[60:63]
  v_fma_f32 v166, v166, v14, v194
  v_fmac_f32 v195, v167, v15
  v_fma_f32 v167, v167, v14, v195
  s_waitcnt lgkmcnt(3)
  v_mfma_f32_16x16x32_bf16 v[36:39], v[100:103], a[112:115], v[36:39]
  ds_read_b128 v[116:119], v12 offset:39936
  v_fmac_f32 v196, v168, v15
  v_fma_f32 v168, v168, v14, v196
  v_fmac_f32 v197, v169, v15
  v_mfma_f32_16x16x32_bf16 v[64:67], v[100:103], a[116:119], v[64:67]
  v_fma_f32 v169, v169, v14, v197
  v_fmac_f32 v198, v170, v15
  v_fma_f32 v170, v170, v14, v198
  s_waitcnt lgkmcnt(3)
  v_mfma_f32_16x16x32_bf16 v[40:43], v[104:107], a[112:115], v[40:43]
  ds_read_b128 v[88:91], v12 offset:40960
  v_fmac_f32 v199, v171, v15
  v_fma_f32 v171, v171, v14, v199
  v_fmac_f32 v200, v172, v15
  v_mfma_f32_16x16x32_bf16 v[68:71], v[104:107], a[116:119], v[68:71]
  v_fma_f32 v172, v172, v14, v200
  v_fmac_f32 v201, v173, v15
  v_fma_f32 v173, v173, v14, v201
  s_waitcnt lgkmcnt(3)
  v_mfma_f32_16x16x32_bf16 v[44:47], v[108:111], a[112:115], v[44:47]
  ds_read_b128 v[92:95], v12 offset:41984
  v_fmac_f32 v202, v174, v15
  v_fma_f32 v174, v174, v14, v202
  v_fmac_f32 v203, v175, v15
  v_mfma_f32_16x16x32_bf16 v[72:75], v[108:111], a[116:119], v[72:75]
  v_fma_f32 v175, v175, v14, v203
  v_fmac_f32 v204, v176, v15
  v_fma_f32 v176, v176, v14, v204
  s_waitcnt lgkmcnt(3)
  v_mfma_f32_16x16x32_bf16 v[48:51], v[112:115], a[112:115], v[48:51]
  ds_read_b128 v[96:99], v12 offset:43008
  v_fmac_f32 v205, v177, v15
  v_fma_f32 v177, v177, v14, v205
  v_fmac_f32 v206, v178, v15
  v_mfma_f32_16x16x32_bf16 v[76:79], v[112:115], a[116:119], v[76:79]
  s_add_u32 s54, s52, 20480
  buffer_load_dwordx4 a[160:163], v1, s[16:19], s54 offen offset:0
  v_fma_f32 v178, v178, v14, v206
  v_fmac_f32 v207, v179, v15
  v_fma_f32 v179, v179, v14, v207
  s_waitcnt lgkmcnt(3)
  v_mfma_f32_16x16x32_bf16 v[52:55], v[116:119], a[112:115], v[52:55]
  ds_read_b128 v[100:103], v12 offset:44032
  v_fmac_f32 v208, v180, v15
  v_fma_f32 v180, v180, v14, v208
  v_fmac_f32 v209, v181, v15
  v_mfma_f32_16x16x32_bf16 v[80:83], v[116:119], a[116:119], v[80:83]
  buffer_load_dwordx4 a[164:167], v1, s[16:19], s54 offen offset:1024
  v_fma_f32 v181, v181, v14, v209
  v_fmac_f32 v210, v182, v15
  v_fma_f32 v182, v182, v14, v210
  s_waitcnt lgkmcnt(3)
  v_mfma_f32_16x16x32_bf16 v[56:59], v[88:91], a[112:115], v[56:59]
  ds_read_b128 v[104:107], v12 offset:45056
  v_fmac_f32 v211, v183, v15
  v_fma_f32 v183, v183, v14, v211
  v_fmac_f32 v212, v184, v15
  v_mfma_f32_16x16x32_bf16 v[84:87], v[88:91], a[116:119], v[84:87]
  buffer_load_dwordx4 a[168:171], v1, s[16:19], s54 offen offset:2048
  v_fma_f32 v184, v184, v14, v212
  v_fmac_f32 v213, v185, v15
  v_fma_f32 v185, v185, v14, v213
  s_waitcnt lgkmcnt(3)
  v_mfma_f32_16x16x32_bf16 v[32:35], v[92:95], a[120:123], v[32:35]
  ds_read_b128 v[108:111], v12 offset:46080
  v_fmac_f32 v214, v186, v15
  v_fma_f32 v186, v186, v14, v214
  v_fmac_f32 v215, v187, v15
  v_mfma_f32_16x16x32_bf16 v[60:63], v[92:95], a[124:127], v[60:63]
  buffer_load_dwordx4 a[172:175], v1, s[16:19], s54 offen offset:3072
  v_fma_f32 v187, v187, v14, v215
  v_fmac_f32 v216, v188, v15
  v_fma_f32 v188, v188, v14, v216
  s_waitcnt lgkmcnt(3)
  v_mfma_f32_16x16x32_bf16 v[36:39], v[96:99], a[120:123], v[36:39]
  ds_read_b128 v[112:115], v12 offset:47104
  v_fmac_f32 v217, v189, v15
  v_fma_f32 v189, v189, v14, v217
  v_fmac_f32 v218, v190, v15
  v_mfma_f32_16x16x32_bf16 v[64:67], v[96:99], a[124:127], v[64:67]
  s_add_u32 s54, s52, 24576
  buffer_load_dwordx4 a[176:179], v1, s[16:19], s54 offen offset:0
  v_fma_f32 v190, v190, v14, v218
  v_fmac_f32 v219, v191, v15
  v_fma_f32 v191, v191, v14, v219
  s_waitcnt lgkmcnt(3)
  v_mfma_f32_16x16x32_bf16 v[40:43], v[100:103], a[120:123], v[40:43]
  ds_read_b128 v[116:119], v12 offset:48128
  v_mfma_f32_16x16x32_bf16 v[68:71], v[100:103], a[124:127], v[68:71]
  s_add_u32 s54, s52, 25600
  buffer_load_dwordx4 a[196:199], v1, s[16:19], s54 offen offset:0
  s_waitcnt lgkmcnt(3)
  v_mfma_f32_16x16x32_bf16 v[44:47], v[104:107], a[120:123], v[44:47]
  s_barrier
  ds_read_b128 v[88:91], v12 offset:49152
  v_mfma_f32_16x16x32_bf16 v[72:75], v[104:107], a[124:127], v[72:75]
  buffer_load_dwordx4 a[200:203], v1, s[16:19], s54 offen offset:1024
  s_waitcnt lgkmcnt(3)
  v_mfma_f32_16x16x32_bf16 v[48:51], v[108:111], a[120:123], v[48:51]
  ds_read_b128 v[92:95], v12 offset:56320
  v_mfma_f32_16x16x32_bf16 v[76:79], v[108:111], a[124:127], v[76:79]
  buffer_load_dwordx4 a[204:207], v1, s[16:19], s54 offen offset:2048
  s_waitcnt lgkmcnt(3)
  v_mfma_f32_16x16x32_bf16 v[52:55], v[112:115], a[120:123], v[52:55]
  ds_read_b128 v[96:99], v12 offset:63488
  v_mfma_f32_16x16x32_bf16 v[80:83], v[112:115], a[124:127], v[80:83]
  buffer_load_dwordx4 a[208:211], v1, s[16:19], s54 offen offset:3072
  s_waitcnt lgkmcnt(3)
  v_mfma_f32_16x16x32_bf16 v[56:59], v[116:119], a[120:123], v[56:59]
  ds_read_b128 v[100:103], v13 offset:5120
  v_mfma_f32_16x16x32_bf16 v[84:87], v[116:119], a[124:127], v[84:87]
  s_add_u32 s54, s52, 29696
  buffer_load_dwordx4 a[212:215], v1, s[16:19], s54 offen offset:0
  s_waitcnt vmcnt(17) lgkmcnt(3)
  v_mfma_f32_16x16x32_bf16 v[32:35], v[88:91], a[220:223], v[32:35]
  ds_read_b128 v[104:107], v12 offset:50176
  s_waitcnt vmcnt(16)
  v_mfma_f32_16x16x32_bf16 v[60:63], v[88:91], a[224:227], v[60:63]
  s_add_u32 s54, s52, 0
  buffer_load_dwordx4 a[16:19], v30, s[16:19], s54 offen offset:0
  s_waitcnt vmcnt(16) lgkmcnt(3)
  v_mfma_f32_16x16x32_bf16 v[32:35], v[92:95], a[228:231], v[32:35]
  ds_read_b128 v[108:111], v12 offset:57344
  s_waitcnt vmcnt(15)
  v_mfma_f32_16x16x32_bf16 v[60:63], v[92:95], a[232:235], v[60:63]
  buffer_load_dwordx4 a[20:23], v30, s[16:19], s54 offen offset:1024
  s_waitcnt vmcnt(15) lgkmcnt(3)
  v_mfma_f32_16x16x32_bf16 v[32:35], v[96:99], a[236:239], v[32:35]
  ds_read_b128 v[112:115], v12 offset:64512
  s_waitcnt vmcnt(14)
  v_mfma_f32_16x16x32_bf16 v[60:63], v[96:99], a[240:243], v[60:63]
  buffer_load_dwordx4 a[24:27], v30, s[16:19], s54 offen offset:2048
  s_waitcnt vmcnt(14) lgkmcnt(3)
  v_mfma_f32_16x16x32_bf16 v[32:35], v[100:103], a[244:247], v[32:35]
  ds_read_b128 v[116:119], v13 offset:6144
  s_waitcnt vmcnt(13)
  v_mfma_f32_16x16x32_bf16 v[60:63], v[100:103], a[248:251], v[60:63]
  buffer_load_dwordx4 a[28:31], v30, s[16:19], s54 offen offset:3072
  s_waitcnt lgkmcnt(3)
  v_mfma_f32_16x16x32_bf16 v[36:39], v[104:107], a[220:223], v[36:39]
  ds_read_b128 v[88:91], v12 offset:51200
  s_nop 0
  v_pk_fma_f32 v[32:33], v[32:33], v[16:17], v[164:165]
  v_pk_fma_f32 v[34:35], v[34:35], v[16:17], v[166:167]
  s_nop 0
  v_pk_fma_f32 v[60:61], v[60:61], v[24:25], v[192:193]
  v_pk_fma_f32 v[62:63], v[62:63], v[24:25], v[194:195]
  v_cvt_pk_bf16_f32 v20, v32, v33
  v_cvt_pk_bf16_f32 v21, v34, v35
  v_mfma_f32_16x16x32_bf16 v[64:67], v[104:107], a[224:227], v[64:67]
  s_add_u32 s54, s52, 4096
  buffer_load_dwordx4 a[32:35], v30, s[16:19], s54 offen offset:0
  v_cvt_pk_bf16_f32 v22, v60, v61
  v_cvt_pk_bf16_f32 v23, v62, v63
  v_lshlrev_b32 v32, 16, v20
  v_lshlrev_b32 v34, 16, v21
  v_lshlrev_b32 v60, 16, v22
  v_lshlrev_b32 v62, 16, v23
  s_waitcnt lgkmcnt(3)
  v_mfma_f32_16x16x32_bf16 v[36:39], v[108:111], a[228:231], v[36:39]
  ds_read_b128 v[92:95], v12 offset:58368
  v_and_b32 v33, s30, v20
  v_and_b32 v35, s30, v21
  v_and_b32 v61, s30, v22
  v_and_b32 v63, s30, v23
  v_pk_add_f32 v[32:33], v[32:33], v[220:221]
  v_pk_add_f32 v[34:35], v[34:35], v[222:223]
  v_mfma_f32_16x16x32_bf16 v[64:67], v[108:111], a[232:235], v[64:67]
  s_add_u32 s54, s52, 5120
  buffer_load_dwordx4 a[52:55], v1, s[16:19], s54 offen offset:0
  v_pk_add_f32 v[60:61], v[60:61], v[220:221]
  v_pk_add_f32 v[62:63], v[62:63], v[222:223]
  v_cvt_pk_bf16_f32 v20, v32, v33
  v_cvt_pk_bf16_f32 v21, v34, v35
  v_cvt_pk_bf16_f32 v22, v60, v61
  v_cvt_pk_bf16_f32 v23, v62, v63
  s_waitcnt lgkmcnt(3)
  v_mfma_f32_16x16x32_bf16 v[36:39], v[112:115], a[236:239], v[36:39]
  ds_read_b128 v[96:99], v13 offset:0
  v_pk_max_i16 v20, v20, 0
  v_pk_max_i16 v21, v21, 0
  v_pk_max_i16 v22, v22, 0
  v_pk_max_i16 v23, v23, 0
  v_lshlrev_b32 v32, 16, v20
  v_lshlrev_b32 v34, 16, v21
  v_mfma_f32_16x16x32_bf16 v[64:67], v[112:115], a[240:243], v[64:67]
  buffer_load_dwordx4 a[56:59], v1, s[16:19], s54 offen offset:1024
  v_lshlrev_b32 v60, 16, v22
  v_lshlrev_b32 v62, 16, v23
  v_and_b32 v33, s30, v20
  v_and_b32 v35, s30, v21
  v_and_b32 v61, s30, v22
  v_and_b32 v63, s30, v23
  s_waitcnt lgkmcnt(3)
  v_mfma_f32_16x16x32_bf16 v[36:39], v[116:119], a[244:247], v[36:39]
  ds_read_b128 v[100:103], v13 offset:7168
  v_pk_mul_f32 v[32:33], v[32:33], v[32:33]
  v_pk_mul_f32 v[34:35], v[34:35], v[34:35]
  v_pk_mul_f32 v[60:61], v[60:61], v[60:61]
  v_pk_mul_f32 v[62:63], v[62:63], v[62:63]
  v_cvt_pk_bf16_f32 v32, v32, v33
  v_cvt_pk_bf16_f32 v33, v34, v35
  v_mfma_f32_16x16x32_bf16 v[64:67], v[116:119], a[248:251], v[64:67]
  buffer_load_dwordx4 a[60:63], v1, s[16:19], s54 offen offset:2048
  v_cvt_pk_bf16_f32 v60, v60, v61
  v_cvt_pk_bf16_f32 v61, v62, v63
  s_waitcnt lgkmcnt(3)
  v_mfma_f32_16x16x32_bf16 v[40:43], v[88:91], a[220:223], v[40:43]
  ds_read_b128 v[104:107], v12 offset:52224
  v_pk_fma_f32 v[36:37], v[36:37], v[16:17], v[168:169]
  v_pk_fma_f32 v[38:39], v[38:39], v[16:17], v[170:171]
  v_pk_fma_f32 v[64:65], v[64:65], v[24:25], v[196:197]
  v_pk_fma_f32 v[66:67], v[66:67], v[24:25], v[198:199]
  v_cvt_pk_bf16_f32 v20, v36, v37
  v_cvt_pk_bf16_f32 v21, v38, v39
  v_mfma_f32_16x16x32_bf16 v[68:71], v[88:91], a[224:227], v[68:71]
  buffer_load_dwordx4 a[64:67], v1, s[16:19], s54 offen offset:3072
  v_cvt_pk_bf16_f32 v22, v64, v65
  v_cvt_pk_bf16_f32 v23, v66, v67
  v_lshlrev_b32 v36, 16, v20
  v_lshlrev_b32 v38, 16, v21
  v_lshlrev_b32 v64, 16, v22
  v_lshlrev_b32 v66, 16, v23
  s_waitcnt lgkmcnt(3)
  v_mfma_f32_16x16x32_bf16 v[40:43], v[92:95], a[228:231], v[40:43]
  ds_read_b128 v[108:111], v12 offset:59392
  v_and_b32 v37, s30, v20
  v_and_b32 v39, s30, v21
  v_and_b32 v65, s30, v22
  v_and_b32 v67, s30, v23
  v_pk_add_f32 v[36:37], v[36:37], v[224:225]
  v_pk_add_f32 v[38:39], v[38:39], v[226:227]
  v_mfma_f32_16x16x32_bf16 v[68:71], v[92:95], a[232:235], v[68:71]
  s_add_u32 s54, s52, 9216
  buffer_load_dwordx4 a[68:71], v1, s[16:19], s54 offen offset:0
  v_pk_add_f32 v[64:65], v[64:65], v[224:225]
  v_pk_add_f32 v[66:67], v[66:67], v[226:227]
  v_cvt_pk_bf16_f32 v20, v36, v37
  v_cvt_pk_bf16_f32 v21, v38, v39
  v_cvt_pk_bf16_f32 v22, v64, v65
  v_cvt_pk_bf16_f32 v23, v66, v67
  s_waitcnt lgkmcnt(3)
  v_mfma_f32_16x16x32_bf16 v[40:43], v[96:99], a[236:239], v[40:43]
  ds_read_b128 v[112:115], v13 offset:1024
  v_pk_max_i16 v20, v20, 0
  v_pk_max_i16 v21, v21, 0
  v_pk_max_i16 v22, v22, 0
  v_pk_max_i16 v23, v23, 0
  v_lshlrev_b32 v36, 16, v20
  v_lshlrev_b32 v38, 16, v21
  v_mfma_f32_16x16x32_bf16 v[68:71], v[96:99], a[240:243], v[68:71]
  s_add_u32 s54, s52, 10240
  buffer_load_dwordx4 a[88:91], v1, s[16:19], s54 offen offset:0
  v_lshlrev_b32 v64, 16, v22
  v_lshlrev_b32 v66, 16, v23
  v_and_b32 v37, s30, v20
  v_and_b32 v39, s30, v21
  v_and_b32 v65, s30, v22
  v_and_b32 v67, s30, v23
  s_waitcnt lgkmcnt(3)
  v_mfma_f32_16x16x32_bf16 v[40:43], v[100:103], a[244:247], v[40:43]
  ds_read_b128 v[116:119], v13 offset:8192
  v_pk_mul_f32 v[36:37], v[36:37], v[36:37]
  v_pk_mul_f32 v[38:39], v[38:39], v[38:39]
  v_pk_mul_f32 v[64:65], v[64:65], v[64:65]
  v_pk_mul_f32 v[66:67], v[66:67], v[66:67]
  v_cvt_pk_bf16_f32 v34, v36, v37
  v_cvt_pk_bf16_f32 v35, v38, v39
  v_mfma_f32_16x16x32_bf16 v[68:71], v[100:103], a[248:251], v[68:71]
  buffer_load_dwordx4 a[92:95], v1, s[16:19], s54 offen offset:1024
  v_cvt_pk_bf16_f32 v62, v64, v65
  v_cvt_pk_bf16_f32 v63, v66, v67
  buffer_store_dwordx4 v[32:35], v2, s[16:19], s32 offen offset:0 sc1
  buffer_store_dwordx4 v[60:63], v2, s[16:19], s32 offen offset:256 sc1
  s_waitcnt lgkmcnt(3)
  v_mfma_f32_16x16x32_bf16 v[44:47], v[104:107], a[220:223], v[44:47]
  ds_read_b128 v[88:91], v12 offset:53248
  v_pk_fma_f32 v[40:41], v[40:41], v[16:17], v[172:173]
  v_pk_fma_f32 v[42:43], v[42:43], v[16:17], v[174:175]
  v_pk_fma_f32 v[68:69], v[68:69], v[24:25], v[200:201]
  v_pk_fma_f32 v[70:71], v[70:71], v[24:25], v[202:203]
  v_cvt_pk_bf16_f32 v20, v40, v41
  v_cvt_pk_bf16_f32 v21, v42, v43
  v_mfma_f32_16x16x32_bf16 v[72:75], v[104:107], a[224:227], v[72:75]
  buffer_load_dwordx4 a[96:99], v1, s[16:19], s54 offen offset:2048
  v_cvt_pk_bf16_f32 v22, v68, v69
  v_cvt_pk_bf16_f32 v23, v70, v71
  v_lshlrev_b32 v40, 16, v20
  v_lshlrev_b32 v42, 16, v21
  v_lshlrev_b32 v68, 16, v22
  v_lshlrev_b32 v70, 16, v23
  s_waitcnt lgkmcnt(3)
  v_mfma_f32_16x16x32_bf16 v[44:47], v[108:111], a[228:231], v[44:47]
  ds_read_b128 v[92:95], v12 offset:60416
  v_and_b32 v41, s30, v20
  v_and_b32 v43, s30, v21
  v_and_b32 v69, s30, v22
  v_and_b32 v71, s30, v23
  v_pk_add_f32 v[40:41], v[40:41], v[228:229]
  v_pk_add_f32 v[42:43], v[42:43], v[230:231]
  v_mfma_f32_16x16x32_bf16 v[72:75], v[108:111], a[232:235], v[72:75]
  buffer_load_dwordx4 a[100:103], v1, s[16:19], s54 offen offset:3072
  v_pk_add_f32 v[68:69], v[68:69], v[228:229]
  v_pk_add_f32 v[70:71], v[70:71], v[230:231]
  v_cvt_pk_bf16_f32 v20, v40, v41
  v_cvt_pk_bf16_f32 v21, v42, v43
  v_cvt_pk_bf16_f32 v22, v68, v69
  v_cvt_pk_bf16_f32 v23, v70, v71
  s_waitcnt lgkmcnt(3)
  v_mfma_f32_16x16x32_bf16 v[44:47], v[112:115], a[236:239], v[44:47]
  ds_read_b128 v[96:99], v13 offset:2048
  v_pk_max_i16 v20, v20, 0
  v_pk_max_i16 v21, v21, 0
  v_pk_max_i16 v22, v22, 0
  v_pk_max_i16 v23, v23, 0
  v_lshlrev_b32 v40, 16, v20
  v_lshlrev_b32 v42, 16, v21
  v_mfma_f32_16x16x32_bf16 v[72:75], v[112:115], a[240:243], v[72:75]
  s_add_u32 s54, s52, 14336
  buffer_load_dwordx4 a[104:107], v1, s[16:19], s54 offen offset:0
  v_lshlrev_b32 v68, 16, v22
  v_lshlrev_b32 v70, 16, v23
  v_and_b32 v41, s30, v20
  v_and_b32 v43, s30, v21
  v_and_b32 v69, s30, v22
  v_and_b32 v71, s30, v23
  s_waitcnt lgkmcnt(3)
  v_mfma_f32_16x16x32_bf16 v[44:47], v[116:119], a[244:247], v[44:47]
  ds_read_b128 v[100:103], v13 offset:9216
  v_pk_mul_f32 v[40:41], v[40:41], v[40:41]
  v_pk_mul_f32 v[42:43], v[42:43], v[42:43]
  v_pk_mul_f32 v[68:69], v[68:69], v[68:69]
  v_pk_mul_f32 v[70:71], v[70:71], v[70:71]
  v_cvt_pk_bf16_f32 v40, v40, v41
  v_cvt_pk_bf16_f32 v41, v42, v43
  v_mfma_f32_16x16x32_bf16 v[72:75], v[116:119], a[248:251], v[72:75]
  s_add_u32 s54, s52, 15360
  buffer_load_dwordx4 a[124:127], v1, s[16:19], s54 offen offset:0
  v_cvt_pk_bf16_f32 v68, v68, v69
  v_cvt_pk_bf16_f32 v69, v70, v71
  s_waitcnt lgkmcnt(3)
  v_mfma_f32_16x16x32_bf16 v[48:51], v[88:91], a[220:223], v[48:51]
  ds_read_b128 v[104:107], v12 offset:54272
  v_pk_fma_f32 v[44:45], v[44:45], v[16:17], v[176:177]
  v_pk_fma_f32 v[46:47], v[46:47], v[16:17], v[178:179]
  v_pk_fma_f32 v[72:73], v[72:73], v[24:25], v[204:205]
  v_pk_fma_f32 v[74:75], v[74:75], v[24:25], v[206:207]
  v_cvt_pk_bf16_f32 v20, v44, v45
  v_cvt_pk_bf16_f32 v21, v46, v47
  v_mfma_f32_16x16x32_bf16 v[76:79], v[88:91], a[224:227], v[76:79]
  buffer_load_dwordx4 a[128:131], v1, s[16:19], s54 offen offset:1024
  v_cvt_pk_bf16_f32 v22, v72, v73
  v_cvt_pk_bf16_f32 v23, v74, v75
  v_lshlrev_b32 v44, 16, v20
  v_lshlrev_b32 v46, 16, v21
  v_lshlrev_b32 v72, 16, v22
  v_lshlrev_b32 v74, 16, v23
  s_waitcnt lgkmcnt(3)
  v_mfma_f32_16x16x32_bf16 v[48:51], v[92:95], a[228:231], v[48:51]
  ds_read_b128 v[108:111], v12 offset:61440
  v_and_b32 v45, s30, v20
  v_and_b32 v47, s30, v21
  v_and_b32 v73, s30, v22
  v_and_b32 v75, s30, v23
  v_pk_add_f32 v[44:45], v[44:45], v[232:233]
  v_pk_add_f32 v[46:47], v[46:47], v[234:235]
  v_mfma_f32_16x16x32_bf16 v[76:79], v[92:95], a[232:235], v[76:79]
  buffer_load_dwordx4 a[132:135], v1, s[16:19], s54 offen offset:2048
  v_pk_add_f32 v[72:73], v[72:73], v[232:233]
  v_pk_add_f32 v[74:75], v[74:75], v[234:235]
  v_cvt_pk_bf16_f32 v20, v44, v45
  v_cvt_pk_bf16_f32 v21, v46, v47
  v_cvt_pk_bf16_f32 v22, v72, v73
  v_cvt_pk_bf16_f32 v23, v74, v75
  s_waitcnt lgkmcnt(3)
  v_mfma_f32_16x16x32_bf16 v[48:51], v[96:99], a[236:239], v[48:51]
  ds_read_b128 v[112:115], v13 offset:3072
  v_pk_max_i16 v20, v20, 0
  v_pk_max_i16 v21, v21, 0
  v_pk_max_i16 v22, v22, 0
  v_pk_max_i16 v23, v23, 0
  v_lshlrev_b32 v44, 16, v20
  v_lshlrev_b32 v46, 16, v21
  v_mfma_f32_16x16x32_bf16 v[76:79], v[96:99], a[240:243], v[76:79]
  buffer_load_dwordx4 a[136:139], v1, s[16:19], s54 offen offset:3072
  v_lshlrev_b32 v72, 16, v22
  v_lshlrev_b32 v74, 16, v23
  v_and_b32 v45, s30, v20
  v_and_b32 v47, s30, v21
  v_and_b32 v73, s30, v22
  v_and_b32 v75, s30, v23
  s_waitcnt lgkmcnt(3)
  v_mfma_f32_16x16x32_bf16 v[48:51], v[100:103], a[244:247], v[48:51]
  ds_read_b128 v[116:119], v13 offset:10240
  v_pk_mul_f32 v[44:45], v[44:45], v[44:45]
  v_pk_mul_f32 v[46:47], v[46:47], v[46:47]
  v_pk_mul_f32 v[72:73], v[72:73], v[72:73]
  v_pk_mul_f32 v[74:75], v[74:75], v[74:75]
  v_cvt_pk_bf16_f32 v42, v44, v45
  v_cvt_pk_bf16_f32 v43, v46, v47
  v_mfma_f32_16x16x32_bf16 v[76:79], v[100:103], a[248:251], v[76:79]
  s_add_u32 s54, s52, 19456
  buffer_load_dwordx4 a[140:143], v1, s[16:19], s54 offen offset:0
  v_cvt_pk_bf16_f32 v70, v72, v73
  v_cvt_pk_bf16_f32 v71, v74, v75
  buffer_store_dwordx4 v[40:43], v2, s[16:19], s32 offen offset:2048 sc1
  buffer_store_dwordx4 v[68:71], v2, s[16:19], s32 offen offset:2304 sc1
  s_waitcnt lgkmcnt(3)
  v_mfma_f32_16x16x32_bf16 v[52:55], v[104:107], a[220:223], v[52:55]
  ds_read_b128 v[88:91], v12 offset:55296
  v_pk_fma_f32 v[48:49], v[48:49], v[16:17], v[180:181]
  v_pk_fma_f32 v[50:51], v[50:51], v[16:17], v[182:183]
  v_pk_fma_f32 v[76:77], v[76:77], v[24:25], v[208:209]
  v_pk_fma_f32 v[78:79], v[78:79], v[24:25], v[210:211]
  v_cvt_pk_bf16_f32 v20, v48, v49
  v_cvt_pk_bf16_f32 v21, v50, v51
  v_mfma_f32_16x16x32_bf16 v[80:83], v[104:107], a[224:227], v[80:83]
  v_cvt_pk_bf16_f32 v22, v76, v77
  v_cvt_pk_bf16_f32 v23, v78, v79
  v_lshlrev_b32 v48, 16, v20
  v_lshlrev_b32 v50, 16, v21
  v_lshlrev_b32 v76, 16, v22
  v_lshlrev_b32 v78, 16, v23
  s_waitcnt lgkmcnt(3)
  v_mfma_f32_16x16x32_bf16 v[52:55], v[108:111], a[228:231], v[52:55]
  ds_read_b128 v[92:95], v12 offset:62464
  v_and_b32 v49, s30, v20
  v_and_b32 v51, s30, v21
  v_and_b32 v77, s30, v22
  v_and_b32 v79, s30, v23
  v_pk_add_f32 v[48:49], v[48:49], v[236:237]
  v_pk_add_f32 v[50:51], v[50:51], v[238:239]
  v_mfma_f32_16x16x32_bf16 v[80:83], v[108:111], a[232:235], v[80:83]
  v_pk_add_f32 v[76:77], v[76:77], v[236:237]
  v_pk_add_f32 v[78:79], v[78:79], v[238:239]
  v_cvt_pk_bf16_f32 v20, v48, v49
  v_cvt_pk_bf16_f32 v21, v50, v51
  v_cvt_pk_bf16_f32 v22, v76, v77
  v_cvt_pk_bf16_f32 v23, v78, v79
  s_waitcnt lgkmcnt(3)
  v_mfma_f32_16x16x32_bf16 v[52:55], v[112:115], a[236:239], v[52:55]
  ds_read_b128 v[96:99], v13 offset:4096
  v_pk_max_i16 v20, v20, 0
  v_pk_max_i16 v21, v21, 0
  v_pk_max_i16 v22, v22, 0
  v_pk_max_i16 v23, v23, 0
  v_lshlrev_b32 v48, 16, v20
  v_lshlrev_b32 v50, 16, v21
  v_mfma_f32_16x16x32_bf16 v[80:83], v[112:115], a[240:243], v[80:83]
  v_lshlrev_b32 v76, 16, v22
  v_lshlrev_b32 v78, 16, v23
  v_and_b32 v49, s30, v20
  v_and_b32 v51, s30, v21
  v_and_b32 v77, s30, v22
  v_and_b32 v79, s30, v23
  s_waitcnt lgkmcnt(3)
  v_mfma_f32_16x16x32_bf16 v[52:55], v[116:119], a[244:247], v[52:55]
  ds_read_b128 v[100:103], v13 offset:11264
  v_pk_mul_f32 v[48:49], v[48:49], v[48:49]
  v_pk_mul_f32 v[50:51], v[50:51], v[50:51]
  v_pk_mul_f32 v[76:77], v[76:77], v[76:77]
  v_pk_mul_f32 v[78:79], v[78:79], v[78:79]
  v_cvt_pk_bf16_f32 v48, v48, v49
  v_cvt_pk_bf16_f32 v49, v50, v51
  v_mfma_f32_16x16x32_bf16 v[80:83], v[116:119], a[248:251], v[80:83]
  v_cvt_pk_bf16_f32 v76, v76, v77
  v_cvt_pk_bf16_f32 v77, v78, v79
  s_waitcnt lgkmcnt(3)
  v_mfma_f32_16x16x32_bf16 v[56:59], v[88:91], a[220:223], v[56:59]
  v_pk_fma_f32 v[52:53], v[52:53], v[16:17], v[184:185]
  v_pk_fma_f32 v[54:55], v[54:55], v[16:17], v[186:187]
  s_nop 1
  v_pk_fma_f32 v[80:81], v[80:81], v[24:25], v[212:213]
  v_pk_fma_f32 v[82:83], v[82:83], v[24:25], v[214:215]
  v_cvt_pk_bf16_f32 v20, v52, v53
  v_cvt_pk_bf16_f32 v21, v54, v55
  v_mfma_f32_16x16x32_bf16 v[84:87], v[88:91], a[224:227], v[84:87]
  v_cvt_pk_bf16_f32 v22, v80, v81
  v_cvt_pk_bf16_f32 v23, v82, v83
  v_lshlrev_b32 v52, 16, v20
  v_lshlrev_b32 v54, 16, v21
  v_lshlrev_b32 v80, 16, v22
  v_lshlrev_b32 v82, 16, v23
  s_waitcnt lgkmcnt(2)
  v_mfma_f32_16x16x32_bf16 v[56:59], v[92:95], a[228:231], v[56:59]
  v_and_b32 v53, s30, v20
  v_and_b32 v55, s30, v21
  v_and_b32 v81, s30, v22
  v_and_b32 v83, s30, v23
  v_pk_add_f32 v[52:53], v[52:53], v[240:241]
  v_pk_add_f32 v[54:55], v[54:55], v[242:243]
  v_mfma_f32_16x16x32_bf16 v[84:87], v[92:95], a[232:235], v[84:87]
  v_pk_add_f32 v[80:81], v[80:81], v[240:241]
  v_pk_add_f32 v[82:83], v[82:83], v[242:243]
  v_cvt_pk_bf16_f32 v20, v52, v53
  v_cvt_pk_bf16_f32 v21, v54, v55
  v_cvt_pk_bf16_f32 v22, v80, v81
  v_cvt_pk_bf16_f32 v23, v82, v83
  s_waitcnt lgkmcnt(1)
  v_mfma_f32_16x16x32_bf16 v[56:59], v[96:99], a[236:239], v[56:59]
  v_pk_max_i16 v20, v20, 0
  v_pk_max_i16 v21, v21, 0
  v_pk_max_i16 v22, v22, 0
  v_pk_max_i16 v23, v23, 0
  v_lshlrev_b32 v52, 16, v20
  v_lshlrev_b32 v54, 16, v21
  v_mfma_f32_16x16x32_bf16 v[84:87], v[96:99], a[240:243], v[84:87]
  v_lshlrev_b32 v80, 16, v22
  v_lshlrev_b32 v82, 16, v23
  v_and_b32 v53, s30, v20
  v_and_b32 v55, s30, v21
  v_and_b32 v81, s30, v22
  v_and_b32 v83, s30, v23
  s_waitcnt lgkmcnt(0)
  v_mfma_f32_16x16x32_bf16 v[56:59], v[100:103], a[244:247], v[56:59]
  v_pk_mul_f32 v[52:53], v[52:53], v[52:53]
  v_pk_mul_f32 v[54:55], v[54:55], v[54:55]
  v_pk_mul_f32 v[80:81], v[80:81], v[80:81]
  v_pk_mul_f32 v[82:83], v[82:83], v[82:83]
  v_cvt_pk_bf16_f32 v50, v52, v53
  v_cvt_pk_bf16_f32 v51, v54, v55
  v_mfma_f32_16x16x32_bf16 v[84:87], v[100:103], a[248:251], v[84:87]
  v_cvt_pk_bf16_f32 v78, v80, v81
  v_cvt_pk_bf16_f32 v79, v82, v83
  buffer_store_dwordx4 v[48:51], v2, s[16:19], s33 offen offset:0 sc1
  buffer_store_dwordx4 v[76:79], v2, s[16:19], s33 offen offset:256 sc1
  v_pk_fma_f32 v[56:57], v[56:57], v[16:17], v[188:189]
  v_pk_fma_f32 v[58:59], v[58:59], v[16:17], v[190:191]
  s_nop 1
  v_pk_fma_f32 v[84:85], v[84:85], v[24:25], v[216:217]
  v_pk_fma_f32 v[86:87], v[86:87], v[24:25], v[218:219]
  v_cvt_pk_bf16_f32 v20, v56, v57
  v_cvt_pk_bf16_f32 v21, v58, v59
  v_cvt_pk_bf16_f32 v22, v84, v85
  v_cvt_pk_bf16_f32 v23, v86, v87
  v_lshlrev_b32 v56, 16, v20
  v_lshlrev_b32 v58, 16, v21
  v_lshlrev_b32 v84, 16, v22
  v_lshlrev_b32 v86, 16, v23
  v_and_b32 v57, s30, v20
  v_and_b32 v59, s30, v21
  v_and_b32 v85, s30, v22
  v_and_b32 v87, s30, v23
  v_pk_add_f32 v[56:57], v[56:57], v[244:245]
  v_pk_add_f32 v[58:59], v[58:59], v[246:247]
  v_pk_add_f32 v[84:85], v[84:85], v[244:245]
  v_pk_add_f32 v[86:87], v[86:87], v[246:247]
  v_cvt_pk_bf16_f32 v20, v56, v57
  v_cvt_pk_bf16_f32 v21, v58, v59
  v_cvt_pk_bf16_f32 v22, v84, v85
  v_cvt_pk_bf16_f32 v23, v86, v87
  v_pk_max_i16 v20, v20, 0
  v_pk_max_i16 v21, v21, 0
  v_pk_max_i16 v22, v22, 0
  v_pk_max_i16 v23, v23, 0
  v_lshlrev_b32 v56, 16, v20
  v_lshlrev_b32 v58, 16, v21
  v_lshlrev_b32 v84, 16, v22
  v_lshlrev_b32 v86, 16, v23
  v_and_b32 v57, s30, v20
  v_and_b32 v59, s30, v21
  v_and_b32 v85, s30, v22
  v_and_b32 v87, s30, v23
  v_pk_mul_f32 v[56:57], v[56:57], v[56:57]
  v_pk_mul_f32 v[58:59], v[58:59], v[58:59]
  v_pk_mul_f32 v[84:85], v[84:85], v[84:85]
  v_pk_mul_f32 v[86:87], v[86:87], v[86:87]
  v_cvt_pk_bf16_f32 v56, v56, v57
  v_cvt_pk_bf16_f32 v57, v58, v59
  v_cvt_pk_bf16_f32 v84, v84, v85
  v_cvt_pk_bf16_f32 v85, v86, v87
  buffer_store_dwordx2 v[56:57], v28, s[16:19], s34 offen offset:0 sc1
  buffer_store_dwordx2 v[84:85], v28, s[16:19], s34 offen offset:256 sc1
  s_waitcnt vmcnt(0)
  s_barrier
  v_mov_b32 v244, 1
  s_mov_b32 s59, 56623104
  buffer_store_dword v244, v3, s[16:19], s59 offen sc1
  s_mov_b32 s30, 0xffff0000
  v_readfirstlane_b32 s20, v0
  s_nop 0
  s_lshr_b32 s20, s20, 6
  s_and_b32 s22, s2, 7
  s_lshl_b32 s22, s22, 2
  s_bfe_u32 s25, s2, 0x20003
  s_add_u32 s22, s22, s25
  s_lshr_b32 s21, s2, 5
  s_mul_i32 s25, s20, 13
  s_cmp_ge_u32 s20, 1
  s_addc_u32 s25, s25, 0
  s_mul_i32 s23, s21, 54
  s_add_u32 s23, s23, s25
  s_mul_i32 s23, s23, 5120
  s_add_u32 s23, s23, 48234496
  s_mul_i32 s24, s22, 229376
  s_lshl_b32 s26, s25, 11
  s_add_u32 s24, s24, s26
  s_add_u32 s24, s24, 33554432
  v_and_b32 v14, 63, v0
  v_lshrrev_b32 v15, 4, v14
  v_and_b32 v16, 15, v0
  v_lshlrev_b32 v5, 4, v14
  v_add_u32 v6, 4096, v5
  v_lshlrev_b32 v17, 9, v15
  v_lshl_add_u32 v17, v16, 4, v17
  s_add_u32 s26, s20, 0
  s_and_b32 s26, s26, 3
  s_lshr_b32 s27, s26, 1
  s_mul_i32 s27, s27, 114688
  s_and_b32 s28, s26, 1
  s_lshl_b32 s28, s28, 8
  s_add_u32 s27, s27, s28
  v_add_u32 v1, s27, v17
  s_add_u32 s26, s20, 1
  s_and_b32 s26, s26, 3
  s_lshr_b32 s27, s26, 1
  s_mul_i32 s27, s27, 114688
  s_and_b32 s28, s26, 1
  s_lshl_b32 s28, s28, 8
  s_add_u32 s27, s27, s28
  v_add_u32 v2, s27, v17
  s_mul_i32 s26, s26, 15360
  s_add_u32 s26, s26, 102400
  v_add_u32 v7, s26, v5
  s_add_u32 s26, s20, 2
  s_and_b32 s26, s26, 3
  s_lshr_b32 s27, s26, 1
  s_mul_i32 s27, s27, 114688
  s_and_b32 s28, s26, 1
  s_lshl_b32 s28, s28, 8
  s_add_u32 s27, s27, s28
  v_add_u32 v3, s27, v17
  s_mul_i32 s26, s26, 15360
  s_add_u32 s26, s26, 107520
  v_add_u32 v8, s26, v5
  s_add_u32 s26, s20, 3
  s_and_b32 s26, s26, 3
  s_lshr_b32 s27, s26, 1
  s_mul_i32 s27, s27, 114688
  s_and_b32 s28, s26, 1
  s_lshl_b32 s28, s28, 8
  s_add_u32 s27, s27, s28
  v_add_u32 v4, s27, v17
  s_mul_i32 s26, s26, 15360
  s_add_u32 s26, s26, 112640
  v_add_u32 v9, s26, v5
  s_cmp_ge_u32 s20, 2
  s_cselect_b32 s26, 0x40000000, 0
  v_add_u32 v13, s26, v5
  v_add_u32 v12, s26, v6
  s_mov_b32 s57, 0xf800
  s_cmp_eq_u32 s20, 2
  s_cselect_b32 s57, 3968, s57
  s_cmp_eq_u32 s20, 1
  s_cselect_b32 s57, 240, s57
  s_cmp_eq_u32 s20, 0
  s_cselect_b32 s57, 15, s57
  s_lshl_b32 s58, s22, 3
  s_add_u32 s58, s58, s21
  s_lshl_b32 s58, s58, 8
  s_add_u32 s58, s58, 56623232
  v_and_b32 v242, 31, v0
  v_lshlrev_b32 v242, 2, v242
  s_mov_b32 s60, 200000
  s_mul_i32 s26, s20, 25600
  v_add_u32 v34, s26, v5
  s_add_u32 s27, s23, 30720
  s_add_u32 m0, s26, 0
  s_nop 0
  buffer_load_dwordx4 v5, s[16:19], s27 offen offset:0 lds
  buffer_load_dwordx4 v5, s[16:19], s27 offen offset:1024 lds
  buffer_load_dwordx4 v5, s[16:19], s27 offen offset:2048 lds
  buffer_load_dwordx4 v5, s[16:19], s27 offen offset:3072 lds
  s_add_u32 s27, s23, 34816
  s_add_u32 m0, s26, 4096
  s_nop 0
  buffer_load_dwordx4 v5, s[16:19], s27 offen offset:0 lds
  s_add_u32 s27, s23, 35840
  s_add_u32 m0, s26, 5120
  s_nop 0
  buffer_load_dwordx4 v5, s[16:19], s27 offen offset:0 lds
  buffer_load_dwordx4 v5, s[16:19], s27 offen offset:1024 lds
  buffer_load_dwordx4 v5, s[16:19], s27 offen offset:2048 lds
  buffer_load_dwordx4 v5, s[16:19], s27 offen offset:3072 lds
  s_add_u32 s27, s23, 39936
  s_add_u32 m0, s26, 9216
  s_nop 0
  buffer_load_dwordx4 v5, s[16:19], s27 offen offset:0 lds
  s_add_u32 s27, s23, 40960
  s_add_u32 m0, s26, 10240
  s_nop 0
  buffer_load_dwordx4 v5, s[16:19], s27 offen offset:0 lds
  buffer_load_dwordx4 v5, s[16:19], s27 offen offset:1024 lds
  buffer_load_dwordx4 v5, s[16:19], s27 offen offset:2048 lds
  buffer_load_dwordx4 v5, s[16:19], s27 offen offset:3072 lds
  s_add_u32 s27, s23, 45056
  s_add_u32 m0, s26, 14336
  s_nop 0
  buffer_load_dwordx4 v5, s[16:19], s27 offen offset:0 lds
  s_add_u32 s27, s23, 46080
  s_add_u32 m0, s26, 15360
  s_nop 0
  buffer_load_dwordx4 v5, s[16:19], s27 offen offset:0 lds
  buffer_load_dwordx4 v5, s[16:19], s27 offen offset:1024 lds
  buffer_load_dwordx4 v5, s[16:19], s27 offen offset:2048 lds
  buffer_load_dwordx4 v5, s[16:19], s27 offen offset:3072 lds
  s_add_u32 s27, s23, 50176
  s_add_u32 m0, s26, 19456
  s_nop 0
  buffer_load_dwordx4 v5, s[16:19], s27 offen offset:0 lds
  s_add_u32 s27, s23, 51200
  s_add_u32 m0, s26, 20480
  s_nop 0
  buffer_load_dwordx4 v5, s[16:19], s27 offen offset:0 lds
  buffer_load_dwordx4 v5, s[16:19], s27 offen offset:1024 lds
  buffer_load_dwordx4 v5, s[16:19], s27 offen offset:2048 lds
  buffer_load_dwordx4 v5, s[16:19], s27 offen offset:3072 lds
  s_add_u32 s27, s23, 55296
  s_add_u32 m0, s26, 24576
  s_nop 0
  buffer_load_dwordx4 v5, s[16:19], s27 offen offset:0 lds
KF_PB_L:
  buffer_load_dword v243, v242, s[16:19], s58 offen sc1
  s_waitcnt vmcnt(0)
  v_cmp_ne_u32 vcc, 0, v243
  s_nop 0
  s_mov_b32 s61, vcc_lo
  s_and_b32 s59, s61, s57
  s_cmp_eq_u32 s59, s57
  s_cbranch_scc1 KF_PB_A
  s_sub_u32 s60, s60, 1
  s_cbranch_scc1 KF_PB_A
  s_sleep 1
  s_branch KF_PB_L
KF_PB_A:
  s_add_u32 s32, s23, 0
  s_add_u32 s33, s24, 0
  buffer_load_dwordx4 a[0:3], v1, s[16:19], s33 offen
  buffer_load_dwordx4 a[4:7], v2, s[16:19], s33 offen
  buffer_load_dwordx4 a[8:11], v3, s[16:19], s33 offen
  buffer_load_dwordx4 a[12:15], v4, s[16:19], s33 offen
  s_add_u32 s34, s23, 5120
  s_add_u32 s35, s24, 2048
  buffer_load_dwordx4 a[36:39], v1, s[16:19], s35 offen
  buffer_load_dwordx4 a[40:43], v2, s[16:19], s35 offen
  buffer_load_dwordx4 a[44:47], v3, s[16:19], s35 offen
  buffer_load_dwordx4 a[48:51], v4, s[16:19], s35 offen
  s_add_u32 s32, s23, 10240
  s_add_u32 s33, s24, 4096
  buffer_load_dwordx4 a[72:75], v1, s[16:19], s33 offen
  buffer_load_dwordx4 a[76:79], v2, s[16:19], s33 offen
  buffer_load_dwordx4 a[80:83], v3, s[16:19], s33 offen
  buffer_load_dwordx4 a[84:87], v4, s[16:19], s33 offen
  s_add_u32 s34, s23, 15360
  s_add_u32 s35, s24, 6144
  buffer_load_dwordx4 a[108:111], v1, s[16:19], s35 offen
  buffer_load_dwordx4 a[112:115], v2, s[16:19], s35 offen
  buffer_load_dwordx4 a[116:119], v3, s[16:19], s35 offen
  buffer_load_dwordx4 a[120:123], v4, s[16:19], s35 offen
  s_add_u32 s32, s23, 20480
  s_add_u32 s33, s24, 8192
  buffer_load_dwordx4 a[144:147], v1, s[16:19], s33 offen
  buffer_load_dwordx4 a[148:151], v2, s[16:19], s33 offen
  buffer_load_dwordx4 a[152:155], v3, s[16:19], s33 offen
  buffer_load_dwordx4 a[156:159], v4, s[16:19], s33 offen
  s_add_u32 s34, s23, 25600
  s_add_u32 s35, s24, 10240
  buffer_load_dwordx4 a[180:183], v1, s[16:19], s35 offen
  buffer_load_dwordx4 a[184:187], v2, s[16:19], s35 offen
  buffer_load_dwordx4 a[188:191], v3, s[16:19], s35 offen
  buffer_load_dwordx4 a[192:195], v4, s[16:19], s35 offen
  s_mul_i32 s26, s20, 15360
  s_add_u32 s26, s26, 102400
  v_add_u32 v10, s26, v5
  s_lshl_b32 s26, s22, 6
  s_lshl_b32 s27, s20, 4
  s_add_u32 s26, s26, s27
  s_mul_i32 s27, s21, 160
  s_mul_i32 s36, s26, 1280
  s_add_u32 s36, s36, s27
  s_lshr_b32 s28, s26, 5
  s_mul_i32 s28, s28, 40960
  s_mul_i32 s29, s21, 5120
  s_add_u32 s28, s28, s29
  s_and_b32 s29, s26, 16
  s_lshl_b32 s29, s29, 4
  s_add_u32 s28, s28, s29
  s_add_u32 s37, s28, 7340032
  s_add_u32 s38, s28, 10485760
  s_mul_i32 s39, s21, 320
  v_mul_u32_u24 v18, 1280, v16
  v_lshl_add_u32 v17, v15, 4, v18
  v_lshl_add_u32 v18, v15, 3, v18
  v_lshlrev_b32 v19, 9, v15
  v_lshl_add_u32 v19, v16, 4, v19
  v_lshrrev_b32 v20, 1, v15
  v_lshlrev_b32 v20, 9, v20
  v_lshl_add_u32 v20, v16, 4, v20
  v_and_b32 v23, 1, v15
  v_lshl_add_u32 v20, v23, 3, v20
  v_add_u32 v20, 4096, v20
  v_lshlrev_b32 v21, 5, v15
  v_lshlrev_b32 v22, 4, v15
  s_waitcnt vmcnt(23)
  v_mfma_f32_16x16x32_bf16 v[80:83], a[16:19], a[0:3], 0
  s_waitcnt vmcnt(22)
  v_mfma_f32_16x16x32_bf16 v[100:103], a[16:19], a[4:7], 0
  s_add_u32 s32, s23, 30720
  s_add_u32 s33, s24, 12288
  ds_read_b128 a[232:235], v34 offset:0
  s_waitcnt vmcnt(21)
  v_mfma_f32_16x16x32_bf16 v[120:123], a[16:19], a[8:11], 0
  s_waitcnt vmcnt(20)
  v_mfma_f32_16x16x32_bf16 v[140:143], a[16:19], a[12:15], 0
  buffer_load_dwordx4 a[216:219], v1, s[16:19], s33 offen
  v_mfma_f32_16x16x32_bf16 v[84:87], a[20:23], a[0:3], 0
  v_mfma_f32_16x16x32_bf16 v[104:107], a[20:23], a[4:7], 0
  ds_read_b128 a[236:239], v34 offset:1024
  v_mfma_f32_16x16x32_bf16 v[124:127], a[20:23], a[8:11], 0
  v_mfma_f32_16x16x32_bf16 v[144:147], a[20:23], a[12:15], 0
  buffer_load_dwordx4 a[220:223], v2, s[16:19], s33 offen
  v_mfma_f32_16x16x32_bf16 v[88:91], a[24:27], a[0:3], 0
  v_mfma_f32_16x16x32_bf16 v[108:111], a[24:27], a[4:7], 0
  ds_read_b128 a[240:243], v34 offset:2048
  v_mfma_f32_16x16x32_bf16 v[128:131], a[24:27], a[8:11], 0
  v_mfma_f32_16x16x32_bf16 v[148:151], a[24:27], a[12:15], 0
  buffer_load_dwordx4 a[224:227], v3, s[16:19], s33 offen
  v_mfma_f32_16x16x32_bf16 v[92:95], a[28:31], a[0:3], 0
  v_mfma_f32_16x16x32_bf16 v[112:115], a[28:31], a[4:7], 0
  ds_read_b128 a[244:247], v34 offset:3072
  v_mfma_f32_16x16x32_bf16 v[132:135], a[28:31], a[8:11], 0
  v_mfma_f32_16x16x32_bf16 v[152:155], a[28:31], a[12:15], 0
  buffer_load_dwordx4 a[228:231], v4, s[16:19], s33 offen
  v_mfma_f32_16x16x32_bf16 v[96:99], a[32:35], a[0:3], 0
  v_mfma_f32_16x16x32_bf16 v[116:119], a[32:35], a[4:7], 0
  ds_read_b128 a[248:251], v34 offset:4096
  v_mfma_f32_16x16x32_bf16 v[136:139], a[32:35], a[8:11], 0
  v_mfma_f32_16x16x32_bf16 v[156:159], a[32:35], a[12:15], 0
  s_waitcnt vmcnt(23)
  v_mfma_f32_16x16x32_bf16 v[80:83], a[52:55], a[36:39], v[80:83]
  s_waitcnt vmcnt(22)
  v_mfma_f32_16x16x32_bf16 v[100:103], a[52:55], a[40:43], v[100:103]
  s_add_u32 s34, s23, 35840
  s_add_u32 s35, s24, 14336
  ds_read_b128 a[16:19], v34 offset:5120
  s_waitcnt vmcnt(21)
  v_mfma_f32_16x16x32_bf16 v[120:123], a[52:55], a[44:47], v[120:123]
  s_waitcnt vmcnt(20)
  v_mfma_f32_16x16x32_bf16 v[140:143], a[52:55], a[48:51], v[140:143]
  buffer_load_dwordx4 a[0:3], v1, s[16:19], s35 offen
  v_mfma_f32_16x16x32_bf16 v[84:87], a[56:59], a[36:39], v[84:87]
  v_mfma_f32_16x16x32_bf16 v[104:107], a[56:59], a[40:43], v[104:107]
  ds_read_b128 a[20:23], v34 offset:6144
  v_mfma_f32_16x16x32_bf16 v[124:127], a[56:59], a[44:47], v[124:127]
  v_mfma_f32_16x16x32_bf16 v[144:147], a[56:59], a[48:51], v[144:147]
  buffer_load_dwordx4 a[4:7], v2, s[16:19], s35 offen
  v_mfma_f32_16x16x32_bf16 v[88:91], a[60:63], a[36:39], v[88:91]
  v_mfma_f32_16x16x32_bf16 v[108:111], a[60:63], a[40:43], v[108:111]
  ds_read_b128 a[24:27], v34 offset:7168
  v_mfma_f32_16x16x32_bf16 v[128:131], a[60:63], a[44:47], v[128:131]
  v_mfma_f32_16x16x32_bf16 v[148:151], a[60:63], a[48:51], v[148:151]
  buffer_load_dwordx4 a[8:11], v3, s[16:19], s35 offen
  v_mfma_f32_16x16x32_bf16 v[92:95], a[64:67], a[36:39], v[92:95]
  v_mfma_f32_16x16x32_bf16 v[112:115], a[64:67], a[40:43], v[112:115]
  ds_read_b128 a[28:31], v34 offset:8192
  v_mfma_f32_16x16x32_bf16 v[132:135], a[64:67], a[44:47], v[132:135]
  v_mfma_f32_16x16x32_bf16 v[152:155], a[64:67], a[48:51], v[152:155]
  buffer_load_dwordx4 a[12:15], v4, s[16:19], s35 offen
  v_mfma_f32_16x16x32_bf16 v[96:99], a[68:71], a[36:39], v[96:99]
  v_mfma_f32_16x16x32_bf16 v[116:119], a[68:71], a[40:43], v[116:119]
  ds_read_b128 a[32:35], v34 offset:9216
  v_mfma_f32_16x16x32_bf16 v[136:139], a[68:71], a[44:47], v[136:139]
  v_mfma_f32_16x16x32_bf16 v[156:159], a[68:71], a[48:51], v[156:159]
  s_waitcnt vmcnt(23)
  v_mfma_f32_16x16x32_bf16 v[80:83], a[88:91], a[72:75], v[80:83]
  s_waitcnt vmcnt(22)
  v_mfma_f32_16x16x32_bf16 v[100:103], a[88:91], a[76:79], v[100:103]
  s_add_u32 s32, s23, 40960
  s_add_u32 s33, s24, 16384
  ds_read_b128 a[52:55], v34 offset:10240
  s_waitcnt vmcnt(21)
  v_mfma_f32_16x16x32_bf16 v[120:123], a[88:91], a[80:83], v[120:123]
  s_waitcnt vmcnt(20)
  v_mfma_f32_16x16x32_bf16 v[140:143], a[88:91], a[84:87], v[140:143]
  buffer_load_dwordx4 a[36:39], v1, s[16:19], s33 offen
  v_mfma_f32_16x16x32_bf16 v[84:87], a[92:95], a[72:75], v[84:87]
  v_mfma_f32_16x16x32_bf16 v[104:107], a[92:95], a[76:79], v[104:107]
  ds_read_b128 a[56:59], v34 offset:11264
  v_mfma_f32_16x16x32_bf16 v[124:127], a[92:95], a[80:83], v[124:127]
  v_mfma_f32_16x16x32_bf16 v[144:147], a[92:95], a[84:87], v[144:147]
  buffer_load_dwordx4 a[40:43], v2, s[16:19], s33 offen
  v_mfma_f32_16x16x32_bf16 v[88:91], a[96:99], a[72:75], v[88:91]
  v_mfma_f32_16x16x32_bf16 v[108:111], a[96:99], a[76:79], v[108:111]
  ds_read_b128 a[60:63], v34 offset:12288
  v_mfma_f32_16x16x32_bf16 v[128:131], a[96:99], a[80:83], v[128:131]
  v_mfma_f32_16x16x32_bf16 v[148:151], a[96:99], a[84:87], v[148:151]
  buffer_load_dwordx4 a[44:47], v3, s[16:19], s33 offen
  v_mfma_f32_16x16x32_bf16 v[92:95], a[100:103], a[72:75], v[92:95]
  v_mfma_f32_16x16x32_bf16 v[112:115], a[100:103], a[76:79], v[112:115]
  ds_read_b128 a[64:67], v34 offset:13312
  v_mfma_f32_16x16x32_bf16 v[132:135], a[100:103], a[80:83], v[132:135]
  v_mfma_f32_16x16x32_bf16 v[152:155], a[100:103], a[84:87], v[152:155]
  buffer_load_dwordx4 a[48:51], v4, s[16:19], s33 offen
  v_mfma_f32_16x16x32_bf16 v[96:99], a[104:107], a[72:75], v[96:99]
  v_mfma_f32_16x16x32_bf16 v[116:119], a[104:107], a[76:79], v[116:119]
  ds_read_b128 a[68:71], v34 offset:14336
  v_mfma_f32_16x16x32_bf16 v[136:139], a[104:107], a[80:83], v[136:139]
  v_mfma_f32_16x16x32_bf16 v[156:159], a[104:107], a[84:87], v[156:159]
  s_waitcnt vmcnt(23)
  v_mfma_f32_16x16x32_bf16 v[80:83], a[124:127], a[108:111], v[80:83]
  s_waitcnt vmcnt(22)
  v_mfma_f32_16x16x32_bf16 v[100:103], a[124:127], a[112:115], v[100:103]
  s_add_u32 s34, s23, 46080
  s_add_u32 s35, s24, 18432
  ds_read_b128 a[88:91], v34 offset:15360
  s_waitcnt vmcnt(21)
  v_mfma_f32_16x16x32_bf16 v[120:123], a[124:127], a[116:119], v[120:123]
  s_waitcnt vmcnt(20)
  v_mfma_f32_16x16x32_bf16 v[140:143], a[124:127], a[120:123], v[140:143]
  buffer_load_dwordx4 a[72:75], v1, s[16:19], s35 offen
  v_mfma_f32_16x16x32_bf16 v[84:87], a[128:131], a[108:111], v[84:87]
  v_mfma_f32_16x16x32_bf16 v[104:107], a[128:131], a[112:115], v[104:107]
  ds_read_b128 a[92:95], v34 offset:16384
  v_mfma_f32_16x16x32_bf16 v[124:127], a[128:131], a[116:119], v[124:127]
  v_mfma_f32_16x16x32_bf16 v[144:147], a[128:131], a[120:123], v[144:147]
  buffer_load_dwordx4 a[76:79], v2, s[16:19], s35 offen
  v_mfma_f32_16x16x32_bf16 v[88:91], a[132:135], a[108:111], v[88:91]
  v_mfma_f32_16x16x32_bf16 v[108:111], a[132:135], a[112:115], v[108:111]
  ds_read_b128 a[96:99], v34 offset:17408
  v_mfma_f32_16x16x32_bf16 v[128:131], a[132:135], a[116:119], v[128:131]
  v_mfma_f32_16x16x32_bf16 v[148:151], a[132:135], a[120:123], v[148:151]
  buffer_load_dwordx4 a[80:83], v3, s[16:19], s35 offen
  v_mfma_f32_16x16x32_bf16 v[92:95], a[136:139], a[108:111], v[92:95]
  v_mfma_f32_16x16x32_bf16 v[112:115], a[136:139], a[112:115], v[112:115]
  ds_read_b128 a[100:103], v34 offset:18432
  v_mfma_f32_16x16x32_bf16 v[132:135], a[136:139], a[116:119], v[132:135]
  v_mfma_f32_16x16x32_bf16 v[152:155], a[136:139], a[120:123], v[152:155]
  buffer_load_dwordx4 a[84:87], v4, s[16:19], s35 offen
  v_mfma_f32_16x16x32_bf16 v[96:99], a[140:143], a[108:111], v[96:99]
  v_mfma_f32_16x16x32_bf16 v[116:119], a[140:143], a[112:115], v[116:119]
  ds_read_b128 a[104:107], v34 offset:19456
  v_mfma_f32_16x16x32_bf16 v[136:139], a[140:143], a[116:119], v[136:139]
  v_mfma_f32_16x16x32_bf16 v[156:159], a[140:143], a[120:123], v[156:159]
  s_waitcnt vmcnt(23)
  v_mfma_f32_16x16x32_bf16 v[80:83], a[160:163], a[144:147], v[80:83]
  s_waitcnt vmcnt(22)
  v_mfma_f32_16x16x32_bf16 v[100:103], a[160:163], a[148:151], v[100:103]
  s_add_u32 s32, s23, 51200
  s_add_u32 s33, s24, 20480
  ds_read_b128 a[124:127], v34 offset:20480
  s_waitcnt vmcnt(21)
  v_mfma_f32_16x16x32_bf16 v[120:123], a[160:163], a[152:155], v[120:123]
  s_waitcnt vmcnt(20)
  v_mfma_f32_16x16x32_bf16 v[140:143], a[160:163], a[156:159], v[140:143]
  buffer_load_dwordx4 a[108:111], v1, s[16:19], s33 offen
  v_mfma_f32_16x16x32_bf16 v[84:87], a[164:167], a[144:147], v[84:87]
  v_mfma_f32_16x16x32_bf16 v[104:107], a[164:167], a[148:151], v[104:107]
  ds_read_b128 a[128:131], v34 offset:21504
  v_mfma_f32_16x16x32_bf16 v[124:127], a[164:167], a[152:155], v[124:127]
  v_mfma_f32_16x16x32_bf16 v[144:147], a[164:167], a[156:159], v[144:147]
  buffer_load_dwordx4 a[112:115], v2, s[16:19], s33 offen
  v_mfma_f32_16x16x32_bf16 v[88:91], a[168:171], a[144:147], v[88:91]
  v_mfma_f32_16x16x32_bf16 v[108:111], a[168:171], a[148:151], v[108:111]
  ds_read_b128 a[132:135], v34 offset:22528
  v_mfma_f32_16x16x32_bf16 v[128:131], a[168:171], a[152:155], v[128:131]
  v_mfma_f32_16x16x32_bf16 v[148:151], a[168:171], a[156:159], v[148:151]
  buffer_load_dwordx4 a[116:119], v3, s[16:19], s33 offen
  v_mfma_f32_16x16x32_bf16 v[92:95], a[172:175], a[144:147], v[92:95]
  v_mfma_f32_16x16x32_bf16 v[112:115], a[172:175], a[148:151], v[112:115]
  ds_read_b128 a[136:139], v34 offset:23552
  v_mfma_f32_16x16x32_bf16 v[132:135], a[172:175], a[152:155], v[132:135]
  v_mfma_f32_16x16x32_bf16 v[152:155], a[172:175], a[156:159], v[152:155]
  buffer_load_dwordx4 a[120:123], v4, s[16:19], s33 offen
  v_mfma_f32_16x16x32_bf16 v[96:99], a[176:179], a[144:147], v[96:99]
  v_mfma_f32_16x16x32_bf16 v[116:119], a[176:179], a[148:151], v[116:119]
  ds_read_b128 a[140:143], v34 offset:24576
  v_mfma_f32_16x16x32_bf16 v[136:139], a[176:179], a[152:155], v[136:139]
  v_mfma_f32_16x16x32_bf16 v[156:159], a[176:179], a[156:159], v[156:159]
  s_waitcnt vmcnt(23)
  v_mfma_f32_16x16x32_bf16 v[80:83], a[196:199], a[180:183], v[80:83]
  s_waitcnt vmcnt(22)
  v_mfma_f32_16x16x32_bf16 v[100:103], a[196:199], a[184:187], v[100:103]
  s_add_u32 s34, s23, 56320
  s_add_u32 s35, s24, 22528
  buffer_load_dwordx4 a[160:163], v5, s[16:19], s34 offen offset:0
  s_waitcnt vmcnt(22)
  v_mfma_f32_16x16x32_bf16 v[120:123], a[196:199], a[188:191], v[120:123]
  s_waitcnt vmcnt(21)
  v_mfma_f32_16x16x32_bf16 v[140:143], a[196:199], a[192:195], v[140:143]
  buffer_load_dwordx4 a[144:147], v1, s[16:19], s35 offen
  v_mfma_f32_16x16x32_bf16 v[84:87], a[200:203], a[180:183], v[84:87]
  v_mfma_f32_16x16x32_bf16 v[104:107], a[200:203], a[184:187], v[104:107]
  buffer_load_dwordx4 a[164:167], v5, s[16:19], s34 offen offset:1024
  v_mfma_f32_16x16x32_bf16 v[124:127], a[200:203], a[188:191], v[124:127]
  v_mfma_f32_16x16x32_bf16 v[144:147], a[200:203], a[192:195], v[144:147]
  buffer_load_dwordx4 a[148:151], v2, s[16:19], s35 offen
  v_mfma_f32_16x16x32_bf16 v[88:91], a[204:207], a[180:183], v[88:91]
  v_mfma_f32_16x16x32_bf16 v[108:111], a[204:207], a[184:187], v[108:111]
  buffer_load_dwordx4 a[168:171], v5, s[16:19], s34 offen offset:2048
  v_mfma_f32_16x16x32_bf16 v[128:131], a[204:207], a[188:191], v[128:131]
  v_mfma_f32_16x16x32_bf16 v[148:151], a[204:207], a[192:195], v[148:151]
  buffer_load_dwordx4 a[152:155], v3, s[16:19], s35 offen
  v_mfma_f32_16x16x32_bf16 v[92:95], a[208:211], a[180:183], v[92:95]
  v_mfma_f32_16x16x32_bf16 v[112:115], a[208:211], a[184:187], v[112:115]
  buffer_load_dwordx4 a[172:175], v5, s[16:19], s34 offen offset:3072
  v_mfma_f32_16x16x32_bf16 v[132:135], a[208:211], a[188:191], v[132:135]
  v_mfma_f32_16x16x32_bf16 v[152:155], a[208:211], a[192:195], v[152:155]
  buffer_load_dwordx4 a[156:159], v4, s[16:19], s35 offen
  v_mfma_f32_16x16x32_bf16 v[96:99], a[212:215], a[180:183], v[96:99]
  v_mfma_f32_16x16x32_bf16 v[116:119], a[212:215], a[184:187], v[116:119]
  buffer_load_dwordx4 a[176:179], v6, s[16:19], s34 offen offset:0
  v_mfma_f32_16x16x32_bf16 v[136:139], a[212:215], a[188:191], v[136:139]
  v_mfma_f32_16x16x32_bf16 v[156:159], a[212:215], a[192:195], v[156:159]
  s_waitcnt vmcnt(28) lgkmcnt(15)
  v_mfma_f32_16x16x32_bf16 v[80:83], a[232:235], a[216:219], v[80:83]
  s_waitcnt vmcnt(27)
  v_mfma_f32_16x16x32_bf16 v[100:103], a[232:235], a[220:223], v[100:103]
  s_add_u32 s32, s23, 61440
  s_add_u32 s33, s24, 24576
  buffer_load_dwordx4 a[196:199], v5, s[16:19], s32 offen offset:0
  s_waitcnt vmcnt(27)
  v_mfma_f32_16x16x32_bf16 v[120:123], a[232:235], a[224:227], v[120:123]
  s_waitcnt vmcnt(26)
  v_mfma_f32_16x16x32_bf16 v[140:143], a[232:235], a[228:231], v[140:143]
  buffer_load_dwordx4 a[180:183], v1, s[16:19], s33 offen
  v_mfma_f32_16x16x32_bf16 v[84:87], a[236:239], a[216:219], v[84:87]
  v_mfma_f32_16x16x32_bf16 v[104:107], a[236:239], a[220:223], v[104:107]
  buffer_load_dwordx4 a[200:203], v5, s[16:19], s32 offen offset:1024
  v_mfma_f32_16x16x32_bf16 v[124:127], a[236:239], a[224:227], v[124:127]
  v_mfma_f32_16x16x32_bf16 v[144:147], a[236:239], a[228:231], v[144:147]
  buffer_load_dwordx4 a[184:187], v2, s[16:19], s33 offen
  v_mfma_f32_16x16x32_bf16 v[88:91], a[240:243], a[216:219], v[88:91]
  v_mfma_f32_16x16x32_bf16 v[108:111], a[240:243], a[220:223], v[108:111]
  buffer_load_dwordx4 a[204:207], v5, s[16:19], s32 offen offset:2048
  v_mfma_f32_16x16x32_bf16 v[128:131], a[240:243], a[224:227], v[128:131]
  v_mfma_f32_16x16x32_bf16 v[148:151], a[240:243], a[228:231], v[148:151]
  buffer_load_dwordx4 a[188:191], v3, s[16:19], s33 offen
  v_mfma_f32_16x16x32_bf16 v[92:95], a[244:247], a[216:219], v[92:95]
  v_mfma_f32_16x16x32_bf16 v[112:115], a[244:247], a[220:223], v[112:115]
  buffer_load_dwordx4 a[208:211], v5, s[16:19], s32 offen offset:3072
  v_mfma_f32_16x16x32_bf16 v[132:135], a[244:247], a[224:227], v[132:135]
  v_mfma_f32_16x16x32_bf16 v[152:155], a[244:247], a[228:231], v[152:155]
  buffer_load_dwordx4 a[192:195], v4, s[16:19], s33 offen
  v_mfma_f32_16x16x32_bf16 v[96:99], a[248:251], a[216:219], v[96:99]
  v_mfma_f32_16x16x32_bf16 v[116:119], a[248:251], a[220:223], v[116:119]
  buffer_load_dwordx4 a[212:215], v6, s[16:19], s32 offen offset:0
  v_mfma_f32_16x16x32_bf16 v[136:139], a[248:251], a[224:227], v[136:139]
  v_mfma_f32_16x16x32_bf16 v[156:159], a[248:251], a[228:231], v[156:159]
  s_waitcnt vmcnt(33)
  v_mfma_f32_16x16x32_bf16 v[80:83], a[16:19], a[0:3], v[80:83]
  s_waitcnt vmcnt(32)
  v_mfma_f32_16x16x32_bf16 v[100:103], a[16:19], a[4:7], v[100:103]
  s_add_u32 s34, s23, 66560
  s_add_u32 s35, s24, 26624
  buffer_load_dwordx4 a[232:235], v5, s[16:19], s34 offen offset:0
  s_waitcnt vmcnt(32)
  v_mfma_f32_16x16x32_bf16 v[120:123], a[16:19], a[8:11], v[120:123]
  s_waitcnt vmcnt(31)
  v_mfma_f32_16x16x32_bf16 v[140:143], a[16:19], a[12:15], v[140:143]
  buffer_load_dwordx4 a[216:219], v1, s[16:19], s35 offen
  v_mfma_f32_16x16x32_bf16 v[84:87], a[20:23], a[0:3], v[84:87]
  v_mfma_f32_16x16x32_bf16 v[104:107], a[20:23], a[4:7], v[104:107]
  buffer_load_dwordx4 a[236:239], v5, s[16:19], s34 offen offset:1024
  v_mfma_f32_16x16x32_bf16 v[124:127], a[20:23], a[8:11], v[124:127]
  v_mfma_f32_16x16x32_bf16 v[144:147], a[20:23], a[12:15], v[144:147]
  buffer_load_dwordx4 a[220:223], v2, s[16:19], s35 offen
  v_mfma_f32_16x16x32_bf16 v[88:91], a[24:27], a[0:3], v[88:91]
  v_mfma_f32_16x16x32_bf16 v[108:111], a[24:27], a[4:7], v[108:111]
  buffer_load_dwordx4 a[240:243], v5, s[16:19], s34 offen offset:2048
  v_mfma_f32_16x16x32_bf16 v[128:131], a[24:27], a[8:11], v[128:131]
  v_mfma_f32_16x16x32_bf16 v[148:151], a[24:27], a[12:15], v[148:151]
  buffer_load_dwordx4 a[224:227], v3, s[16:19], s35 offen
  v_mfma_f32_16x16x32_bf16 v[92:95], a[28:31], a[0:3], v[92:95]
  v_mfma_f32_16x16x32_bf16 v[112:115], a[28:31], a[4:7], v[112:115]
  buffer_load_dwordx4 a[244:247], v5, s[16:19], s34 offen offset:3072
  v_mfma_f32_16x16x32_bf16 v[132:135], a[28:31], a[8:11], v[132:135]
  v_mfma_f32_16x16x32_bf16 v[152:155], a[28:31], a[12:15], v[152:155]
  buffer_load_dwordx4 a[228:231], v4, s[16:19], s35 offen
  v_mfma_f32_16x16x32_bf16 v[96:99], a[32:35], a[0:3], v[96:99]
  v_mfma_f32_16x16x32_bf16 v[116:119], a[32:35], a[4:7], v[116:119]
  buffer_load_dwordx4 a[248:251], v6, s[16:19], s34 offen offset:0
  v_mfma_f32_16x16x32_bf16 v[136:139], a[32:35], a[8:11], v[136:139]
  v_mfma_f32_16x16x32_bf16 v[156:159], a[32:35], a[12:15], v[156:159]
  s_add_u32 s40, s39, 12800
  buffer_load_dwordx4 v[36:39], v21, s[16:19], s40 offen offset:0
  buffer_load_dwordx4 v[40:43], v21, s[16:19], s40 offen offset:16
  buffer_load_dwordx4 v[44:47], v21, s[16:19], s40 offen offset:128
  buffer_load_dwordx4 v[48:51], v21, s[16:19], s40 offen offset:144
  buffer_load_dwordx4 v[52:55], v22, s[16:19], s40 offen offset:256
  v_lshlrev_b32 v23, 3, v15
  buffer_load_dwordx4 v[56:59], v22, s[12:15], s27 offen
  buffer_load_dwordx4 v[60:63], v22, s[12:15], s27 offen offset:64
  buffer_load_dwordx2 v[64:65], v23, s[12:15], s27 offen offset:128
  s_waitcnt vmcnt(46) lgkmcnt(14)
  v_mfma_f32_16x16x32_bf16 v[80:83], a[52:55], a[36:39], v[80:83]
  s_waitcnt vmcnt(45)
  v_mfma_f32_16x16x32_bf16 v[100:103], a[52:55], a[40:43], v[100:103]
  s_waitcnt vmcnt(44)
  v_mfma_f32_16x16x32_bf16 v[120:123], a[52:55], a[44:47], v[120:123]
  s_waitcnt vmcnt(43)
  v_mfma_f32_16x16x32_bf16 v[140:143], a[52:55], a[48:51], v[140:143]
  s_waitcnt lgkmcnt(13)
  v_mfma_f32_16x16x32_bf16 v[84:87], a[56:59], a[36:39], v[84:87]
  v_mfma_f32_16x16x32_bf16 v[104:107], a[56:59], a[40:43], v[104:107]
  v_mfma_f32_16x16x32_bf16 v[124:127], a[56:59], a[44:47], v[124:127]
  v_mfma_f32_16x16x32_bf16 v[144:147], a[56:59], a[48:51], v[144:147]
  s_waitcnt lgkmcnt(12)
  v_mfma_f32_16x16x32_bf16 v[88:91], a[60:63], a[36:39], v[88:91]
  v_mfma_f32_16x16x32_bf16 v[108:111], a[60:63], a[40:43], v[108:111]
  v_mfma_f32_16x16x32_bf16 v[128:131], a[60:63], a[44:47], v[128:131]
  v_mfma_f32_16x16x32_bf16 v[148:151], a[60:63], a[48:51], v[148:151]
  s_waitcnt lgkmcnt(11)
  v_mfma_f32_16x16x32_bf16 v[92:95], a[64:67], a[36:39], v[92:95]
  v_mfma_f32_16x16x32_bf16 v[112:115], a[64:67], a[40:43], v[112:115]
  v_mfma_f32_16x16x32_bf16 v[132:135], a[64:67], a[44:47], v[132:135]
  v_mfma_f32_16x16x32_bf16 v[152:155], a[64:67], a[48:51], v[152:155]
  s_waitcnt lgkmcnt(10)
  v_mfma_f32_16x16x32_bf16 v[96:99], a[68:71], a[36:39], v[96:99]
  v_mfma_f32_16x16x32_bf16 v[116:119], a[68:71], a[40:43], v[116:119]
  v_mfma_f32_16x16x32_bf16 v[136:139], a[68:71], a[44:47], v[136:139]
  v_mfma_f32_16x16x32_bf16 v[156:159], a[68:71], a[48:51], v[156:159]
  s_waitcnt vmcnt(42) lgkmcnt(9)
  v_mfma_f32_16x16x32_bf16 v[80:83], a[88:91], a[72:75], v[80:83]
  s_waitcnt vmcnt(41)
  v_mfma_f32_16x16x32_bf16 v[100:103], a[88:91], a[76:79], v[100:103]
  s_waitcnt vmcnt(40)
  v_mfma_f32_16x16x32_bf16 v[120:123], a[88:91], a[80:83], v[120:123]
  s_waitcnt vmcnt(39)
  v_mfma_f32_16x16x32_bf16 v[140:143], a[88:91], a[84:87], v[140:143]
  s_waitcnt lgkmcnt(8)
  v_mfma_f32_16x16x32_bf16 v[84:87], a[92:95], a[72:75], v[84:87]
  v_mfma_f32_16x16x32_bf16 v[104:107], a[92:95], a[76:79], v[104:107]
  v_mfma_f32_16x16x32_bf16 v[124:127], a[92:95], a[80:83], v[124:127]
  v_mfma_f32_16x16x32_bf16 v[144:147], a[92:95], a[84:87], v[144:147]
  s_waitcnt lgkmcnt(7)
  v_mfma_f32_16x16x32_bf16 v[88:91], a[96:99], a[72:75], v[88:91]
  v_mfma_f32_16x16x32_bf16 v[108:111], a[96:99], a[76:79], v[108:111]
  v_mfma_f32_16x16x32_bf16 v[128:131], a[96:99], a[80:83], v[128:131]
  v_mfma_f32_16x16x32_bf16 v[148:151], a[96:99], a[84:87], v[148:151]
  s_waitcnt lgkmcnt(6)
  v_mfma_f32_16x16x32_bf16 v[92:95], a[100:103], a[72:75], v[92:95]
  v_mfma_f32_16x16x32_bf16 v[112:115], a[100:103], a[76:79], v[112:115]
  v_mfma_f32_16x16x32_bf16 v[132:135], a[100:103], a[80:83], v[132:135]
  v_mfma_f32_16x16x32_bf16 v[152:155], a[100:103], a[84:87], v[152:155]
  s_waitcnt lgkmcnt(5)
  v_mfma_f32_16x16x32_bf16 v[96:99], a[104:107], a[72:75], v[96:99]
  v_mfma_f32_16x16x32_bf16 v[116:119], a[104:107], a[76:79], v[116:119]
  v_mfma_f32_16x16x32_bf16 v[136:139], a[104:107], a[80:83], v[136:139]
  v_mfma_f32_16x16x32_bf16 v[156:159], a[104:107], a[84:87], v[156:159]
  s_waitcnt vmcnt(38) lgkmcnt(4)
  v_mfma_f32_16x16x32_bf16 v[80:83], a[124:127], a[108:111], v[80:83]
  s_waitcnt vmcnt(37)
  v_mfma_f32_16x16x32_bf16 v[100:103], a[124:127], a[112:115], v[100:103]
  s_waitcnt vmcnt(36)
  v_mfma_f32_16x16x32_bf16 v[120:123], a[124:127], a[116:119], v[120:123]
  s_waitcnt vmcnt(35)
  v_mfma_f32_16x16x32_bf16 v[140:143], a[124:127], a[120:123], v[140:143]
  s_waitcnt lgkmcnt(3)
  v_mfma_f32_16x16x32_bf16 v[84:87], a[128:131], a[108:111], v[84:87]
  v_mfma_f32_16x16x32_bf16 v[104:107], a[128:131], a[112:115], v[104:107]
  v_mfma_f32_16x16x32_bf16 v[124:127], a[128:131], a[116:119], v[124:127]
  v_mfma_f32_16x16x32_bf16 v[144:147], a[128:131], a[120:123], v[144:147]
  s_waitcnt lgkmcnt(2)
  v_mfma_f32_16x16x32_bf16 v[88:91], a[132:135], a[108:111], v[88:91]
  v_mfma_f32_16x16x32_bf16 v[108:111], a[132:135], a[112:115], v[108:111]
  v_mfma_f32_16x16x32_bf16 v[128:131], a[132:135], a[116:119], v[128:131]
  v_mfma_f32_16x16x32_bf16 v[148:151], a[132:135], a[120:123], v[148:151]
  s_waitcnt lgkmcnt(1)
  v_mfma_f32_16x16x32_bf16 v[92:95], a[136:139], a[108:111], v[92:95]
  v_mfma_f32_16x16x32_bf16 v[112:115], a[136:139], a[112:115], v[112:115]
  v_mfma_f32_16x16x32_bf16 v[132:135], a[136:139], a[116:119], v[132:135]
  v_mfma_f32_16x16x32_bf16 v[152:155], a[136:139], a[120:123], v[152:155]
  s_waitcnt lgkmcnt(0)
  v_mfma_f32_16x16x32_bf16 v[96:99], a[140:143], a[108:111], v[96:99]
  v_mfma_f32_16x16x32_bf16 v[116:119], a[140:143], a[112:115], v[116:119]
  v_mfma_f32_16x16x32_bf16 v[136:139], a[140:143], a[116:119], v[136:139]
  v_mfma_f32_16x16x32_bf16 v[156:159], a[140:143], a[120:123], v[156:159]
  s_waitcnt vmcnt(33)
  v_mfma_f32_16x16x32_bf16 v[80:83], a[160:163], a[144:147], v[80:83]
  s_waitcnt vmcnt(31)
  v_mfma_f32_16x16x32_bf16 v[100:103], a[160:163], a[148:151], v[100:103]
  s_waitcnt vmcnt(29)
  v_mfma_f32_16x16x32_bf16 v[120:123], a[160:163], a[152:155], v[120:123]
  s_waitcnt vmcnt(27)
  v_mfma_f32_16x16x32_bf16 v[140:143], a[160:163], a[156:159], v[140:143]
  v_mfma_f32_16x16x32_bf16 v[84:87], a[164:167], a[144:147], v[84:87]
  v_mfma_f32_16x16x32_bf16 v[104:107], a[164:167], a[148:151], v[104:107]
  v_mfma_f32_16x16x32_bf16 v[124:127], a[164:167], a[152:155], v[124:127]
  v_mfma_f32_16x16x32_bf16 v[144:147], a[164:167], a[156:159], v[144:147]
  v_mfma_f32_16x16x32_bf16 v[88:91], a[168:171], a[144:147], v[88:91]
  v_mfma_f32_16x16x32_bf16 v[108:111], a[168:171], a[148:151], v[108:111]
  v_mfma_f32_16x16x32_bf16 v[128:131], a[168:171], a[152:155], v[128:131]
  v_mfma_f32_16x16x32_bf16 v[148:151], a[168:171], a[156:159], v[148:151]
  v_mfma_f32_16x16x32_bf16 v[92:95], a[172:175], a[144:147], v[92:95]
  v_mfma_f32_16x16x32_bf16 v[112:115], a[172:175], a[148:151], v[112:115]
  v_mfma_f32_16x16x32_bf16 v[132:135], a[172:175], a[152:155], v[132:135]
  v_mfma_f32_16x16x32_bf16 v[152:155], a[172:175], a[156:159], v[152:155]
  s_waitcnt vmcnt(26)
  v_mfma_f32_16x16x32_bf16 v[96:99], a[176:179], a[144:147], v[96:99]
  v_mfma_f32_16x16x32_bf16 v[116:119], a[176:179], a[148:151], v[116:119]
  v_mfma_f32_16x16x32_bf16 v[136:139], a[176:179], a[152:155], v[136:139]
  v_mfma_f32_16x16x32_bf16 v[156:159], a[176:179], a[156:159], v[156:159]
  s_waitcnt vmcnt(24)
  v_mfma_f32_16x16x32_bf16 v[80:83], a[196:199], a[180:183], v[80:83]
  s_waitcnt vmcnt(22)
  v_mfma_f32_16x16x32_bf16 v[100:103], a[196:199], a[184:187], v[100:103]
  s_waitcnt vmcnt(20)
  v_mfma_f32_16x16x32_bf16 v[120:123], a[196:199], a[188:191], v[120:123]
  s_waitcnt vmcnt(18)
  v_mfma_f32_16x16x32_bf16 v[140:143], a[196:199], a[192:195], v[140:143]
  v_mfma_f32_16x16x32_bf16 v[84:87], a[200:203], a[180:183], v[84:87]
  v_mfma_f32_16x16x32_bf16 v[104:107], a[200:203], a[184:187], v[104:107]
  v_mfma_f32_16x16x32_bf16 v[124:127], a[200:203], a[188:191], v[124:127]
  v_mfma_f32_16x16x32_bf16 v[144:147], a[200:203], a[192:195], v[144:147]
  v_mfma_f32_16x16x32_bf16 v[88:91], a[204:207], a[180:183], v[88:91]
  v_mfma_f32_16x16x32_bf16 v[108:111], a[204:207], a[184:187], v[108:111]
  v_mfma_f32_16x16x32_bf16 v[128:131], a[204:207], a[188:191], v[128:131]
  v_mfma_f32_16x16x32_bf16 v[148:151], a[204:207], a[192:195], v[148:151]
  v_mfma_f32_16x16x32_bf16 v[92:95], a[208:211], a[180:183], v[92:95]
  v_mfma_f32_16x16x32_bf16 v[112:115], a[208:211], a[184:187], v[112:115]
  v_mfma_f32_16x16x32_bf16 v[132:135], a[208:211], a[188:191], v[132:135]
  v_mfma_f32_16x16x32_bf16 v[152:155], a[208:211], a[192:195], v[152:155]
  s_waitcnt vmcnt(17)
  v_mfma_f32_16x16x32_bf16 v[96:99], a[212:215], a[180:183], v[96:99]
  v_mfma_f32_16x16x32_bf16 v[116:119], a[212:215], a[184:187], v[116:119]
  v_mfma_f32_16x16x32_bf16 v[136:139], a[212:215], a[188:191], v[136:139]
  v_mfma_f32_16x16x32_bf16 v[156:159], a[212:215], a[192:195], v[156:159]
  s_waitcnt vmcnt(13)
  v_mfma_f32_16x16x32_bf16 v[100:103], a[232:235], a[220:223], v[100:103]
  v_mfma_f32_16x16x32_bf16 v[104:107], a[236:239], a[220:223], v[104:107]
  s_waitcnt vmcnt(12)
  v_mfma_f32_16x16x32_bf16 v[108:111], a[240:243], a[220:223], v[108:111]
  s_waitcnt vmcnt(10)
  v_mfma_f32_16x16x32_bf16 v[112:115], a[244:247], a[220:223], v[112:115]
  s_waitcnt vmcnt(8)
  v_mfma_f32_16x16x32_bf16 v[116:119], a[248:251], a[220:223], v[116:119]
  v_mfma_f32_16x16x32_bf16 v[120:123], a[232:235], a[224:227], v[120:123]
  v_mfma_f32_16x16x32_bf16 v[124:127], a[236:239], a[224:227], v[124:127]
  v_mfma_f32_16x16x32_bf16 v[128:131], a[240:243], a[224:227], v[128:131]
  ds_write_b128 v7, v[100:103] offset:0
  v_mfma_f32_16x16x32_bf16 v[132:135], a[244:247], a[224:227], v[132:135]
  ds_write_b128 v7, v[104:107] offset:1024
  v_mfma_f32_16x16x32_bf16 v[136:139], a[248:251], a[224:227], v[136:139]
  ds_write_b128 v7, v[108:111] offset:2048
  v_mfma_f32_16x16x32_bf16 v[140:143], a[232:235], a[228:231], v[140:143]
  ds_write_b128 v7, v[112:115] offset:3072
  v_mfma_f32_16x16x32_bf16 v[144:147], a[236:239], a[228:231], v[144:147]
  ds_write_b128 v7, v[116:119] offset:4096
  v_mfma_f32_16x16x32_bf16 v[148:151], a[240:243], a[228:231], v[148:151]
  ds_write_b128 v8, v[120:123] offset:0
  v_mfma_f32_16x16x32_bf16 v[152:155], a[244:247], a[228:231], v[152:155]
  ds_write_b128 v8, v[124:127] offset:1024
  v_mfma_f32_16x16x32_bf16 v[156:159], a[248:251], a[228:231], v[156:159]
  ds_write_b128 v8, v[128:131] offset:2048
  v_mfma_f32_16x16x32_bf16 v[80:83], a[232:235], a[216:219], v[80:83]
  ds_write_b128 v8, v[132:135] offset:3072
  v_mfma_f32_16x16x32_bf16 v[84:87], a[236:239], a[216:219], v[84:87]
  ds_write_b128 v8, v[136:139] offset:4096
  v_mfma_f32_16x16x32_bf16 v[88:91], a[240:243], a[216:219], v[88:91]
  ds_write_b128 v9, v[140:143] offset:0
  v_mfma_f32_16x16x32_bf16 v[92:95], a[244:247], a[216:219], v[92:95]
  ds_write_b128 v9, v[144:147] offset:1024
  v_mfma_f32_16x16x32_bf16 v[96:99], a[248:251], a[216:219], v[96:99]
  ds_write_b128 v9, v[148:151] offset:2048
  ds_write_b128 v9, v[152:155] offset:3072
  ds_write_b128 v9, v[156:159] offset:4096
  s_waitcnt lgkmcnt(0)
  s_barrier
  ds_read_b128 v[160:163], v10 offset:0
  ds_read_b128 v[164:167], v10 offset:1024
  ds_read_b128 v[168:171], v10 offset:2048
  ds_read_b128 v[172:175], v10 offset:3072
  ds_read_b128 v[176:179], v10 offset:4096
  ds_read_b128 v[180:183], v10 offset:5120
  ds_read_b128 v[184:187], v10 offset:6144
  ds_read_b128 v[188:191], v10 offset:7168
  ds_read_b128 v[192:195], v10 offset:8192
  ds_read_b128 v[196:199], v10 offset:9216
  ds_read_b128 v[200:203], v10 offset:10240
  ds_read_b128 v[204:207], v10 offset:11264
  ds_read_b128 v[208:211], v10 offset:12288
  ds_read_b128 v[212:215], v10 offset:13312
  ds_read_b128 v[216:219], v10 offset:14336
  s_waitcnt lgkmcnt(14)
  v_add_f32 v80, v80, v160
  v_add_f32 v81, v81, v161
  v_add_f32 v82, v82, v162
  v_add_f32 v83, v83, v163
  s_waitcnt lgkmcnt(13)
  v_add_f32 v84, v84, v164
  v_add_f32 v85, v85, v165
  v_add_f32 v86, v86, v166
  v_add_f32 v87, v87, v167
  s_waitcnt lgkmcnt(12)
  v_add_f32 v88, v88, v168
  v_add_f32 v89, v89, v169
  v_add_f32 v90, v90, v170
  v_add_f32 v91, v91, v171
  s_waitcnt lgkmcnt(11)
  v_add_f32 v92, v92, v172
  v_add_f32 v93, v93, v173
  v_add_f32 v94, v94, v174
  v_add_f32 v95, v95, v175
  s_waitcnt lgkmcnt(10)
  v_add_f32 v96, v96, v176
  v_add_f32 v97, v97, v177
  v_add_f32 v98, v98, v178
  v_add_f32 v99, v99, v179
  s_waitcnt lgkmcnt(9)
  v_add_f32 v80, v80, v180
  v_add_f32 v81, v81, v181
  v_add_f32 v82, v82, v182
  v_add_f32 v83, v83, v183
  s_waitcnt lgkmcnt(8)
  v_add_f32 v84, v84, v184
  v_add_f32 v85, v85, v185
  v_add_f32 v86, v86, v186
  v_add_f32 v87, v87, v187
  s_waitcnt lgkmcnt(7)
  v_add_f32 v88, v88, v188
  v_add_f32 v89, v89, v189
  v_add_f32 v90, v90, v190
  v_add_f32 v91, v91, v191
  s_waitcnt lgkmcnt(6)
  v_add_f32 v92, v92, v192
  v_add_f32 v93, v93, v193
  v_add_f32 v94, v94, v194
  v_add_f32 v95, v95, v195
  s_waitcnt lgkmcnt(5)
  v_add_f32 v96, v96, v196
  v_add_f32 v97, v97, v197
  v_add_f32 v98, v98, v198
  v_add_f32 v99, v99, v199
  s_waitcnt lgkmcnt(4)
  v_add_f32 v80, v80, v200
  v_add_f32 v81, v81, v201
  v_add_f32 v82, v82, v202
  v_add_f32 v83, v83, v203
  s_waitcnt lgkmcnt(3)
  v_add_f32 v84, v84, v204
  v_add_f32 v85, v85, v205
  v_add_f32 v86, v86, v206
  v_add_f32 v87, v87, v207
  s_waitcnt lgkmcnt(2)
  v_add_f32 v88, v88, v208
  v_add_f32 v89, v89, v209
  v_add_f32 v90, v90, v210
  v_add_f32 v91, v91, v211
  s_waitcnt lgkmcnt(1)
  v_add_f32 v92, v92, v212
  v_add_f32 v93, v93, v213
  v_add_f32 v94, v94, v214
  v_add_f32 v95, v95, v215
  s_waitcnt lgkmcnt(0)
  v_add_f32 v96, v96, v216
  v_add_f32 v97, v97, v217
  v_add_f32 v98, v98, v218
  v_add_f32 v99, v99, v219
  v_cvt_pk_bf16_f32 v100, v80, v81
  v_lshlrev_b32 v80, 16, v100
  v_and_b32 v81, s30, v100
  s_waitcnt vmcnt(2)
  v_lshlrev_b32 v120, 16, v56
  v_and_b32 v121, s30, v56
  v_add_f32 v80, v80, v120
  v_add_f32 v81, v81, v121
  v_cvt_pk_bf16_f32 v100, v80, v81
  v_lshlrev_b32 v80, 16, v100
  v_and_b32 v81, s30, v100
  v_mul_f32 v80, v80, v36
  v_mul_f32 v81, v81, v37
  v_cvt_pk_bf16_f32 v100, v80, v81
  v_lshlrev_b32 v80, 16, v100
  v_and_b32 v81, s30, v100
  v_lshlrev_b32 v120, 16, v248
  v_and_b32 v121, s30, v248
  v_add_f32 v80, v80, v120
  v_add_f32 v81, v81, v121
  v_cvt_pk_bf16_f32 v102, v80, v81
  v_cvt_pk_bf16_f32 v100, v82, v83
  v_lshlrev_b32 v82, 16, v100
  v_and_b32 v83, s30, v100
  v_lshlrev_b32 v120, 16, v57
  v_and_b32 v121, s30, v57
  v_add_f32 v82, v82, v120
  v_add_f32 v83, v83, v121
  v_cvt_pk_bf16_f32 v100, v82, v83
  v_lshlrev_b32 v82, 16, v100
  v_and_b32 v83, s30, v100
  v_mul_f32 v82, v82, v38
  v_mul_f32 v83, v83, v39
  v_cvt_pk_bf16_f32 v100, v82, v83
  v_lshlrev_b32 v82, 16, v100
  v_and_b32 v83, s30, v100
  v_lshlrev_b32 v120, 16, v249
  v_and_b32 v121, s30, v249
  v_add_f32 v82, v82, v120
  v_add_f32 v83, v83, v121
  v_cvt_pk_bf16_f32 v103, v82, v83
  v_cvt_pk_bf16_f32 v100, v84, v85
  v_lshlrev_b32 v84, 16, v100
  v_and_b32 v85, s30, v100
  v_lshlrev_b32 v120, 16, v58
  v_and_b32 v121, s30, v58
  v_add_f32 v84, v84, v120
  v_add_f32 v85, v85, v121
  v_cvt_pk_bf16_f32 v100, v84, v85
  v_lshlrev_b32 v84, 16, v100
  v_and_b32 v85, s30, v100
  v_mul_f32 v84, v84, v40
  v_mul_f32 v85, v85, v41
  v_cvt_pk_bf16_f32 v100, v84, v85
  v_lshlrev_b32 v84, 16, v100
  v_and_b32 v85, s30, v100
  v_lshlrev_b32 v120, 16, v250
  v_and_b32 v121, s30, v250
  v_add_f32 v84, v84, v120
  v_add_f32 v85, v85, v121
  v_cvt_pk_bf16_f32 v104, v84, v85
  v_cvt_pk_bf16_f32 v100, v86, v87
  v_lshlrev_b32 v86, 16, v100
  v_and_b32 v87, s30, v100
  v_lshlrev_b32 v120, 16, v59
  v_and_b32 v121, s30, v59
  v_add_f32 v86, v86, v120
  v_add_f32 v87, v87, v121
  v_cvt_pk_bf16_f32 v100, v86, v87
  v_lshlrev_b32 v86, 16, v100
  v_and_b32 v87, s30, v100
  v_mul_f32 v86, v86, v42
  v_mul_f32 v87, v87, v43
  v_cvt_pk_bf16_f32 v100, v86, v87
  v_lshlrev_b32 v86, 16, v100
  v_and_b32 v87, s30, v100
  v_lshlrev_b32 v120, 16, v251
  v_and_b32 v121, s30, v251
  v_add_f32 v86, v86, v120
  v_add_f32 v87, v87, v121
  v_cvt_pk_bf16_f32 v105, v86, v87
  v_cvt_pk_bf16_f32 v100, v88, v89
  v_lshlrev_b32 v88, 16, v100
  v_and_b32 v89, s30, v100
  s_waitcnt vmcnt(1)
  v_lshlrev_b32 v120, 16, v60
  v_and_b32 v121, s30, v60
  v_add_f32 v88, v88, v120
  v_add_f32 v89, v89, v121
  v_cvt_pk_bf16_f32 v100, v88, v89
  v_lshlrev_b32 v88, 16, v100
  v_and_b32 v89, s30, v100
  v_mul_f32 v88, v88, v44
  v_mul_f32 v89, v89, v45
  v_cvt_pk_bf16_f32 v100, v88, v89
  v_lshlrev_b32 v88, 16, v100
  v_and_b32 v89, s30, v100
  v_lshlrev_b32 v120, 16, v252
  v_and_b32 v121, s30, v252
  v_add_f32 v88, v88, v120
  v_add_f32 v89, v89, v121
  v_cvt_pk_bf16_f32 v106, v88, v89
  v_cvt_pk_bf16_f32 v100, v90, v91
  v_lshlrev_b32 v90, 16, v100
  v_and_b32 v91, s30, v100
  v_lshlrev_b32 v120, 16, v61
  v_and_b32 v121, s30, v61
  v_add_f32 v90, v90, v120
  v_add_f32 v91, v91, v121
  v_cvt_pk_bf16_f32 v100, v90, v91
  v_lshlrev_b32 v90, 16, v100
  v_and_b32 v91, s30, v100
  v_mul_f32 v90, v90, v46
  v_mul_f32 v91, v91, v47
  v_cvt_pk_bf16_f32 v100, v90, v91
  v_lshlrev_b32 v90, 16, v100
  v_and_b32 v91, s30, v100
  v_lshlrev_b32 v120, 16, v253
  v_and_b32 v121, s30, v253
  v_add_f32 v90, v90, v120
  v_add_f32 v91, v91, v121
  v_cvt_pk_bf16_f32 v107, v90, v91
  v_cvt_pk_bf16_f32 v100, v92, v93
  v_lshlrev_b32 v92, 16, v100
  v_and_b32 v93, s30, v100
  v_lshlrev_b32 v120, 16, v62
  v_and_b32 v121, s30, v62
  v_add_f32 v92, v92, v120
  v_add_f32 v93, v93, v121
  v_cvt_pk_bf16_f32 v100, v92, v93
  v_lshlrev_b32 v92, 16, v100
  v_and_b32 v93, s30, v100
  v_mul_f32 v92, v92, v48
  v_mul_f32 v93, v93, v49
  v_cvt_pk_bf16_f32 v100, v92, v93
  v_lshlrev_b32 v92, 16, v100
  v_and_b32 v93, s30, v100
  v_lshlrev_b32 v120, 16, v254
  v_and_b32 v121, s30, v254
  v_add_f32 v92, v92, v120
  v_add_f32 v93, v93, v121
  v_cvt_pk_bf16_f32 v108, v92, v93
  v_cvt_pk_bf16_f32 v100, v94, v95
  v_lshlrev_b32 v94, 16, v100
  v_and_b32 v95, s30, v100
  v_lshlrev_b32 v120, 16, v63
  v_and_b32 v121, s30, v63
  v_add_f32 v94, v94, v120
  v_add_f32 v95, v95, v121
  v_cvt_pk_bf16_f32 v100, v94, v95
  v_lshlrev_b32 v94, 16, v100
  v_and_b32 v95, s30, v100
  v_mul_f32 v94, v94, v50
  v_mul_f32 v95, v95, v51
  v_cvt_pk_bf16_f32 v100, v94, v95
  v_lshlrev_b32 v94, 16, v100
  v_and_b32 v95, s30, v100
  v_lshlrev_b32 v120, 16, v255
  v_and_b32 v121, s30, v255
  v_add_f32 v94, v94, v120
  v_add_f32 v95, v95, v121
  v_cvt_pk_bf16_f32 v109, v94, v95
  v_cvt_pk_bf16_f32 v100, v96, v97
  v_lshlrev_b32 v96, 16, v100
  v_and_b32 v97, s30, v100
  s_waitcnt vmcnt(0)
  v_lshlrev_b32 v120, 16, v64
  v_and_b32 v121, s30, v64
  v_add_f32 v96, v96, v120
  v_add_f32 v97, v97, v121
  v_cvt_pk_bf16_f32 v100, v96, v97
  v_lshlrev_b32 v96, 16, v100
  v_and_b32 v97, s30, v100
  v_mul_f32 v96, v96, v52
  v_mul_f32 v97, v97, v53
  v_cvt_pk_bf16_f32 v100, v96, v97
  v_lshlrev_b32 v96, 16, v100
  v_and_b32 v97, s30, v100
  v_lshlrev_b32 v120, 16, v29
  v_and_b32 v121, s30, v29
  v_add_f32 v96, v96, v120
  v_add_f32 v97, v97, v121
  v_cvt_pk_bf16_f32 v110, v96, v97
  v_cvt_pk_bf16_f32 v100, v98, v99
  v_lshlrev_b32 v98, 16, v100
  v_and_b32 v99, s30, v100
  v_lshlrev_b32 v120, 16, v65
  v_and_b32 v121, s30, v65
  v_add_f32 v98, v98, v120
  v_add_f32 v99, v99, v121
  v_cvt_pk_bf16_f32 v100, v98, v99
  v_lshlrev_b32 v98, 16, v100
  v_and_b32 v99, s30, v100
  v_mul_f32 v98, v98, v54
  v_mul_f32 v99, v99, v55
  v_cvt_pk_bf16_f32 v100, v98, v99
  v_lshlrev_b32 v98, 16, v100
  v_and_b32 v99, s30, v100
  v_lshlrev_b32 v120, 16, v31
  v_and_b32 v121, s30, v31
  v_add_f32 v98, v98, v120
  v_add_f32 v99, v99, v121
  v_cvt_pk_bf16_f32 v111, v98, v99
  buffer_store_dwordx4 v[102:105], v17, s[48:51], s36 offen
  buffer_store_dwordx4 v[106:109], v17, s[48:51], s36 offen offset:64
  buffer_store_dwordx2 v[110:111], v18, s[48:51], s36 offen offset:128
KF_END:
  s_endpgm
.section .rodata,"a"
.p2align 6
.amdhsa_kernel k1_kernel
  .amdhsa_next_free_vgpr 256
  .amdhsa_next_free_sgpr 102
  .amdhsa_accum_offset 256
  .amdhsa_group_segment_fixed_size 0
  .amdhsa_kernarg_size 120
  .amdhsa_user_sgpr_count 2
  .amdhsa_user_sgpr_kernarg_segment_ptr 1
  .amdhsa_system_sgpr_workgroup_id_x 1
.end_amdhsa_kernel
.p2align 6
.amdhsa_kernel kf_kernel
  .amdhsa_next_free_vgpr 512
  .amdhsa_next_free_sgpr 102
  .amdhsa_accum_offset 256
  .amdhsa_group_segment_fixed_size 0
  .amdhsa_kernarg_size 120
  .amdhsa_user_sgpr_count 2
  .amdhsa_user_sgpr_kernarg_segment_ptr 1
  .amdhsa_system_sgpr_workgroup_id_x 1
.end_amdhsa_kernel
```
